```python
import torch

def _softmax(x, axis=-1):
    return torch.softmax(x, dim=axis)

def _gelu(x):
    return torch.nn.functional.gelu(x, approximate='tanh')

def _silu(x):
    return torch.nn.functional.silu(x)

def _sigmoid(x):
    return torch.sigmoid(x)

def _layernorm(x, axis=-1, eps=1e-05):
    m = x.mean(dim=axis, keepdim=True)
    v = x.var(dim=axis, keepdim=True, unbiased=False)
    return (x - m) / torch.sqrt(v + eps)

def _scatter_add(tgt, idx, src, axis=0):
    return tgt.clone().index_add_(axis, idx, src)

def _segment_sum(src, seg, n):
    out = torch.zeros((n,) + src.shape[1:], dtype=src.dtype)
    return out.index_add_(0, seg, src)

def _pad(x, pw):
    flat = tuple((v for pair in reversed(pw) for v in pair))
    return torch.nn.functional.pad(x, flat)
kernel_name = 'adaLN_cond__sliding_local_dilated__geglu_ffn__prompt'

def setup_inputs():

    _w = lambda a: (lambda t: t.to(torch.bfloat16) if t.is_floating_point() else t)(torch.as_tensor(a))

    def _A_setup():
        B, S, D = (1, 2048, 640)
        return {'x': _w((lambda *s: torch.randn(*s, dtype=torch.bfloat16) * 0.05)(B, S, D)), 'wqkv': _w((lambda *s: torch.randn(*s, dtype=torch.bfloat16) * 0.05)(D, 3 * D)), 'wo': _w((lambda *s: torch.randn(*s, dtype=torch.bfloat16) * 0.05)(D, D))}
    _A_in = _A_setup()

    def _B_setup():
        B, S, D, F = (1, 2048, 640, 1536)
        return {'x': _w((lambda *s: torch.randn(*s, dtype=torch.bfloat16) * 0.05)(B, S, D)), 'w_gate': _w((lambda *s: torch.randn(*s, dtype=torch.bfloat16) * 0.05)(D, F)), 'w_up': _w((lambda *s: torch.randn(*s, dtype=torch.bfloat16) * 0.05)(D, F)), 'w_down': _w((lambda *s: torch.randn(*s, dtype=torch.bfloat16) * 0.05)(F, D))}
    _B_in = _B_setup()
    return {'A_x': _A_in['x'], 'A_wqkv': _A_in['wqkv'], 'A_wo': _A_in['wo'], 'B_x': _B_in['x'], 'B_w_gate': _B_in['w_gate'], 'B_w_up': _B_in['w_up'], 'B_w_down': _B_in['w_down'], 'c': _w((lambda *s: torch.randn(*s, dtype=torch.bfloat16) * 0.1)(1, 640) * 8.0), 'w_mod': _w((lambda *s: torch.randn(*s, dtype=torch.bfloat16) * 0.1)(640, 6 * 640) * 640 ** (-0.5) * 8.0)}

def reference(A_x, A_wqkv, A_wo, B_x, B_w_gate, B_w_up, B_w_down, c, w_mod):

    def _A_ref(x, wqkv, wo):
        B, S, D = x.shape
        H = 32
        Dh = D // H
        W, dil = (8, 2)
        qkv = (lambda x, *d: x.permute(*d))((x @ wqkv).reshape(B, S, 3, H, Dh), 2, 0, 3, 1, 4)
        q, k, v = (qkv[0], qkv[1], qkv[2])
        scale = Dh ** (-0.5)
        pos = torch.arange(S)
        off = torch.arange(W) * dil
        idx = pos[:, None] - off[None, :]
        mask = idx >= 0
        idx_c = torch.where(mask, idx, 0).reshape(-1)
        kg = k[:, :, idx_c, :].reshape(B, H, S, W, Dh)
        vg = v[:, :, idx_c, :].reshape(B, H, S, W, Dh)
        logits = torch.einsum('bhsd,bhswd->bhsw', q, kg) * scale
        logits = torch.where(mask[None, None, :, :], logits, -1000000000.0)
        attn = _softmax(logits, axis=-1)
        o = torch.einsum('bhsw,bhswd->bhsd', attn, vg)
        return (lambda x, *d: x.permute(*d))(o, 0, 2, 1, 3).reshape(B, S, D) @ wo

    def _B_ref(x, w_gate, w_up, w_down):
        return _gelu(x @ w_gate) * (x @ w_up) @ w_down
    x = A_x
    mod = (_silu(c) @ w_mod).reshape(c.shape[0], 6, 1, -1)
    sa, ca, ga, sb, cb, gb = (mod[:, 0].clone(), mod[:, 1].clone(), mod[:, 2].clone(), mod[:, 3].clone(), mod[:, 4].clone(), mod[:, 5].clone())
    h = _layernorm(x, axis=-1) * (1 + ca) + sa
    x = x + ga * _A_ref(h, A_wqkv, A_wo)
    h = _layernorm(x, axis=-1) * (1 + cb) + sb
    x = x + gb * _B_ref(h, B_w_gate, B_w_up, B_w_down)
    return x
```

```asm
; @launch grid=(256,1,1) block=(512,1,1) lds=163840
.amdgcn_target "amdgcn-amd-amdhsa--gfx950"
.text
.globl adaLN_cond__sliding_local_dilated__geglu_ffn__prompt_kernel
.p2align 8
.type adaLN_cond__sliding_local_dilated__geglu_ffn__prompt_kernel,@function
adaLN_cond__sliding_local_dilated__geglu_ffn__prompt_kernel:
    s_cmp_ge_u32 s2, 256
    s_cbranch_scc1 k0_end
    s_load_dwordx4 s[48:51], s[0:1], 0
    s_load_dwordx2 s[16:17], s[0:1], 16
    s_load_dwordx4 s[52:55], s[0:1], 56
    s_load_dwordx2 s[28:29], s[0:1], 88
    v_lshrrev_b32 v3, 6, v0
    v_and_b32 v1, 63, v0
    v_readfirstlane_b32 s44, v3
    s_nop 3
    s_and_b32 s32, s44, 3
    v_lshlrev_b32 v2, 4, v1
    s_and_b32 s33, s2, 7
    s_lshr_b32 s34, s2, 3
    s_lshr_b32 s40, s33, 2
    s_add_u32 s40, s40, 8
    s_and_b32 s41, s33, 3
    s_cmp_ge_u32 s34, 20
    s_cselect_b32 s35, 1, 0
    s_cmp_ge_u32 s34, 25
    s_cselect_b32 s35, 2, s35
    s_cmp_ge_u32 s34, 30
    s_cselect_b32 s35, 3, s35
    s_cmp_lt_u32 s34, 16
    s_cselect_b32 s37, s33, s40
    s_sub_u32 s42, s34, 20
    s_cmp_lt_u32 s42, 4
    s_cselect_b32 s37, s33, s37
    s_lshl_b32 s43, s41, 2
    s_add_u32 s43, s43, s34
    s_sub_u32 s43, s43, 16
    s_cmp_lt_u32 s34, 16
    s_cselect_b32 s38, s34, s43
    s_cmp_lt_u32 s42, 4
    s_cselect_b32 s38, s42, s38
    s_cmp_eq_u32 s34, 24
    s_cselect_b32 s38, s41, s38
    s_mul_i32 s40, s33, 5
    s_add_u32 s40, s40, s34
    s_sub_u32 s40, s40, 25
    s_lshl_b32 s41, s33, 1
    s_add_u32 s41, s41, s34
    s_add_u32 s41, s41, 10
    s_cmp_eq_u32 s35, 2
    s_cselect_b32 s39, s40, 63
    s_cmp_eq_u32 s35, 3
    s_cselect_b32 s39, s41, s39
    s_lshl_b32 s40, s37, 7
    s_add_u32 s41, s40, 1280
    s_cmp_eq_u32 s35, 0
    s_cselect_b32 s36, s41, s40
    s_lshl_b32 s40, s39, 7
    s_add_u32 s40, s40, 2560
    s_cmp_eq_u32 s35, 2
    s_cselect_b32 s36, s40, s36
    s_mov_b32 s10, 2621440
    s_mov_b32 s11, 0x20000
    s_mov_b32 s14, 2457600
    s_mov_b32 s15, 0x20000
    s_mov_b32 s18, 819200
    s_mov_b32 s19, 0x20000
    s_mov_b32 s22, 1280
    s_mov_b32 s23, 0x20000
    s_mov_b32 s26, 4915200
    s_mov_b32 s27, 0x20000
    s_mov_b32 s30, 26906624
    s_mov_b32 s31, 0x20000
    s_cmp_lt_u32 s44, 4
    s_cbranch_scc1 k0_compute
    v_bfe_u32 v4, v1, 4, 1
    v_bfe_u32 v3, v1, 5, 1
    s_and_b32 s40, s32, 1
    v_xor_b32 v3, s40, v3
    v_lshl_or_b32 v3, v3, 1, v4
    v_lshlrev_b32 v3, 1, v3
    v_and_b32 v4, 7, v1
    v_xor_b32 v3, v3, v4
    v_lshrrev_b32 v4, 3, v1
    v_mul_u32_u24 v7, 7680, v4
    v_lshl_add_u32 v7, v3, 4, v7
    s_getpc_b64 s[84:85]
cp_here:
    s_add_u32 s84, s84, adaLN_cond__sliding_local_dilated__geglu_ffn__prompt_kernel-cp_here
    s_addc_u32 s85, s85, -1
    s_mov_b32 s86, all_code_end-adaLN_cond__sliding_local_dilated__geglu_ffn__prompt_kernel
    s_mov_b32 s87, 0x20000
    s_lshr_b32 s88, s2, 3
    s_lshl_b32 s88, s88, 2
    s_add_u32 s88, s88, s32
    s_lshl_b32 s88, s88, 10
    v_and_b32 v120, 63, v0
    v_lshlrev_b32 v120, 7, v120
    s_mov_b64 exec, 0xff
    buffer_load_dword v122, v120, s[84:87], s88 offen
    s_mov_b64 exec, -1
    s_waitcnt lgkmcnt(0)
    s_mov_b32 s8, s48
    s_mov_b32 s9, s49
    s_mov_b32 s12, s50
    s_mov_b32 s13, s51
    s_mov_b32 s20, s52
    s_mov_b32 s21, s53
    s_mov_b32 s24, s54
    s_mov_b32 s25, s55
    s_cmp_eq_u32 s35, 3
    s_cbranch_scc1 k0_dma_none
    s_cmp_eq_u32 s35, 2
    s_cbranch_scc1 k0_dma_B
    s_mul_i32 s40, s32, 61440
    s_add_u32 s40, s40, s36
    s_lshl_b32 s41, s32, 10
    s_add_u32 s41, s41, 67584
    s_mov_b32 m0, s41
    s_add_u32 s41, s41, 4096
    buffer_load_dwordx4 v7, s[24:27], s40 offen lds
    s_add_u32 s40, s40, 245760
    s_mov_b32 m0, s41
    s_add_u32 s41, s41, 4096
    buffer_load_dwordx4 v7, s[24:27], s40 offen lds
    s_add_u32 s40, s40, 245760
    s_mov_b32 m0, s41
    s_add_u32 s41, s41, 4096
    buffer_load_dwordx4 v7, s[24:27], s40 offen lds
    s_add_u32 s40, s40, 245760
    s_mov_b32 m0, s41
    s_add_u32 s41, s41, 4096
    buffer_load_dwordx4 v7, s[24:27], s40 offen lds
    s_add_u32 s40, s40, 245760
    s_mov_b32 m0, s41
    s_add_u32 s41, s41, 4096
    buffer_load_dwordx4 v7, s[24:27], s40 offen lds
    s_add_u32 s40, s40, 245760
    s_mov_b32 m0, s41
    s_add_u32 s41, s41, 4096
    buffer_load_dwordx4 v7, s[24:27], s40 offen lds
    s_add_u32 s40, s40, 245760
    s_mov_b32 m0, s41
    s_add_u32 s41, s41, 4096
    buffer_load_dwordx4 v7, s[24:27], s40 offen lds
    s_add_u32 s40, s40, 245760
    s_mov_b32 m0, s41
    s_add_u32 s41, s41, 4096
    buffer_load_dwordx4 v7, s[24:27], s40 offen lds
    s_add_u32 s40, s40, 245760
    s_mov_b32 m0, s41
    s_add_u32 s41, s41, 4096
    buffer_load_dwordx4 v7, s[24:27], s40 offen lds
    s_add_u32 s40, s40, 245760
    s_mov_b32 m0, s41
    s_add_u32 s41, s41, 4096
    buffer_load_dwordx4 v7, s[24:27], s40 offen lds
    s_add_u32 s40, s40, 245760
    s_mov_b32 m0, s41
    s_add_u32 s41, s41, 4096
    buffer_load_dwordx4 v7, s[24:27], s40 offen lds
    s_add_u32 s40, s40, 245760
    s_mov_b32 m0, s41
    s_add_u32 s41, s41, 4096
    buffer_load_dwordx4 v7, s[24:27], s40 offen lds
    s_add_u32 s40, s40, 245760
    s_mov_b32 m0, s41
    s_add_u32 s41, s41, 4096
    buffer_load_dwordx4 v7, s[24:27], s40 offen lds
    s_add_u32 s40, s40, 245760
    s_mov_b32 m0, s41
    s_add_u32 s41, s41, 4096
    buffer_load_dwordx4 v7, s[24:27], s40 offen lds
    s_add_u32 s40, s40, 245760
    s_mov_b32 m0, s41
    s_add_u32 s41, s41, 4096
    buffer_load_dwordx4 v7, s[24:27], s40 offen lds
    s_add_u32 s40, s40, 245760
    s_mov_b32 m0, s41
    s_add_u32 s41, s41, 4096
    buffer_load_dwordx4 v7, s[24:27], s40 offen lds
    s_add_u32 s40, s40, 245760
    s_mov_b32 m0, s41
    s_add_u32 s41, s41, 4096
    buffer_load_dwordx4 v7, s[24:27], s40 offen lds
    s_add_u32 s40, s40, 245760
    s_mov_b32 m0, s41
    s_add_u32 s41, s41, 4096
    buffer_load_dwordx4 v7, s[24:27], s40 offen lds
    s_add_u32 s40, s40, 245760
    s_mov_b32 m0, s41
    s_add_u32 s41, s41, 4096
    buffer_load_dwordx4 v7, s[24:27], s40 offen lds
    s_add_u32 s40, s40, 245760
    s_mov_b32 m0, s41
    s_nop 0
    buffer_load_dwordx4 v7, s[24:27], s40 offen lds
    s_cmp_eq_u32 s35, 1
    s_cbranch_scc1 k0_dma_D
    s_bfe_u32 s43, s32, 0x10001
    v_lshrrev_b32 v4, 4, v1
    s_lshl_b32 s42, s43, 2
    v_or_b32 v4, s42, v4
    v_lshlrev_b32 v4, 1, v4
    v_and_b32 v3, 15, v1
    v_xor_b32 v3, v3, v4
    v_min_u32 v3, 14, v3
    v_mul_u32_u24 v4, 52, v3
    v_lshrrev_b32 v4, 8, v4
    v_mul_u32_u24 v5, 5, v4
    v_sub_u32 v3, v3, v5
    v_lshlrev_b32 v3, 4, v3
    v_mul_u32_u24 v4, 1280, v4
    v_add_u32 v3, v3, v4
    v_lshrrev_b32 v4, 4, v1
    v_mul_u32_u24 v4, 3840, v4
    v_add_u32 v8, v3, v4
    s_lshl_b32 s40, s37, 4
    s_add_u32 s40, s40, s32
    s_mul_i32 s40, s40, 15360
    s_mul_i32 s41, s38, 80
    s_add_u32 s40, s40, s41
    s_lshl_b32 s41, s32, 10
    s_add_u32 s41, s41, 2048
    s_mov_b32 m0, s41
    s_add_u32 s41, s41, 4096
    buffer_load_dwordx4 v8, s[12:15], s40 offen lds
    s_add_u32 s40, s40, 61440
    s_mov_b32 m0, s41
    s_add_u32 s41, s41, 4096
    buffer_load_dwordx4 v8, s[12:15], s40 offen lds
    s_add_u32 s40, s40, 61440
    s_mov_b32 m0, s41
    s_add_u32 s41, s41, 4096
    buffer_load_dwordx4 v8, s[12:15], s40 offen lds
    s_add_u32 s40, s40, 61440
    s_mov_b32 m0, s41
    s_add_u32 s41, s41, 4096
    buffer_load_dwordx4 v8, s[12:15], s40 offen lds
    s_add_u32 s40, s40, 61440
    s_cmp_lt_u32 s32, 2
    s_cbranch_scc0 k0_xr_C
    s_lshl_b32 s40, s2, 3
    s_lshl_b32 s41, s32, 2
    s_add_u32 s40, s40, s41
    v_lshrrev_b32 v3, 4, v1
    v_add_u32 v3, s40, v3
    s_movk_i32 s41, 1280
    v_mul_lo_u32 v14, v3, s41
    v_and_b32 v3, 15, v1
    v_lshl_add_u32 v14, v3, 4, v14
    buffer_load_dwordx4 v[24:27], v14, s[8:11], 0 offen offset:0
    buffer_load_dwordx4 v[28:31], v14, s[8:11], 0 offen offset:256
    buffer_load_dwordx4 v[32:35], v14, s[8:11], 0 offen offset:512
    buffer_load_dwordx4 v[36:39], v14, s[8:11], 0 offen offset:768
    buffer_load_dwordx4 v[40:43], v14, s[8:11], 0 offen offset:1024
    s_branch k0_xrd_C
k0_xr_C:
    v_mov_b32 v14, 0x40000000
    buffer_load_dword v24, v14, s[8:11], 0 offen
    buffer_load_dword v25, v14, s[8:11], 0 offen
    buffer_load_dword v26, v14, s[8:11], 0 offen
    buffer_load_dword v27, v14, s[8:11], 0 offen
    buffer_load_dword v28, v14, s[8:11], 0 offen
k0_xrd_C:
    s_waitcnt vmcnt(9)
    s_branch k0_dma_done
k0_dma_B:
    s_mul_i32 s40, s32, 61440
    s_add_u32 s40, s40, s36
    s_lshl_b32 s41, s32, 10
    s_add_u32 s41, s41, 67584
    s_mov_b32 m0, s41
    s_add_u32 s41, s41, 4096
    buffer_load_dwordx4 v7, s[24:27], s40 offen lds
    s_add_u32 s40, s40, 245760
    s_mov_b32 m0, s41
    s_add_u32 s41, s41, 4096
    buffer_load_dwordx4 v7, s[24:27], s40 offen lds
    s_add_u32 s40, s40, 245760
    s_mov_b32 m0, s41
    s_add_u32 s41, s41, 4096
    buffer_load_dwordx4 v7, s[24:27], s40 offen lds
    s_add_u32 s40, s40, 245760
    s_mov_b32 m0, s41
    s_add_u32 s41, s41, 4096
    buffer_load_dwordx4 v7, s[24:27], s40 offen lds
    s_add_u32 s40, s40, 245760
    s_mov_b32 m0, s41
    s_add_u32 s41, s41, 4096
    buffer_load_dwordx4 v7, s[24:27], s40 offen lds
    s_add_u32 s40, s40, 245760
    s_mov_b32 m0, s41
    s_add_u32 s41, s41, 4096
    buffer_load_dwordx4 v7, s[24:27], s40 offen lds
    s_add_u32 s40, s40, 245760
    s_mov_b32 m0, s41
    s_add_u32 s41, s41, 4096
    buffer_load_dwordx4 v7, s[24:27], s40 offen lds
    s_add_u32 s40, s40, 245760
    s_mov_b32 m0, s41
    s_add_u32 s41, s41, 4096
    buffer_load_dwordx4 v7, s[24:27], s40 offen lds
    s_add_u32 s40, s40, 245760
    s_mov_b32 m0, s41
    s_add_u32 s41, s41, 4096
    buffer_load_dwordx4 v7, s[24:27], s40 offen lds
    s_add_u32 s40, s40, 245760
    s_mov_b32 m0, s41
    s_add_u32 s41, s41, 4096
    buffer_load_dwordx4 v7, s[24:27], s40 offen lds
    s_add_u32 s40, s40, 245760
    s_mov_b32 m0, s41
    s_add_u32 s41, s41, 4096
    buffer_load_dwordx4 v7, s[24:27], s40 offen lds
    s_add_u32 s40, s40, 245760
    s_mov_b32 m0, s41
    s_add_u32 s41, s41, 4096
    buffer_load_dwordx4 v7, s[24:27], s40 offen lds
    s_add_u32 s40, s40, 245760
    s_mov_b32 m0, s41
    s_add_u32 s41, s41, 4096
    buffer_load_dwordx4 v7, s[24:27], s40 offen lds
    s_add_u32 s40, s40, 245760
    s_mov_b32 m0, s41
    s_add_u32 s41, s41, 4096
    buffer_load_dwordx4 v7, s[24:27], s40 offen lds
    s_add_u32 s40, s40, 245760
    s_mov_b32 m0, s41
    s_add_u32 s41, s41, 4096
    buffer_load_dwordx4 v7, s[24:27], s40 offen lds
    s_add_u32 s40, s40, 245760
    s_mov_b32 m0, s41
    s_add_u32 s41, s41, 4096
    buffer_load_dwordx4 v7, s[24:27], s40 offen lds
    s_add_u32 s40, s40, 245760
    s_mov_b32 m0, s41
    s_add_u32 s41, s41, 4096
    buffer_load_dwordx4 v7, s[24:27], s40 offen lds
    s_add_u32 s40, s40, 245760
    s_mov_b32 m0, s41
    s_add_u32 s41, s41, 4096
    buffer_load_dwordx4 v7, s[24:27], s40 offen lds
    s_add_u32 s40, s40, 245760
    s_mov_b32 m0, s41
    s_add_u32 s41, s41, 4096
    buffer_load_dwordx4 v7, s[24:27], s40 offen lds
    s_add_u32 s40, s40, 245760
    s_mov_b32 m0, s41
    s_nop 0
    buffer_load_dwordx4 v7, s[24:27], s40 offen lds
    s_mul_i32 s42, s39, 205
    s_lshr_b32 s42, s42, 11
    s_mul_i32 s43, s42, 10
    s_sub_u32 s43, s39, s43
    s_lshl_b32 s42, s42, 7
    s_lshl_b32 s43, s43, 7
    v_bfe_u32 v4, v1, 4, 1
    v_bfe_u32 v3, v1, 5, 1
    s_and_b32 s40, s32, 1
    v_xor_b32 v3, s40, v3
    v_lshl_or_b32 v3, v3, 1, v4
    v_lshlrev_b32 v3, 1, v3
    v_and_b32 v4, 7, v1
    v_xor_b32 v3, v3, v4
    v_lshrrev_b32 v4, 3, v1
    v_mul_u32_u24 v8, 1280, v4
    v_lshl_add_u32 v8, v3, 4, v8
    s_lshl_b32 s40, s32, 3
    s_add_u32 s40, s40, s42
    s_mul_i32 s40, s40, 1280
    s_add_u32 s40, s40, s43
    s_lshl_b32 s41, s32, 10
    s_add_u32 s41, s41, 2048
    s_mov_b32 m0, s41
    s_add_u32 s41, s41, 4096
    buffer_load_dwordx4 v8, s[16:19], s40 offen lds
    s_add_u32 s40, s40, 40960
    s_mov_b32 m0, s41
    s_add_u32 s41, s41, 4096
    buffer_load_dwordx4 v8, s[16:19], s40 offen lds
    s_add_u32 s40, s40, 40960
    s_mov_b32 m0, s41
    s_add_u32 s41, s41, 4096
    buffer_load_dwordx4 v8, s[16:19], s40 offen lds
    s_add_u32 s40, s40, 40960
    s_mov_b32 m0, s41
    s_add_u32 s41, s41, 4096
    buffer_load_dwordx4 v8, s[16:19], s40 offen lds
    s_add_u32 s40, s40, 40960
    s_cmp_lt_u32 s32, 2
    s_cbranch_scc0 k0_xr_B
    s_lshl_b32 s40, s2, 3
    s_lshl_b32 s41, s32, 2
    s_add_u32 s40, s40, s41
    v_lshrrev_b32 v3, 4, v1
    v_add_u32 v3, s40, v3
    s_movk_i32 s41, 1280
    v_mul_lo_u32 v14, v3, s41
    v_and_b32 v3, 15, v1
    v_lshl_add_u32 v14, v3, 4, v14
    buffer_load_dwordx4 v[24:27], v14, s[8:11], 0 offen offset:0
    buffer_load_dwordx4 v[28:31], v14, s[8:11], 0 offen offset:256
    buffer_load_dwordx4 v[32:35], v14, s[8:11], 0 offen offset:512
    buffer_load_dwordx4 v[36:39], v14, s[8:11], 0 offen offset:768
    buffer_load_dwordx4 v[40:43], v14, s[8:11], 0 offen offset:1024
    s_branch k0_xrd_B
k0_xr_B:
    v_mov_b32 v14, 0x40000000
    buffer_load_dword v24, v14, s[8:11], 0 offen
    buffer_load_dword v25, v14, s[8:11], 0 offen
    buffer_load_dword v26, v14, s[8:11], 0 offen
    buffer_load_dword v27, v14, s[8:11], 0 offen
    buffer_load_dword v28, v14, s[8:11], 0 offen
k0_xrd_B:
    s_waitcnt vmcnt(9)
    s_branch k0_dma_done
k0_dma_none:
    s_cmp_lt_u32 s39, 50
    s_cbranch_scc0 k0_dma_none2
    s_mul_i32 s42, s39, 205
    s_lshr_b32 s42, s42, 11
    s_mul_i32 s43, s42, 10
    s_sub_u32 s43, s39, s43
    s_lshl_b32 s42, s42, 7
    s_lshl_b32 s43, s43, 7
    v_bfe_u32 v4, v1, 4, 1
    v_bfe_u32 v3, v1, 5, 1
    s_and_b32 s40, s32, 1
    v_xor_b32 v3, s40, v3
    v_lshl_or_b32 v3, v3, 1, v4
    v_lshlrev_b32 v3, 1, v3
    v_and_b32 v4, 7, v1
    v_xor_b32 v3, v3, v4
    v_lshrrev_b32 v4, 3, v1
    v_mul_u32_u24 v8, 1280, v4
    v_lshl_add_u32 v8, v3, 4, v8
    s_lshl_b32 s40, s32, 3
    s_add_u32 s40, s40, s42
    s_mul_i32 s40, s40, 1280
    s_add_u32 s40, s40, s43
    s_lshl_b32 s41, s32, 10
    s_add_u32 s41, s41, 2048
    s_mov_b32 m0, s41
    s_add_u32 s41, s41, 4096
    buffer_load_dwordx4 v8, s[16:19], s40 offen lds
    s_add_u32 s40, s40, 40960
    s_mov_b32 m0, s41
    s_add_u32 s41, s41, 4096
    buffer_load_dwordx4 v8, s[16:19], s40 offen lds
    s_add_u32 s40, s40, 40960
    s_mov_b32 m0, s41
    s_add_u32 s41, s41, 4096
    buffer_load_dwordx4 v8, s[16:19], s40 offen lds
    s_add_u32 s40, s40, 40960
    s_mov_b32 m0, s41
    s_add_u32 s41, s41, 4096
    buffer_load_dwordx4 v8, s[16:19], s40 offen lds
    s_add_u32 s40, s40, 40960
k0_dma_none2:
    s_cmp_lt_u32 s32, 2
    s_cbranch_scc0 k0_xr_N
    s_lshl_b32 s40, s2, 3
    s_lshl_b32 s41, s32, 2
    s_add_u32 s40, s40, s41
    v_lshrrev_b32 v3, 4, v1
    v_add_u32 v3, s40, v3
    s_movk_i32 s41, 1280
    v_mul_lo_u32 v14, v3, s41
    v_and_b32 v3, 15, v1
    v_lshl_add_u32 v14, v3, 4, v14
    buffer_load_dwordx4 v[24:27], v14, s[8:11], 0 offen offset:0
    buffer_load_dwordx4 v[28:31], v14, s[8:11], 0 offen offset:256
    buffer_load_dwordx4 v[32:35], v14, s[8:11], 0 offen offset:512
    buffer_load_dwordx4 v[36:39], v14, s[8:11], 0 offen offset:768
    buffer_load_dwordx4 v[40:43], v14, s[8:11], 0 offen offset:1024
    s_branch k0_xrd_N
k0_xr_N:
    v_mov_b32 v14, 0x40000000
    buffer_load_dword v24, v14, s[8:11], 0 offen
    buffer_load_dword v25, v14, s[8:11], 0 offen
    buffer_load_dword v26, v14, s[8:11], 0 offen
    buffer_load_dword v27, v14, s[8:11], 0 offen
    buffer_load_dword v28, v14, s[8:11], 0 offen
k0_xrd_N:
    s_branch k0_dma_done
k0_dma_D:
    s_lshl_b32 s40, s32, 1
    v_xor_b32 v3, s40, v1
    v_lshlrev_b32 v8, 4, v3
    s_lshl_b32 s40, s32, 1
    s_or_b32 s40, s40, 8
    v_xor_b32 v3, s40, v1
    v_lshlrev_b32 v15, 4, v3
    s_lshl_b32 s56, s37, 6
    s_add_u32 s56, s56, s32
    s_mul_i32 s56, s56, 3840
    s_lshl_b32 s41, s38, 10
    s_add_u32 s56, s56, s41
    s_lshl_b32 s57, s32, 10
    s_add_u32 s57, s57, 2048
    s_add_u32 m0, s57, 0
    s_add_u32 s40, s56, 0
    buffer_load_dwordx4 v8, s[12:15], s40 offen lds
    s_add_u32 m0, s57, 4096
    s_add_u32 s40, s56, 15360
    buffer_load_dwordx4 v8, s[12:15], s40 offen lds
    s_add_u32 m0, s57, 8192
    s_add_u32 s40, s56, 30720
    buffer_load_dwordx4 v15, s[12:15], s40 offen lds
    s_add_u32 m0, s57, 12288
    s_add_u32 s40, s56, 46080
    buffer_load_dwordx4 v15, s[12:15], s40 offen lds
    s_waitcnt vmcnt(4)
    s_barrier
    s_add_u32 m0, s57, 16384
    s_add_u32 s40, s56, 61440
    buffer_load_dwordx4 v8, s[12:15], s40 offen lds
    s_add_u32 m0, s57, 20480
    s_add_u32 s40, s56, 76800
    buffer_load_dwordx4 v8, s[12:15], s40 offen lds
    s_add_u32 m0, s57, 24576
    s_add_u32 s40, s56, 92160
    buffer_load_dwordx4 v15, s[12:15], s40 offen lds
    s_add_u32 m0, s57, 28672
    s_add_u32 s40, s56, 107520
    buffer_load_dwordx4 v15, s[12:15], s40 offen lds
    s_add_u32 m0, s57, 32768
    s_add_u32 s40, s56, 122880
    buffer_load_dwordx4 v8, s[12:15], s40 offen lds
    s_add_u32 m0, s57, 36864
    s_add_u32 s40, s56, 138240
    buffer_load_dwordx4 v8, s[12:15], s40 offen lds
    s_add_u32 m0, s57, 40960
    s_add_u32 s40, s56, 153600
    buffer_load_dwordx4 v15, s[12:15], s40 offen lds
    s_add_u32 m0, s57, 45056
    s_add_u32 s40, s56, 168960
    buffer_load_dwordx4 v15, s[12:15], s40 offen lds
    s_add_u32 m0, s57, 49152
    s_add_u32 s40, s56, 184320
    buffer_load_dwordx4 v8, s[12:15], s40 offen lds
    s_add_u32 m0, s57, 53248
    s_add_u32 s40, s56, 199680
    buffer_load_dwordx4 v8, s[12:15], s40 offen lds
    s_add_u32 m0, s57, 57344
    s_add_u32 s40, s56, 215040
    buffer_load_dwordx4 v15, s[12:15], s40 offen lds
    s_add_u32 m0, s57, 61440
    s_add_u32 s40, s56, 230400
    buffer_load_dwordx4 v15, s[12:15], s40 offen lds
    s_cmp_lt_u32 s32, 2
    s_cbranch_scc0 k0_xr_D
    s_lshl_b32 s40, s2, 3
    s_lshl_b32 s41, s32, 2
    s_add_u32 s40, s40, s41
    v_lshrrev_b32 v3, 4, v1
    v_add_u32 v3, s40, v3
    s_movk_i32 s41, 1280
    v_mul_lo_u32 v14, v3, s41
    v_and_b32 v3, 15, v1
    v_lshl_add_u32 v14, v3, 4, v14
    buffer_load_dwordx4 v[24:27], v14, s[8:11], 0 offen offset:0
    buffer_load_dwordx4 v[28:31], v14, s[8:11], 0 offen offset:256
    buffer_load_dwordx4 v[32:35], v14, s[8:11], 0 offen offset:512
    buffer_load_dwordx4 v[36:39], v14, s[8:11], 0 offen offset:768
    buffer_load_dwordx4 v[40:43], v14, s[8:11], 0 offen offset:1024
    s_branch k0_xrd_D
k0_xr_D:
    v_mov_b32 v14, 0x40000000
    buffer_load_dword v24, v14, s[8:11], 0 offen
    buffer_load_dword v25, v14, s[8:11], 0 offen
    buffer_load_dword v26, v14, s[8:11], 0 offen
    buffer_load_dword v27, v14, s[8:11], 0 offen
    buffer_load_dword v28, v14, s[8:11], 0 offen
k0_xrd_D:
    s_branch k0_dma_x1
k0_dma_done:
    s_barrier
k0_dma_x1:
    s_waitcnt vmcnt(5)
    s_barrier
    s_cmp_lt_u32 s32, 2
    s_cbranch_scc0 k0_xdone
    s_waitcnt vmcnt(0)
    v_lshlrev_b32 v44, 16, v24
    v_and_b32 v45, 0xffff0000, v24
    v_lshlrev_b32 v46, 16, v25
    v_and_b32 v47, 0xffff0000, v25
    v_lshlrev_b32 v48, 16, v26
    v_and_b32 v49, 0xffff0000, v26
    v_lshlrev_b32 v50, 16, v27
    v_and_b32 v51, 0xffff0000, v27
    v_lshlrev_b32 v52, 16, v28
    v_and_b32 v53, 0xffff0000, v28
    v_lshlrev_b32 v54, 16, v29
    v_and_b32 v55, 0xffff0000, v29
    v_lshlrev_b32 v56, 16, v30
    v_and_b32 v57, 0xffff0000, v30
    v_lshlrev_b32 v58, 16, v31
    v_and_b32 v59, 0xffff0000, v31
    v_lshlrev_b32 v60, 16, v32
    v_and_b32 v61, 0xffff0000, v32
    v_lshlrev_b32 v62, 16, v33
    v_and_b32 v63, 0xffff0000, v33
    v_lshlrev_b32 v64, 16, v34
    v_and_b32 v65, 0xffff0000, v34
    v_lshlrev_b32 v66, 16, v35
    v_and_b32 v67, 0xffff0000, v35
    v_lshlrev_b32 v68, 16, v36
    v_and_b32 v69, 0xffff0000, v36
    v_lshlrev_b32 v70, 16, v37
    v_and_b32 v71, 0xffff0000, v37
    v_lshlrev_b32 v72, 16, v38
    v_and_b32 v73, 0xffff0000, v38
    v_lshlrev_b32 v74, 16, v39
    v_and_b32 v75, 0xffff0000, v39
    v_lshlrev_b32 v76, 16, v40
    v_and_b32 v77, 0xffff0000, v40
    v_lshlrev_b32 v78, 16, v41
    v_and_b32 v79, 0xffff0000, v41
    v_lshlrev_b32 v80, 16, v42
    v_and_b32 v81, 0xffff0000, v42
    v_lshlrev_b32 v82, 16, v43
    v_and_b32 v83, 0xffff0000, v43
    v_pk_add_f32 v[84:85], v[44:45], v[46:47]
    v_pk_add_f32 v[86:87], v[48:49], v[50:51]
    v_pk_add_f32 v[84:85], v[84:85], v[52:53]
    v_pk_add_f32 v[86:87], v[86:87], v[54:55]
    v_pk_add_f32 v[84:85], v[84:85], v[56:57]
    v_pk_add_f32 v[86:87], v[86:87], v[58:59]
    v_pk_add_f32 v[84:85], v[84:85], v[60:61]
    v_pk_add_f32 v[86:87], v[86:87], v[62:63]
    v_pk_add_f32 v[84:85], v[84:85], v[64:65]
    v_pk_add_f32 v[86:87], v[86:87], v[66:67]
    v_pk_add_f32 v[84:85], v[84:85], v[68:69]
    v_pk_add_f32 v[86:87], v[86:87], v[70:71]
    v_pk_add_f32 v[84:85], v[84:85], v[72:73]
    v_pk_add_f32 v[86:87], v[86:87], v[74:75]
    v_pk_add_f32 v[84:85], v[84:85], v[76:77]
    v_pk_add_f32 v[86:87], v[86:87], v[78:79]
    v_pk_add_f32 v[84:85], v[84:85], v[80:81]
    v_pk_add_f32 v[86:87], v[86:87], v[82:83]
    v_pk_add_f32 v[84:85], v[84:85], v[86:87]
    v_add_f32 v84, v84, v85
    s_nop 1
    v_add_f32_dpp v84, v84, v84 row_ror:8 row_mask:0xf bank_mask:0xf
    s_nop 1
    v_add_f32_dpp v84, v84, v84 row_ror:4 row_mask:0xf bank_mask:0xf
    s_nop 1
    v_add_f32_dpp v84, v84, v84 row_ror:2 row_mask:0xf bank_mask:0xf
    s_nop 1
    v_add_f32_dpp v84, v84, v84 row_ror:1 row_mask:0xf bank_mask:0xf
    v_mul_f32 v84, 0xbacccccd, v84
    v_pk_add_f32 v[44:45], v[44:45], v[84:85] op_sel_hi:[1,0]
    v_pk_add_f32 v[46:47], v[46:47], v[84:85] op_sel_hi:[1,0]
    v_pk_add_f32 v[48:49], v[48:49], v[84:85] op_sel_hi:[1,0]
    v_pk_add_f32 v[50:51], v[50:51], v[84:85] op_sel_hi:[1,0]
    v_pk_add_f32 v[52:53], v[52:53], v[84:85] op_sel_hi:[1,0]
    v_pk_add_f32 v[54:55], v[54:55], v[84:85] op_sel_hi:[1,0]
    v_pk_add_f32 v[56:57], v[56:57], v[84:85] op_sel_hi:[1,0]
    v_pk_add_f32 v[58:59], v[58:59], v[84:85] op_sel_hi:[1,0]
    v_pk_add_f32 v[60:61], v[60:61], v[84:85] op_sel_hi:[1,0]
    v_pk_add_f32 v[62:63], v[62:63], v[84:85] op_sel_hi:[1,0]
    v_pk_add_f32 v[64:65], v[64:65], v[84:85] op_sel_hi:[1,0]
    v_pk_add_f32 v[66:67], v[66:67], v[84:85] op_sel_hi:[1,0]
    v_pk_add_f32 v[68:69], v[68:69], v[84:85] op_sel_hi:[1,0]
    v_pk_add_f32 v[70:71], v[70:71], v[84:85] op_sel_hi:[1,0]
    v_pk_add_f32 v[72:73], v[72:73], v[84:85] op_sel_hi:[1,0]
    v_pk_add_f32 v[74:75], v[74:75], v[84:85] op_sel_hi:[1,0]
    v_pk_add_f32 v[76:77], v[76:77], v[84:85] op_sel_hi:[1,0]
    v_pk_add_f32 v[78:79], v[78:79], v[84:85] op_sel_hi:[1,0]
    v_pk_add_f32 v[80:81], v[80:81], v[84:85] op_sel_hi:[1,0]
    v_pk_add_f32 v[82:83], v[82:83], v[84:85] op_sel_hi:[1,0]
    v_pk_mul_f32 v[86:87], v[44:45], v[44:45]
    v_pk_mul_f32 v[88:89], v[46:47], v[46:47]
    v_pk_fma_f32 v[86:87], v[48:49], v[48:49], v[86:87]
    v_pk_fma_f32 v[88:89], v[50:51], v[50:51], v[88:89]
    v_pk_fma_f32 v[86:87], v[52:53], v[52:53], v[86:87]
    v_pk_fma_f32 v[88:89], v[54:55], v[54:55], v[88:89]
    v_pk_fma_f32 v[86:87], v[56:57], v[56:57], v[86:87]
    v_pk_fma_f32 v[88:89], v[58:59], v[58:59], v[88:89]
    v_pk_fma_f32 v[86:87], v[60:61], v[60:61], v[86:87]
    v_pk_fma_f32 v[88:89], v[62:63], v[62:63], v[88:89]
    v_pk_fma_f32 v[86:87], v[64:65], v[64:65], v[86:87]
    v_pk_fma_f32 v[88:89], v[66:67], v[66:67], v[88:89]
    v_pk_fma_f32 v[86:87], v[68:69], v[68:69], v[86:87]
    v_pk_fma_f32 v[88:89], v[70:71], v[70:71], v[88:89]
    v_pk_fma_f32 v[86:87], v[72:73], v[72:73], v[86:87]
    v_pk_fma_f32 v[88:89], v[74:75], v[74:75], v[88:89]
    v_pk_fma_f32 v[86:87], v[76:77], v[76:77], v[86:87]
    v_pk_fma_f32 v[88:89], v[78:79], v[78:79], v[88:89]
    v_pk_fma_f32 v[86:87], v[80:81], v[80:81], v[86:87]
    v_pk_fma_f32 v[88:89], v[82:83], v[82:83], v[88:89]
    v_pk_add_f32 v[86:87], v[86:87], v[88:89]
    v_add_f32 v86, v86, v87
    s_nop 1
    v_add_f32_dpp v86, v86, v86 row_ror:8 row_mask:0xf bank_mask:0xf
    s_nop 1
    v_add_f32_dpp v86, v86, v86 row_ror:4 row_mask:0xf bank_mask:0xf
    s_nop 1
    v_add_f32_dpp v86, v86, v86 row_ror:2 row_mask:0xf bank_mask:0xf
    s_nop 1
    v_add_f32_dpp v86, v86, v86 row_ror:1 row_mask:0xf bank_mask:0xf
    v_mov_b32 v87, 0x3727c5ac
    v_fmac_f32 v87, 0x3acccccd, v86
    v_rsq_f32 v86, v87
    s_nop 0
    v_pk_mul_f32 v[44:45], v[44:45], v[86:87] op_sel_hi:[1,0]
    v_pk_mul_f32 v[46:47], v[46:47], v[86:87] op_sel_hi:[1,0]
    v_pk_mul_f32 v[48:49], v[48:49], v[86:87] op_sel_hi:[1,0]
    v_pk_mul_f32 v[50:51], v[50:51], v[86:87] op_sel_hi:[1,0]
    v_pk_mul_f32 v[52:53], v[52:53], v[86:87] op_sel_hi:[1,0]
    v_pk_mul_f32 v[54:55], v[54:55], v[86:87] op_sel_hi:[1,0]
    v_pk_mul_f32 v[56:57], v[56:57], v[86:87] op_sel_hi:[1,0]
    v_pk_mul_f32 v[58:59], v[58:59], v[86:87] op_sel_hi:[1,0]
    v_pk_mul_f32 v[60:61], v[60:61], v[86:87] op_sel_hi:[1,0]
    v_pk_mul_f32 v[62:63], v[62:63], v[86:87] op_sel_hi:[1,0]
    v_pk_mul_f32 v[64:65], v[64:65], v[86:87] op_sel_hi:[1,0]
    v_pk_mul_f32 v[66:67], v[66:67], v[86:87] op_sel_hi:[1,0]
    v_pk_mul_f32 v[68:69], v[68:69], v[86:87] op_sel_hi:[1,0]
    v_pk_mul_f32 v[70:71], v[70:71], v[86:87] op_sel_hi:[1,0]
    v_pk_mul_f32 v[72:73], v[72:73], v[86:87] op_sel_hi:[1,0]
    v_pk_mul_f32 v[74:75], v[74:75], v[86:87] op_sel_hi:[1,0]
    v_pk_mul_f32 v[76:77], v[76:77], v[86:87] op_sel_hi:[1,0]
    v_pk_mul_f32 v[78:79], v[78:79], v[86:87] op_sel_hi:[1,0]
    v_pk_mul_f32 v[80:81], v[80:81], v[86:87] op_sel_hi:[1,0]
    v_pk_mul_f32 v[82:83], v[82:83], v[86:87] op_sel_hi:[1,0]
    v_cvt_pk_bf16_f32 v92, v44, v45
    v_cvt_pk_bf16_f32 v93, v46, v47
    v_cvt_pk_bf16_f32 v94, v48, v49
    v_cvt_pk_bf16_f32 v95, v50, v51
    v_cvt_pk_bf16_f32 v96, v52, v53
    v_cvt_pk_bf16_f32 v97, v54, v55
    v_cvt_pk_bf16_f32 v98, v56, v57
    v_cvt_pk_bf16_f32 v99, v58, v59
    v_cvt_pk_bf16_f32 v100, v60, v61
    v_cvt_pk_bf16_f32 v101, v62, v63
    v_cvt_pk_bf16_f32 v102, v64, v65
    v_cvt_pk_bf16_f32 v103, v66, v67
    v_cvt_pk_bf16_f32 v104, v68, v69
    v_cvt_pk_bf16_f32 v105, v70, v71
    v_cvt_pk_bf16_f32 v106, v72, v73
    v_cvt_pk_bf16_f32 v107, v74, v75
    v_cvt_pk_bf16_f32 v108, v76, v77
    v_cvt_pk_bf16_f32 v109, v78, v79
    v_cvt_pk_bf16_f32 v110, v80, v81
    v_cvt_pk_bf16_f32 v111, v82, v83
    v_and_b32 v3, 15, v1
    v_lshrrev_b32 v4, 2, v3
    s_mov_b32 s40, 132096
    v_mul_lo_u32 v14, v4, s40
    v_and_b32 v3, 3, v3
    v_lshl_add_u32 v14, v3, 8, v14
    v_lshrrev_b32 v3, 4, v1
    v_lshl_add_u32 v14, v3, 4, v14
    s_lshr_b32 s40, s2, 1
    s_add_u32 s40, s40, 1
    s_lshl_b32 s40, s40, 10
    s_and_b32 s41, s2, 1
    s_lshl_b32 s41, s41, 7
    s_add_u32 s40, s40, s41
    s_lshl_b32 s41, s32, 6
    s_add_u32 s40, s40, s41
    buffer_store_dwordx4 v[92:95], v14, s[28:31], s40 offen sc1
    s_add_u32 s40, s40, 528384
    buffer_store_dwordx4 v[96:99], v14, s[28:31], s40 offen sc1
    s_add_u32 s40, s40, 528384
    buffer_store_dwordx4 v[100:103], v14, s[28:31], s40 offen sc1
    s_add_u32 s40, s40, 528384
    buffer_store_dwordx4 v[104:107], v14, s[28:31], s40 offen sc1
    s_add_u32 s40, s40, 528384
    buffer_store_dwordx4 v[108:111], v14, s[28:31], s40 offen sc1
k0_xdone:
    s_cmp_eq_u32 s32, 3
    s_cbranch_scc0 k0_ftag_done
    v_mov_b32 v3, 0
    s_mov_b32 s40, 26632192
    buffer_load_dword v4, v3, s[28:31], s40 offen sc1
    s_waitcnt vmcnt(0)
    v_add_u32 v4, 2, v4
    v_or_b32 v4, 1, v4
    v_mov_b32 v3, 1800
    ds_write_b32 v3, v4
    s_waitcnt lgkmcnt(0)
k0_ftag_done:
    v_mov_b32 v24, 0
    v_mov_b32 v25, 0
    v_mov_b32 v26, 0
    v_mov_b32 v27, 0
    s_lshl_b32 s42, s2, 2
    s_add_u32 s42, s42, s32
    s_mul_i32 s40, s42, 2560
    s_add_u32 s40, s40, 12197888
    buffer_store_dwordx4 v[24:27], v2, s[28:31], s40 offen sc1
    buffer_store_dwordx4 v[24:27], v2, s[28:31], s40 offen offset:1024 sc1
    s_mov_b32 exec_hi, 0
    buffer_store_dwordx4 v[24:27], v2, s[28:31], s40 offen offset:2048 sc1
    s_mov_b64 exec, -1
    s_mul_i32 s40, s42, 2560
    s_add_u32 s40, s40, 17440768
    buffer_store_dwordx4 v[24:27], v2, s[28:31], s40 offen sc1
    buffer_store_dwordx4 v[24:27], v2, s[28:31], s40 offen offset:1024 sc1
    s_mov_b32 exec_hi, 0
    buffer_store_dwordx4 v[24:27], v2, s[28:31], s40 offen offset:2048 sc1
    s_mov_b64 exec, -1
    s_lshl_b32 s40, s42, 7
    s_add_u32 s40, s40, 20062208
    s_mov_b64 exec, 0xff
    buffer_store_dwordx4 v[24:27], v2, s[28:31], s40 offen sc1
    s_mov_b64 exec, -1
    s_cmp_eq_u32 s2, 0
    s_cbranch_scc0 k0_l1
    s_cmp_ge_u32 s32, 2
    s_cbranch_scc0 k0_l1
    v_mov_b32 v56, 0
    v_mov_b32 v57, 0
    v_mov_b32 v58, 0
    v_mov_b32 v59, 0
    s_sub_u32 s40, s32, 2
    s_mul_i32 s40, s40, 1320960
    buffer_store_dwordx4 v[56:59], v2, s[28:31], s40 offen sc1
    s_add_u32 s40, s40, 132096
    buffer_store_dwordx4 v[56:59], v2, s[28:31], s40 offen sc1
    s_add_u32 s40, s40, 132096
    buffer_store_dwordx4 v[56:59], v2, s[28:31], s40 offen sc1
    s_add_u32 s40, s40, 132096
    buffer_store_dwordx4 v[56:59], v2, s[28:31], s40 offen sc1
    s_add_u32 s40, s40, 132096
    buffer_store_dwordx4 v[56:59], v2, s[28:31], s40 offen sc1
    s_add_u32 s40, s40, 132096
    buffer_store_dwordx4 v[56:59], v2, s[28:31], s40 offen sc1
    s_add_u32 s40, s40, 132096
    buffer_store_dwordx4 v[56:59], v2, s[28:31], s40 offen sc1
    s_add_u32 s40, s40, 132096
    buffer_store_dwordx4 v[56:59], v2, s[28:31], s40 offen sc1
    s_add_u32 s40, s40, 132096
    buffer_store_dwordx4 v[56:59], v2, s[28:31], s40 offen sc1
    s_add_u32 s40, s40, 132096
    buffer_store_dwordx4 v[56:59], v2, s[28:31], s40 offen sc1
k0_l1:
    s_branch k0_done
k0_compute:
    s_waitcnt lgkmcnt(0)
    s_mov_b32 s8, s48
    s_mov_b32 s9, s49
    s_mov_b32 s12, s50
    s_mov_b32 s13, s51
    s_mov_b32 s20, s52
    s_mov_b32 s21, s53
    s_mov_b32 s24, s54
    s_mov_b32 s25, s55
    s_cmp_lt_u32 s32, 2
    s_cbranch_scc0 k0_early_silu
    v_lshrrev_b32 v3, 4, v1
    v_bfe_u32 v4, v1, 2, 2
    v_lshl_add_u32 v3, v3, 3, v4
    v_bfe_u32 v4, v1, 1, 1
    s_lshl_b32 s40, s32, 1
    v_add_u32 v4, s40, v4
    v_bfe_u32 v10, v3, 2, 1
    v_bfe_u32 v5, v3, 3, 1
    v_xor_b32 v10, v10, v5
    v_bfe_u32 v5, v3, 1, 1
    v_lshl_or_b32 v10, v10, 1, v5
    v_lshlrev_b32 v10, 1, v10
    v_xor_b32 v4, v4, v10
    v_lshlrev_b32 v4, 4, v4
    v_and_b32 v10, 1, v1
    v_lshl_add_u32 v4, v10, 3, v4
    v_lshl_add_u32 v10, v3, 7, v4
    v_lshrrev_b32 v3, 4, v1
    v_bfe_u32 v4, v1, 2, 2
    v_lshl_add_u32 v3, v3, 3, v4
    v_add_u32 v3, 4, v3
    v_bfe_u32 v4, v1, 1, 1
    s_lshl_b32 s40, s32, 1
    v_add_u32 v4, s40, v4
    v_bfe_u32 v11, v3, 2, 1
    v_bfe_u32 v5, v3, 3, 1
    v_xor_b32 v11, v11, v5
    v_bfe_u32 v5, v3, 1, 1
    v_lshl_or_b32 v11, v11, 1, v5
    v_lshlrev_b32 v11, 1, v11
    v_xor_b32 v4, v4, v11
    v_lshlrev_b32 v4, 4, v4
    v_and_b32 v11, 1, v1
    v_lshl_add_u32 v4, v11, 3, v4
    v_lshl_add_u32 v11, v3, 7, v4
    v_add_u32 v10, 67584, v10
    v_add_u32 v11, 67584, v11
    v_add_u32 v12, 0x10000, v10
    v_add_u32 v13, 0x10000, v11
    v_lshrrev_b32 v9, 4, v1
    v_lshlrev_b32 v9, 4, v9
    v_lshrrev_b32 v3, 4, v1
    v_bfe_u32 v4, v1, 2, 2
    v_lshl_add_u32 v5, v3, 3, v4
    v_lshlrev_b32 v20, 8, v5
    v_and_b32 v3, 1, v3
    v_lshl_or_b32 v3, v3, 2, v4
    v_lshl_or_b32 v20, v3, 5, v20
    v_and_b32 v3, 3, v1
    v_lshl_or_b32 v20, v3, 3, v20
    v_lshrrev_b32 v3, 4, v1
    v_bfe_u32 v4, v1, 2, 2
    v_lshl_add_u32 v5, v3, 3, v4
    v_add_u32 v5, 4, v5
    v_lshlrev_b32 v21, 8, v5
    v_and_b32 v3, 1, v3
    v_lshl_or_b32 v3, v3, 2, v4
    v_lshl_or_b32 v21, v3, 5, v21
    v_and_b32 v3, 3, v1
    v_lshl_or_b32 v21, v3, 3, v21
    s_lshl_b32 s40, s32, 6
    s_add_u32 s41, s40, 32
    v_xor_b32 v112, s40, v20
    v_xor_b32 v113, s40, v21
    v_xor_b32 v114, s41, v20
    v_xor_b32 v115, s41, v21
    s_lshl_b32 s40, s32, 8
    v_lshrrev_b32 v3, 8, v20
    v_and_b32 v4, 0xff, v20
    v_lshl_add_u32 v3, v3, 10, v4
    v_xor_b32 v116, 0, v3
    v_add_u32 v116, s40, v116
    v_xor_b32 v118, 32, v3
    v_add_u32 v118, s40, v118
    v_xor_b32 v120, 64, v3
    v_add_u32 v120, s40, v120
    v_xor_b32 v122, 96, v3
    v_add_u32 v122, s40, v122
    v_xor_b32 v124, 128, v3
    v_add_u32 v124, s40, v124
    v_xor_b32 v126, 160, v3
    v_add_u32 v126, s40, v126
    v_xor_b32 v128, 192, v3
    v_add_u32 v128, s40, v128
    v_xor_b32 v130, 224, v3
    v_add_u32 v130, s40, v130
    v_lshrrev_b32 v3, 8, v21
    v_and_b32 v4, 0xff, v21
    v_lshl_add_u32 v3, v3, 10, v4
    v_xor_b32 v117, 0, v3
    v_add_u32 v117, s40, v117
    v_xor_b32 v119, 32, v3
    v_add_u32 v119, s40, v119
    v_xor_b32 v121, 64, v3
    v_add_u32 v121, s40, v121
    v_xor_b32 v123, 96, v3
    v_add_u32 v123, s40, v123
    v_xor_b32 v125, 128, v3
    v_add_u32 v125, s40, v125
    v_xor_b32 v127, 160, v3
    v_add_u32 v127, s40, v127
    v_xor_b32 v129, 192, v3
    v_add_u32 v129, s40, v129
    v_xor_b32 v131, 224, v3
    v_add_u32 v131, s40, v131
    s_branch k0_job_done
k0_early_silu:
    v_subrev_u32 v3, 128, v0
    v_lshlrev_b32 v14, 2, v3
    buffer_load_dword v24, v14, s[20:23], 0 offen offset:0
    buffer_load_dword v25, v14, s[20:23], 0 offen offset:512
    buffer_load_dword v26, v14, s[20:23], 0 offen offset:1024
    v_lshrrev_b32 v3, 4, v1
    v_bfe_u32 v4, v1, 2, 2
    v_lshl_add_u32 v3, v3, 3, v4
    v_bfe_u32 v4, v1, 1, 1
    s_lshl_b32 s40, s32, 1
    v_add_u32 v4, s40, v4
    v_bfe_u32 v10, v3, 2, 1
    v_bfe_u32 v5, v3, 3, 1
    v_xor_b32 v10, v10, v5
    v_bfe_u32 v5, v3, 1, 1
    v_lshl_or_b32 v10, v10, 1, v5
    v_lshlrev_b32 v10, 1, v10
    v_xor_b32 v4, v4, v10
    v_lshlrev_b32 v4, 4, v4
    v_and_b32 v10, 1, v1
    v_lshl_add_u32 v4, v10, 3, v4
    v_lshl_add_u32 v10, v3, 7, v4
    v_lshrrev_b32 v3, 4, v1
    v_bfe_u32 v4, v1, 2, 2
    v_lshl_add_u32 v3, v3, 3, v4
    v_add_u32 v3, 4, v3
    v_bfe_u32 v4, v1, 1, 1
    s_lshl_b32 s40, s32, 1
    v_add_u32 v4, s40, v4
    v_bfe_u32 v11, v3, 2, 1
    v_bfe_u32 v5, v3, 3, 1
    v_xor_b32 v11, v11, v5
    v_bfe_u32 v5, v3, 1, 1
    v_lshl_or_b32 v11, v11, 1, v5
    v_lshlrev_b32 v11, 1, v11
    v_xor_b32 v4, v4, v11
    v_lshlrev_b32 v4, 4, v4
    v_and_b32 v11, 1, v1
    v_lshl_add_u32 v4, v11, 3, v4
    v_lshl_add_u32 v11, v3, 7, v4
    v_add_u32 v10, 67584, v10
    v_add_u32 v11, 67584, v11
    v_add_u32 v12, 0x10000, v10
    v_add_u32 v13, 0x10000, v11
    v_lshrrev_b32 v9, 4, v1
    v_lshlrev_b32 v9, 4, v9
    v_lshrrev_b32 v3, 4, v1
    v_bfe_u32 v4, v1, 2, 2
    v_lshl_add_u32 v5, v3, 3, v4
    v_lshlrev_b32 v20, 8, v5
    v_and_b32 v3, 1, v3
    v_lshl_or_b32 v3, v3, 2, v4
    v_lshl_or_b32 v20, v3, 5, v20
    v_and_b32 v3, 3, v1
    v_lshl_or_b32 v20, v3, 3, v20
    v_lshrrev_b32 v3, 4, v1
    v_bfe_u32 v4, v1, 2, 2
    v_lshl_add_u32 v5, v3, 3, v4
    v_add_u32 v5, 4, v5
    v_lshlrev_b32 v21, 8, v5
    v_and_b32 v3, 1, v3
    v_lshl_or_b32 v3, v3, 2, v4
    v_lshl_or_b32 v21, v3, 5, v21
    v_and_b32 v3, 3, v1
    v_lshl_or_b32 v21, v3, 3, v21
    s_lshl_b32 s40, s32, 6
    s_add_u32 s41, s40, 32
    v_xor_b32 v112, s40, v20
    v_xor_b32 v113, s40, v21
    v_xor_b32 v114, s41, v20
    v_xor_b32 v115, s41, v21
    s_lshl_b32 s40, s32, 8
    v_lshrrev_b32 v3, 8, v20
    v_and_b32 v4, 0xff, v20
    v_lshl_add_u32 v3, v3, 10, v4
    v_xor_b32 v116, 0, v3
    v_add_u32 v116, s40, v116
    v_xor_b32 v118, 32, v3
    v_add_u32 v118, s40, v118
    v_xor_b32 v120, 64, v3
    v_add_u32 v120, s40, v120
    v_xor_b32 v122, 96, v3
    v_add_u32 v122, s40, v122
    v_xor_b32 v124, 128, v3
    v_add_u32 v124, s40, v124
    v_xor_b32 v126, 160, v3
    v_add_u32 v126, s40, v126
    v_xor_b32 v128, 192, v3
    v_add_u32 v128, s40, v128
    v_xor_b32 v130, 224, v3
    v_add_u32 v130, s40, v130
    v_lshrrev_b32 v3, 8, v21
    v_and_b32 v4, 0xff, v21
    v_lshl_add_u32 v3, v3, 10, v4
    v_xor_b32 v117, 0, v3
    v_add_u32 v117, s40, v117
    v_xor_b32 v119, 32, v3
    v_add_u32 v119, s40, v119
    v_xor_b32 v121, 64, v3
    v_add_u32 v121, s40, v121
    v_xor_b32 v123, 96, v3
    v_add_u32 v123, s40, v123
    v_xor_b32 v125, 128, v3
    v_add_u32 v125, s40, v125
    v_xor_b32 v127, 160, v3
    v_add_u32 v127, s40, v127
    v_xor_b32 v129, 192, v3
    v_add_u32 v129, s40, v129
    v_xor_b32 v131, 224, v3
    v_add_u32 v131, s40, v131
    s_waitcnt vmcnt(0)
    s_mov_b32 s40, 0xbfb8aa3b
    v_lshlrev_b32 v28, 16, v24
    v_and_b32 v29, 0xffff0000, v24
    v_lshlrev_b32 v30, 16, v25
    v_and_b32 v31, 0xffff0000, v25
    v_lshlrev_b32 v32, 16, v26
    v_and_b32 v33, 0xffff0000, v26
    v_mul_f32 v36, s40, v28
    v_mul_f32 v37, s40, v29
    v_mul_f32 v38, s40, v30
    v_mul_f32 v39, s40, v31
    v_mul_f32 v40, s40, v32
    v_mul_f32 v41, s40, v33
    v_exp_f32 v36, v36
    v_exp_f32 v37, v37
    v_exp_f32 v38, v38
    v_exp_f32 v39, v39
    v_exp_f32 v40, v40
    v_exp_f32 v41, v41
    v_add_f32 v36, 1.0, v36
    v_add_f32 v37, 1.0, v37
    v_add_f32 v38, 1.0, v38
    v_add_f32 v39, 1.0, v39
    v_add_f32 v40, 1.0, v40
    v_add_f32 v41, 1.0, v41
    v_rcp_f32 v36, v36
    v_rcp_f32 v37, v37
    v_rcp_f32 v38, v38
    v_rcp_f32 v39, v39
    v_rcp_f32 v40, v40
    v_rcp_f32 v41, v41
    v_mul_f32 v36, v28, v36
    v_mul_f32 v37, v29, v37
    v_mul_f32 v38, v30, v38
    v_mul_f32 v39, v31, v39
    v_mul_f32 v40, v32, v40
    v_mul_f32 v41, v33, v41
    v_cvt_pk_bf16_f32 v24, v36, v37
    v_cvt_pk_bf16_f32 v25, v38, v39
    v_cvt_pk_bf16_f32 v26, v40, v41
    ds_write_b32 v14, v24 offset:0
    ds_write_b32 v14, v25 offset:512
    ds_write_b32 v14, v26 offset:1024
    s_waitcnt lgkmcnt(0)
k0_job_done:
    s_nop 7
    s_nop 3
    s_barrier
k0_after_x1:
    s_nop 7
    s_nop 3
    s_cmp_eq_u32 s35, 3
    s_cbranch_scc1 k0_tail_none
    ds_read_b64_tr_b16 v[24:25], v10 offset:0
    ds_read_b64_tr_b16 v[26:27], v11 offset:0
    ds_read_b128 v[28:31], v9 offset:0
    ds_read_b64_tr_b16 v[32:33], v10 offset:4096
    ds_read_b64_tr_b16 v[34:35], v11 offset:4096
    ds_read_b128 v[36:39], v9 offset:64
    ds_read_b64_tr_b16 v[40:41], v10 offset:8192
    ds_read_b64_tr_b16 v[42:43], v11 offset:8192
    ds_read_b128 v[44:47], v9 offset:128
    ds_read_b64_tr_b16 v[48:49], v10 offset:12288
    ds_read_b64_tr_b16 v[50:51], v11 offset:12288
    ds_read_b128 v[52:55], v9 offset:192
    s_waitcnt lgkmcnt(9)
    v_mfma_f32_16x16x32_bf16 v[16:19], v[24:27], v[28:31], 0
    ds_read_b64_tr_b16 v[24:25], v10 offset:16384
    ds_read_b64_tr_b16 v[26:27], v11 offset:16384
    ds_read_b128 v[28:31], v9 offset:256
    s_waitcnt lgkmcnt(9)
    v_mfma_f32_16x16x32_bf16 v[16:19], v[32:35], v[36:39], v[16:19]
    ds_read_b64_tr_b16 v[32:33], v10 offset:20480
    ds_read_b64_tr_b16 v[34:35], v11 offset:20480
    ds_read_b128 v[36:39], v9 offset:320
    s_waitcnt lgkmcnt(9)
    v_mfma_f32_16x16x32_bf16 v[16:19], v[40:43], v[44:47], v[16:19]
    ds_read_b64_tr_b16 v[40:41], v10 offset:24576
    ds_read_b64_tr_b16 v[42:43], v11 offset:24576
    ds_read_b128 v[44:47], v9 offset:384
    s_waitcnt lgkmcnt(9)
    v_mfma_f32_16x16x32_bf16 v[16:19], v[48:51], v[52:55], v[16:19]
    ds_read_b64_tr_b16 v[48:49], v10 offset:28672
    ds_read_b64_tr_b16 v[50:51], v11 offset:28672
    ds_read_b128 v[52:55], v9 offset:448
    s_waitcnt lgkmcnt(9)
    v_mfma_f32_16x16x32_bf16 v[16:19], v[24:27], v[28:31], v[16:19]
    ds_read_b64_tr_b16 v[24:25], v10 offset:32768
    ds_read_b64_tr_b16 v[26:27], v11 offset:32768
    ds_read_b128 v[28:31], v9 offset:512
    s_waitcnt lgkmcnt(9)
    v_mfma_f32_16x16x32_bf16 v[16:19], v[32:35], v[36:39], v[16:19]
    ds_read_b64_tr_b16 v[32:33], v10 offset:36864
    ds_read_b64_tr_b16 v[34:35], v11 offset:36864
    ds_read_b128 v[36:39], v9 offset:576
    s_waitcnt lgkmcnt(9)
    v_mfma_f32_16x16x32_bf16 v[16:19], v[40:43], v[44:47], v[16:19]
    ds_read_b64_tr_b16 v[40:41], v10 offset:40960
    ds_read_b64_tr_b16 v[42:43], v11 offset:40960
    ds_read_b128 v[44:47], v9 offset:640
    s_waitcnt lgkmcnt(9)
    v_mfma_f32_16x16x32_bf16 v[16:19], v[48:51], v[52:55], v[16:19]
    ds_read_b64_tr_b16 v[48:49], v10 offset:45056
    ds_read_b64_tr_b16 v[50:51], v11 offset:45056
    ds_read_b128 v[52:55], v9 offset:704
    s_waitcnt lgkmcnt(9)
    v_mfma_f32_16x16x32_bf16 v[16:19], v[24:27], v[28:31], v[16:19]
    ds_read_b64_tr_b16 v[24:25], v10 offset:49152
    ds_read_b64_tr_b16 v[26:27], v11 offset:49152
    ds_read_b128 v[28:31], v9 offset:768
    s_waitcnt lgkmcnt(9)
    v_mfma_f32_16x16x32_bf16 v[16:19], v[32:35], v[36:39], v[16:19]
    ds_read_b64_tr_b16 v[32:33], v10 offset:53248
    ds_read_b64_tr_b16 v[34:35], v11 offset:53248
    ds_read_b128 v[36:39], v9 offset:832
    s_waitcnt lgkmcnt(9)
    v_mfma_f32_16x16x32_bf16 v[16:19], v[40:43], v[44:47], v[16:19]
    ds_read_b64_tr_b16 v[40:41], v10 offset:57344
    ds_read_b64_tr_b16 v[42:43], v11 offset:57344
    ds_read_b128 v[44:47], v9 offset:896
    s_waitcnt lgkmcnt(9)
    v_mfma_f32_16x16x32_bf16 v[16:19], v[48:51], v[52:55], v[16:19]
    ds_read_b64_tr_b16 v[48:49], v10 offset:61440
    ds_read_b64_tr_b16 v[50:51], v11 offset:61440
    ds_read_b128 v[52:55], v9 offset:960
    s_waitcnt lgkmcnt(9)
    v_mfma_f32_16x16x32_bf16 v[16:19], v[24:27], v[28:31], v[16:19]
    ds_read_b64_tr_b16 v[24:25], v12 offset:0
    ds_read_b64_tr_b16 v[26:27], v13 offset:0
    ds_read_b128 v[28:31], v9 offset:1024
    s_waitcnt lgkmcnt(9)
    v_mfma_f32_16x16x32_bf16 v[16:19], v[32:35], v[36:39], v[16:19]
    ds_read_b64_tr_b16 v[32:33], v12 offset:4096
    ds_read_b64_tr_b16 v[34:35], v13 offset:4096
    ds_read_b128 v[36:39], v9 offset:1088
    s_waitcnt lgkmcnt(9)
    v_mfma_f32_16x16x32_bf16 v[16:19], v[40:43], v[44:47], v[16:19]
    ds_read_b64_tr_b16 v[40:41], v12 offset:8192
    ds_read_b64_tr_b16 v[42:43], v13 offset:8192
    ds_read_b128 v[44:47], v9 offset:1152
    s_waitcnt lgkmcnt(9)
    v_mfma_f32_16x16x32_bf16 v[16:19], v[48:51], v[52:55], v[16:19]
    ds_read_b64_tr_b16 v[48:49], v12 offset:12288
    ds_read_b64_tr_b16 v[50:51], v13 offset:12288
    ds_read_b128 v[52:55], v9 offset:1216
    s_waitcnt lgkmcnt(9)
    v_mfma_f32_16x16x32_bf16 v[16:19], v[24:27], v[28:31], v[16:19]
    s_waitcnt lgkmcnt(6)
    v_mfma_f32_16x16x32_bf16 v[16:19], v[32:35], v[36:39], v[16:19]
    s_waitcnt lgkmcnt(3)
    v_mfma_f32_16x16x32_bf16 v[16:19], v[40:43], v[44:47], v[16:19]
    s_waitcnt lgkmcnt(0)
    v_mfma_f32_16x16x32_bf16 v[16:19], v[48:51], v[52:55], v[16:19]
    s_cmp_eq_u32 s35, 1
    s_cbranch_scc1 k0_tail_D
    s_cmp_eq_u32 s35, 2
    s_cbranch_scc1 k0_tail_B
    s_nop 3
    v_cvt_pk_bf16_f32 v3, v16, v17
    v_lshlrev_b32 v24, 16, v3
    v_and_b32 v25, 0xffff0000, v3
    v_cvt_pk_bf16_f32 v3, v18, v19
    v_lshlrev_b32 v26, 16, v3
    v_and_b32 v27, 0xffff0000, v3
    v_pk_add_f32 v[24:25], v[24:25], 1.0 op_sel_hi:[1,0]
    v_pk_add_f32 v[26:27], v[26:27], 1.0 op_sel_hi:[1,0]
    v_cvt_pk_bf16_f32 v3, v24, v25
    v_lshlrev_b32 v28, 16, v3
    v_and_b32 v29, 0xffff0000, v3
    v_cvt_pk_bf16_f32 v3, v26, v27
    v_lshlrev_b32 v30, 16, v3
    v_and_b32 v31, 0xffff0000, v3
    s_lshl_b32 s40, s32, 6
    v_add_u32 v3, s40, v9
    s_mov_b32 exec_lo, 0x00010001
    s_mov_b32 exec_hi, 0x00010001
    ds_write_b128 v3, v[28:31] offset:1536
    s_mov_b64 exec, -1
    s_waitcnt lgkmcnt(0)
    s_barrier
    ds_read_b64_tr_b16 v[32:33], v112 offset:2048
    ds_read_b64_tr_b16 v[34:35], v113 offset:2048
    ds_read_b64_tr_b16 v[36:37], v114 offset:2048
    ds_read_b64_tr_b16 v[38:39], v115 offset:2048
    ds_read_b64_tr_b16 v[40:41], v112 offset:10240
    ds_read_b64_tr_b16 v[42:43], v113 offset:10240
    ds_read_b64_tr_b16 v[44:45], v114 offset:10240
    ds_read_b64_tr_b16 v[46:47], v115 offset:10240
    v_lshlrev_b32 v3, 1, v9
    ds_read_b128 v[48:51], v3 offset:1536
    ds_read_b128 v[52:55], v3 offset:1552
    ds_read_b128 v[56:59], v3 offset:1664
    ds_read_b128 v[60:63], v3 offset:1680
    s_mul_i32 s40, s38, 20
    s_lshl_b32 s41, s37, 1
    s_add_u32 s40, s40, s41
    s_lshl_b32 s40, s40, 3
    s_lshl_b32 s41, s32, 1
    s_add_u32 s40, s40, s41
    s_lshl_b32 s40, s40, 10
    s_add_u32 s40, s40, 2641920
    s_add_u32 s41, s40, 8192
    s_waitcnt lgkmcnt(0)
    v_lshlrev_b32 v64, 16, v32
    v_and_b32 v65, 0xffff0000, v32
    v_lshlrev_b32 v66, 16, v33
    v_and_b32 v67, 0xffff0000, v33
    v_lshlrev_b32 v68, 16, v34
    v_and_b32 v69, 0xffff0000, v34
    v_lshlrev_b32 v70, 16, v35
    v_and_b32 v71, 0xffff0000, v35
    v_pk_mul_f32 v[64:65], v[64:65], v[48:49]
    v_pk_mul_f32 v[66:67], v[66:67], v[50:51]
    v_pk_mul_f32 v[68:69], v[68:69], v[52:53]
    v_pk_mul_f32 v[70:71], v[70:71], v[54:55]
    v_cvt_pk_bf16_f32 v32, v64, v65
    v_cvt_pk_bf16_f32 v33, v66, v67
    v_cvt_pk_bf16_f32 v34, v68, v69
    v_cvt_pk_bf16_f32 v35, v70, v71
    buffer_store_dwordx4 v[32:35], v2, s[28:31], s40 offen offset:0 sc1
    v_lshlrev_b32 v64, 16, v36
    v_and_b32 v65, 0xffff0000, v36
    v_lshlrev_b32 v66, 16, v37
    v_and_b32 v67, 0xffff0000, v37
    v_lshlrev_b32 v68, 16, v38
    v_and_b32 v69, 0xffff0000, v38
    v_lshlrev_b32 v70, 16, v39
    v_and_b32 v71, 0xffff0000, v39
    v_pk_mul_f32 v[64:65], v[64:65], v[48:49]
    v_pk_mul_f32 v[66:67], v[66:67], v[50:51]
    v_pk_mul_f32 v[68:69], v[68:69], v[52:53]
    v_pk_mul_f32 v[70:71], v[70:71], v[54:55]
    v_cvt_pk_bf16_f32 v36, v64, v65
    v_cvt_pk_bf16_f32 v37, v66, v67
    v_cvt_pk_bf16_f32 v38, v68, v69
    v_cvt_pk_bf16_f32 v39, v70, v71
    buffer_store_dwordx4 v[36:39], v2, s[28:31], s40 offen offset:1024 sc1
    v_lshlrev_b32 v64, 16, v40
    v_and_b32 v65, 0xffff0000, v40
    v_lshlrev_b32 v66, 16, v41
    v_and_b32 v67, 0xffff0000, v41
    v_lshlrev_b32 v68, 16, v42
    v_and_b32 v69, 0xffff0000, v42
    v_lshlrev_b32 v70, 16, v43
    v_and_b32 v71, 0xffff0000, v43
    v_pk_mul_f32 v[64:65], v[64:65], v[56:57]
    v_pk_mul_f32 v[66:67], v[66:67], v[58:59]
    v_pk_mul_f32 v[68:69], v[68:69], v[60:61]
    v_pk_mul_f32 v[70:71], v[70:71], v[62:63]
    v_cvt_pk_bf16_f32 v40, v64, v65
    v_cvt_pk_bf16_f32 v41, v66, v67
    v_cvt_pk_bf16_f32 v42, v68, v69
    v_cvt_pk_bf16_f32 v43, v70, v71
    buffer_store_dwordx4 v[40:43], v2, s[28:31], s41 offen offset:0 sc1
    v_lshlrev_b32 v64, 16, v44
    v_and_b32 v65, 0xffff0000, v44
    v_lshlrev_b32 v66, 16, v45
    v_and_b32 v67, 0xffff0000, v45
    v_lshlrev_b32 v68, 16, v46
    v_and_b32 v69, 0xffff0000, v46
    v_lshlrev_b32 v70, 16, v47
    v_and_b32 v71, 0xffff0000, v47
    v_pk_mul_f32 v[64:65], v[64:65], v[56:57]
    v_pk_mul_f32 v[66:67], v[66:67], v[58:59]
    v_pk_mul_f32 v[68:69], v[68:69], v[60:61]
    v_pk_mul_f32 v[70:71], v[70:71], v[62:63]
    v_cvt_pk_bf16_f32 v44, v64, v65
    v_cvt_pk_bf16_f32 v45, v66, v67
    v_cvt_pk_bf16_f32 v46, v68, v69
    v_cvt_pk_bf16_f32 v47, v70, v71
    buffer_store_dwordx4 v[44:47], v2, s[28:31], s41 offen offset:1024 sc1
    s_branch k0_fin
k0_tail_D:
    s_nop 7
    s_nop 3
    v_cvt_pk_bf16_f32 v24, v16, v17
    v_cvt_pk_bf16_f32 v25, v18, v19
    s_lshl_b32 s40, s32, 5
    v_lshrrev_b32 v3, 1, v9
    v_add_u32 v3, s40, v3
    s_mov_b32 exec_lo, 0x00010001
    s_mov_b32 exec_hi, 0x00010001
    ds_write_b64 v3, v[24:25] offset:1536
    s_mov_b64 exec, -1
    s_waitcnt lgkmcnt(0)
    s_barrier
    ds_read_b128 v[28:31], v9 offset:1536
    ds_read_b128 v[32:35], v9 offset:1600
    s_lshl_b32 s40, s37, 4
    s_lshl_b32 s41, s38, 2
    s_add_u32 s40, s40, s41
    s_add_u32 s40, s40, s32
    s_lshl_b32 s40, s40, 9
    s_add_u32 s40, s40, 5263360
    ds_read_b64_tr_b16 v[40:41], v116 offset:2048
    ds_read_b64_tr_b16 v[42:43], v117 offset:2048
    ds_read_b64_tr_b16 v[44:45], v116 offset:34816
    ds_read_b64_tr_b16 v[46:47], v117 offset:34816
    ds_read_b64_tr_b16 v[48:49], v118 offset:2048
    ds_read_b64_tr_b16 v[50:51], v119 offset:2048
    ds_read_b64_tr_b16 v[52:53], v118 offset:34816
    ds_read_b64_tr_b16 v[54:55], v119 offset:34816
    s_waitcnt lgkmcnt(4)
    v_mfma_f32_16x16x32_bf16 v[72:75], v[40:43], v[28:31], 0
    v_mfma_f32_16x16x32_bf16 v[72:75], v[44:47], v[32:35], v[72:75]
    ds_read_b64_tr_b16 v[40:41], v120 offset:2048
    ds_read_b64_tr_b16 v[42:43], v121 offset:2048
    ds_read_b64_tr_b16 v[44:45], v120 offset:34816
    ds_read_b64_tr_b16 v[46:47], v121 offset:34816
    s_waitcnt lgkmcnt(4)
    v_mfma_f32_16x16x32_bf16 v[76:79], v[48:51], v[28:31], 0
    v_mfma_f32_16x16x32_bf16 v[76:79], v[52:55], v[32:35], v[76:79]
    ds_read_b64_tr_b16 v[48:49], v122 offset:2048
    ds_read_b64_tr_b16 v[50:51], v123 offset:2048
    ds_read_b64_tr_b16 v[52:53], v122 offset:34816
    ds_read_b64_tr_b16 v[54:55], v123 offset:34816
    s_waitcnt lgkmcnt(4)
    v_mfma_f32_16x16x32_bf16 v[80:83], v[40:43], v[28:31], 0
    v_mfma_f32_16x16x32_bf16 v[80:83], v[44:47], v[32:35], v[80:83]
    ds_read_b64_tr_b16 v[40:41], v124 offset:2048
    ds_read_b64_tr_b16 v[42:43], v125 offset:2048
    ds_read_b64_tr_b16 v[44:45], v124 offset:34816
    ds_read_b64_tr_b16 v[46:47], v125 offset:34816
    s_waitcnt lgkmcnt(4)
    v_mfma_f32_16x16x32_bf16 v[84:87], v[48:51], v[28:31], 0
    v_mfma_f32_16x16x32_bf16 v[84:87], v[52:55], v[32:35], v[84:87]
    ds_read_b64_tr_b16 v[48:49], v126 offset:2048
    ds_read_b64_tr_b16 v[50:51], v127 offset:2048
    ds_read_b64_tr_b16 v[52:53], v126 offset:34816
    ds_read_b64_tr_b16 v[54:55], v127 offset:34816
    s_waitcnt lgkmcnt(4)
    v_mfma_f32_16x16x32_bf16 v[88:91], v[40:43], v[28:31], 0
    v_mfma_f32_16x16x32_bf16 v[88:91], v[44:47], v[32:35], v[88:91]
    ds_read_b64_tr_b16 v[40:41], v128 offset:2048
    ds_read_b64_tr_b16 v[42:43], v129 offset:2048
    ds_read_b64_tr_b16 v[44:45], v128 offset:34816
    ds_read_b64_tr_b16 v[46:47], v129 offset:34816
    s_waitcnt lgkmcnt(4)
    v_mfma_f32_16x16x32_bf16 v[92:95], v[48:51], v[28:31], 0
    v_mfma_f32_16x16x32_bf16 v[92:95], v[52:55], v[32:35], v[92:95]
    ds_read_b64_tr_b16 v[48:49], v130 offset:2048
    ds_read_b64_tr_b16 v[50:51], v131 offset:2048
    ds_read_b64_tr_b16 v[52:53], v130 offset:34816
    ds_read_b64_tr_b16 v[54:55], v131 offset:34816
    s_waitcnt lgkmcnt(4)
    v_mfma_f32_16x16x32_bf16 v[96:99], v[40:43], v[28:31], 0
    v_mfma_f32_16x16x32_bf16 v[96:99], v[44:47], v[32:35], v[96:99]
    s_waitcnt lgkmcnt(0)
    v_mfma_f32_16x16x32_bf16 v[100:103], v[48:51], v[28:31], 0
    v_mfma_f32_16x16x32_bf16 v[100:103], v[52:55], v[32:35], v[100:103]
    s_mov_b32 exec_lo, 0x00010001
    s_mov_b32 exec_hi, 0x00010001
    buffer_store_dwordx4 v[72:75], v9, s[28:31], s40 offen offset:0 sc1
    buffer_store_dwordx4 v[76:79], v9, s[28:31], s40 offen offset:64 sc1
    buffer_store_dwordx4 v[80:83], v9, s[28:31], s40 offen offset:128 sc1
    buffer_store_dwordx4 v[84:87], v9, s[28:31], s40 offen offset:192 sc1
    buffer_store_dwordx4 v[88:91], v9, s[28:31], s40 offen offset:256 sc1
    buffer_store_dwordx4 v[92:95], v9, s[28:31], s40 offen offset:320 sc1
    buffer_store_dwordx4 v[96:99], v9, s[28:31], s40 offen offset:384 sc1
    buffer_store_dwordx4 v[100:103], v9, s[28:31], s40 offen offset:448 sc1
    s_mov_b64 exec, -1
    s_branch k0_fin
k0_tail_B:
    s_nop 7
    s_nop 3
    v_cvt_pk_bf16_f32 v3, v16, v17
    v_lshlrev_b32 v24, 16, v3
    v_and_b32 v25, 0xffff0000, v3
    v_cvt_pk_bf16_f32 v3, v18, v19
    v_lshlrev_b32 v26, 16, v3
    v_and_b32 v27, 0xffff0000, v3
    s_cmp_lt_u32 s39, 20
    s_cbranch_scc1 k0_B_store
    s_cmp_ge_u32 s39, 30
    s_cbranch_scc1 k0_B_store
    v_pk_add_f32 v[24:25], v[24:25], 1.0 op_sel_hi:[1,0]
    v_pk_add_f32 v[26:27], v[26:27], 1.0 op_sel_hi:[1,0]
    v_cvt_pk_bf16_f32 v3, v24, v25
    v_lshlrev_b32 v24, 16, v3
    v_and_b32 v25, 0xffff0000, v3
    v_cvt_pk_bf16_f32 v3, v26, v27
    v_lshlrev_b32 v26, 16, v3
    v_and_b32 v27, 0xffff0000, v3
k0_B_store:
    s_nop 7
    s_nop 3
    s_lshl_b32 s40, s39, 8
    s_lshl_b32 s41, s32, 6
    s_add_u32 s40, s40, s41
    s_add_u32 s40, s40, 5345280
    s_mov_b32 exec_lo, 0x00010001
    s_mov_b32 exec_hi, 0x00010001
    buffer_store_dwordx4 v[24:27], v9, s[28:31], s40 offen sc1
    s_mov_b64 exec, -1
k0_tail_none:
    s_nop 7
    s_nop 3
    s_barrier
    v_lshrrev_b32 v9, 4, v1
    v_lshlrev_b32 v9, 4, v9
    s_cmp_lt_u32 s39, 50
    s_cbranch_scc0 k0_fin
    s_mul_i32 s42, s39, 205
    s_lshr_b32 s42, s42, 11
    s_mul_i32 s43, s42, 10
    s_sub_u32 s43, s39, s43
    s_lshl_b32 s43, s43, 2
    s_add_u32 s43, s43, s32
    s_mul_i32 s40, s43, 205
    s_lshr_b32 s40, s40, 10
    s_mul_i32 s41, s40, 5
    s_sub_u32 s41, s43, s41
    s_mul_i32 s40, s40, 20
    s_lshl_b32 s42, s42, 2
    s_add_u32 s40, s40, s42
    s_mul_i32 s40, s40, 5
    s_add_u32 s40, s40, s41
    s_lshl_b32 s40, s40, 10
    s_add_u32 s40, s40, 5357568
    v_lshrrev_b32 v3, 4, v1
    v_bfe_u32 v4, v1, 2, 2
    v_lshl_add_u32 v3, v3, 3, v4
    v_bfe_u32 v4, v1, 1, 1
    s_lshl_b32 s41, s32, 1
    v_add_u32 v4, s41, v4
    v_bfe_u32 v10, v3, 2, 1
    v_bfe_u32 v5, v3, 3, 1
    v_xor_b32 v10, v10, v5
    v_bfe_u32 v5, v3, 1, 1
    v_lshl_or_b32 v10, v10, 1, v5
    v_lshlrev_b32 v10, 1, v10
    v_xor_b32 v4, v4, v10
    v_lshlrev_b32 v4, 4, v4
    v_and_b32 v10, 1, v1
    v_lshl_add_u32 v4, v10, 3, v4
    v_lshl_add_u32 v10, v3, 7, v4
    v_lshrrev_b32 v3, 4, v1
    v_bfe_u32 v4, v1, 2, 2
    v_lshl_add_u32 v3, v3, 3, v4
    v_add_u32 v3, 4, v3
    v_bfe_u32 v4, v1, 1, 1
    s_lshl_b32 s41, s32, 1
    v_add_u32 v4, s41, v4
    v_bfe_u32 v11, v3, 2, 1
    v_bfe_u32 v5, v3, 3, 1
    v_xor_b32 v11, v11, v5
    v_bfe_u32 v5, v3, 1, 1
    v_lshl_or_b32 v11, v11, 1, v5
    v_lshlrev_b32 v11, 1, v11
    v_xor_b32 v4, v4, v11
    v_lshlrev_b32 v4, 4, v4
    v_and_b32 v11, 1, v1
    v_lshl_add_u32 v4, v11, 3, v4
    v_lshl_add_u32 v11, v3, 7, v4
    ds_read_b64_tr_b16 v[40:41], v10 offset:2048
    ds_read_b64_tr_b16 v[42:43], v11 offset:2048
    ds_read_b64_tr_b16 v[44:45], v10 offset:6144
    ds_read_b64_tr_b16 v[46:47], v11 offset:6144
    ds_read_b64_tr_b16 v[48:49], v10 offset:10240
    ds_read_b64_tr_b16 v[50:51], v11 offset:10240
    ds_read_b64_tr_b16 v[52:53], v10 offset:14336
    ds_read_b64_tr_b16 v[54:55], v11 offset:14336
    s_waitcnt lgkmcnt(6)
    buffer_store_dwordx4 v[40:43], v2, s[28:31], s40 offen sc1
    s_add_u32 s40, s40, 5120
    s_waitcnt lgkmcnt(4)
    buffer_store_dwordx4 v[44:47], v2, s[28:31], s40 offen sc1
    s_add_u32 s40, s40, 5120
    s_waitcnt lgkmcnt(2)
    buffer_store_dwordx4 v[48:51], v2, s[28:31], s40 offen sc1
    s_add_u32 s40, s40, 5120
    s_waitcnt lgkmcnt(0)
    buffer_store_dwordx4 v[52:55], v2, s[28:31], s40 offen sc1
k0_fin:
k0_done:
    s_load_dwordx2 s[8:9], s[0:1], 88
    s_load_dwordx2 s[16:17], s[0:1], 40
    s_load_dwordx2 s[18:19], s[0:1], 32
    s_load_dwordx2 s[20:21], s[0:1], 48
    s_load_dwordx2 s[22:23], s[0:1], 0
    s_load_dwordx2 s[24:25], s[0:1], 72
    s_waitcnt vmcnt(0) lgkmcnt(0)
    s_barrier
    v_mov_b32 v3, 1800
    ds_read_b32 v4, v3
    s_waitcnt lgkmcnt(0)
    v_readfirstlane_b32 s96, v4
    s_cmp_eq_u32 s44, 0
    s_cbranch_scc0 kp_start
    s_lshl_b32 s40, s2, 7
    s_add_u32 s40, s40, 26599424
    v_mov_b32 v3, 0
    s_mov_b64 exec, 1
    buffer_store_dword v4, v3, s[28:31], s40 offen sc1
    s_mov_b64 exec, -1
    s_branch kp_start
k0_end:
    s_endpgm
kp_start:
    v_lshrrev_b32 v5, 6, v0
    v_and_b32 v1, 63, v0
    v_readfirstlane_b32 s32, v5
    v_lshlrev_b32 v2, 4, v1
    v_lshlrev_b32 v4, 2, v1
    v_lshrrev_b32 v3, 4, v1
    v_lshlrev_b32 v3, 4, v3
    s_mov_b32 s10, 26906624
    s_mov_b32 s11, 0x20000
    s_and_b32 s40, s2, 7
    s_lshr_b32 s41, s2, 3
    s_lshl_b32 s33, s40, 1
    s_lshr_b32 s42, s41, 4
    s_add_u32 s33, s33, s42
    s_and_b32 s34, s41, 15
    s_lshl_b32 s35, s33, 1
    s_lshr_b32 s42, s34, 3
    s_add_u32 s35, s35, s42
    s_and_b32 s36, s34, 7
    s_mov_b32 s37, 0
    s_waitcnt lgkmcnt(0)
    s_cmp_eq_u32 s32, 4
    s_cbranch_scc1 kp_L0
    s_cmp_eq_u32 s32, 5
    s_cbranch_scc1 kp_L1
    s_cmp_eq_u32 s32, 6
    s_cbranch_scc1 kp_L2
    s_cmp_eq_u32 s32, 7
    s_cbranch_scc1 kp_L3
    v_add_u32 v9, 0, v2
    v_add_u32 v10, 0x10000, v9
    s_lshl_b32 s40, s32, 11
    s_add_u32 s40, s40, 9216
    v_add_u32 v11, s40, v2
    v_add_u32 v12, 0x10000, v11
    v_and_b32 v7, 15, v1
    v_mul_u32_u24 v7, 368, v7
    v_add_u32 v7, 69632, v7
    s_lshl_b32 s40, s32, 3
    s_add_u32 s40, s40, 0
    v_lshrrev_b32 v5, 4, v1
    v_add_u32 v5, s40, v5
    s_cmp_lt_u32 s40, 20
    s_cbranch_scc0 kp_awf1
    v_mul_u32_u24 v6, 52, v5
    v_lshrrev_b32 v6, 8, v6
    v_mul_u32_u24 v184, 5, v6
    v_sub_u32 v5, v5, v184
    v_lshlrev_b32 v5, 3, v5
    v_mul_u32_u24 v6, 48, v6
    v_add_u32 v184, v5, v6
    s_branch kp_awd2
kp_awf1:
    v_subrev_u32 v5, 20, v5
    v_mul_u32_u24 v6, 52, v5
    v_lshrrev_b32 v6, 8, v6
    v_mul_u32_u24 v184, 5, v6
    v_sub_u32 v184, v5, v184
    v_lshlrev_b32 v184, 4, v184
    v_mul_u32_u24 v6, 80, v6
    v_add_u32 v184, v184, v6
    v_add_u32 v184, 192, v184
    v_cmp_gt_u32 vcc, 10, v5
    v_mov_b32 v6, 352
    s_nop 0
    v_cndmask_b32 v184, v6, v184, vcc
kp_awd2:
    v_add_u32 v184, v184, v7
    s_lshl_b32 s40, s32, 3
    s_add_u32 s40, s40, 4
    v_lshrrev_b32 v5, 4, v1
    v_add_u32 v5, s40, v5
    s_cmp_lt_u32 s40, 20
    s_cbranch_scc0 kp_awf3
    v_mul_u32_u24 v6, 52, v5
    v_lshrrev_b32 v6, 8, v6
    v_mul_u32_u24 v185, 5, v6
    v_sub_u32 v5, v5, v185
    v_lshlrev_b32 v5, 3, v5
    v_mul_u32_u24 v6, 48, v6
    v_add_u32 v185, v5, v6
    s_branch kp_awd4
kp_awf3:
    v_subrev_u32 v5, 20, v5
    v_mul_u32_u24 v6, 52, v5
    v_lshrrev_b32 v6, 8, v6
    v_mul_u32_u24 v185, 5, v6
    v_sub_u32 v185, v5, v185
    v_lshlrev_b32 v185, 4, v185
    v_mul_u32_u24 v6, 80, v6
    v_add_u32 v185, v185, v6
    v_add_u32 v185, 192, v185
    v_cmp_gt_u32 vcc, 10, v5
    v_mov_b32 v6, 352
    s_nop 0
    v_cndmask_b32 v185, v6, v185, vcc
kp_awd4:
    v_add_u32 v185, v185, v7
    s_and_b32 s40, s32, 1
    s_lshl_b32 s40, s40, 6
    v_add_u32 v5, s40, v1
    v_add_u32 v6, 2, v5
    v_mul_u32_u24 v6, 368, v6
    v_add_u32 v6, 69632, v6
    s_lshr_b32 s41, s32, 1
    s_mul_i32 s42, s41, 48
    v_add_u32 v186, s42, v6
    s_mul_i32 s42, s41, 80
    v_add_u32 v187, s42, v6
    v_lshrrev_b32 v188, 6, v5
    v_mul_u32_u24 v188, 81920, v188
    v_bfe_u32 v6, v5, 4, 2
    v_lshl_add_u32 v188, v6, 10, v188
    v_and_b32 v6, 15, v5
    v_lshl_add_u32 v188, v6, 4, v188
    s_mul_i32 s42, s34, 10
    s_mul_i32 s41, s41, 5
    s_add_u32 s42, s42, s41
    s_mul_i32 s43, s33, 163840
    s_add_u32 s43, s43, 12197888
    s_add_u32 s40, s42, 0
    s_lshr_b32 s41, s40, 3
    s_lshl_b32 s41, s41, 12
    s_bfe_u32 s44, s40, 0x20001
    s_lshl_b32 s44, s44, 8
    s_add_u32 s41, s41, s44
    s_and_b32 s40, s40, 1
    s_lshl_b32 s40, s40, 3
    s_add_u32 s40, s40, s41
    s_add_u32 s74, s40, s43
    s_add_u32 s40, s42, 1
    s_lshr_b32 s41, s40, 3
    s_lshl_b32 s41, s41, 12
    s_bfe_u32 s44, s40, 0x20001
    s_lshl_b32 s44, s44, 8
    s_add_u32 s41, s41, s44
    s_and_b32 s40, s40, 1
    s_lshl_b32 s40, s40, 3
    s_add_u32 s40, s40, s41
    s_add_u32 s75, s40, s43
    s_add_u32 s40, s42, 2
    s_lshr_b32 s41, s40, 3
    s_lshl_b32 s41, s41, 12
    s_bfe_u32 s44, s40, 0x20001
    s_lshl_b32 s44, s44, 8
    s_add_u32 s41, s41, s44
    s_and_b32 s40, s40, 1
    s_lshl_b32 s40, s40, 3
    s_add_u32 s40, s40, s41
    s_add_u32 s76, s40, s43
    s_add_u32 s40, s42, 3
    s_lshr_b32 s41, s40, 3
    s_lshl_b32 s41, s41, 12
    s_bfe_u32 s44, s40, 0x20001
    s_lshl_b32 s44, s44, 8
    s_add_u32 s41, s41, s44
    s_and_b32 s40, s40, 1
    s_lshl_b32 s40, s40, 3
    s_add_u32 s40, s40, s41
    s_add_u32 s77, s40, s43
    s_add_u32 s40, s42, 4
    s_lshr_b32 s41, s40, 3
    s_lshl_b32 s41, s41, 12
    s_bfe_u32 s44, s40, 0x20001
    s_lshl_b32 s44, s44, 8
    s_add_u32 s41, s41, s44
    s_and_b32 s40, s40, 1
    s_lshl_b32 s40, s40, 3
    s_add_u32 s40, s40, s41
    s_add_u32 s78, s40, s43
    s_lshl_b32 s40, s33, 7
    v_add_u32 v5, s40, v5
    v_cmp_le_u32 s[60:61], 2, v5
    v_cmp_le_u32 s[62:63], 4, v5
    v_cmp_le_u32 s[64:65], 6, v5
    v_cmp_le_u32 s[66:67], 8, v5
    v_cmp_le_u32 s[68:69], 10, v5
    v_cmp_le_u32 s[70:71], 12, v5
    v_cmp_le_u32 s[72:73], 14, v5
    s_barrier
    v_and_b32 v5, 15, v1
    v_cmp_gt_u32 vcc, 10, v5
    v_lshlrev_b32 v5, 13, v5
    s_mul_i32 s41, s34, 160
    s_add_u32 s41, s41, 5263360
    s_lshl_b32 s40, s32, 3
    s_add_u32 s40, s40, 0
    v_lshrrev_b32 v6, 4, v1
    v_add_u32 v6, s40, v6
    v_min_u32 v6, 29, v6
    v_mul_u32_u24 v7, 26, v6
    v_lshrrev_b32 v7, 8, v7
    v_mul_u32_u24 v8, 10, v7
    v_sub_u32 v6, v6, v8
    v_lshlrev_b32 v6, 4, v6
    v_mul_u32_u24 v7, 2560, v7
    v_add3_u32 v6, v6, v7, v5
    v_mov_b32 v7, 0x40000000
    v_cndmask_b32 v13, v7, v6, vcc
    buffer_load_dwordx4 v[176:179], v13, s[8:11], s41 offen
    s_lshl_b32 s40, s32, 3
    s_add_u32 s40, s40, 4
    v_lshrrev_b32 v6, 4, v1
    v_add_u32 v6, s40, v6
    v_min_u32 v6, 29, v6
    v_mul_u32_u24 v7, 26, v6
    v_lshrrev_b32 v7, 8, v7
    v_mul_u32_u24 v8, 10, v7
    v_sub_u32 v6, v6, v8
    v_lshlrev_b32 v6, 4, v6
    v_mul_u32_u24 v7, 2560, v7
    v_add3_u32 v6, v6, v7, v5
    v_mov_b32 v7, 0x40000000
    v_cndmask_b32 v14, v7, v6, vcc
    buffer_load_dwordx4 v[180:183], v14, s[8:11], s41 offen
    s_waitcnt vmcnt(0)
    v_add_f32_dpp v176, v176, v176 row_ror:8 row_mask:0xf bank_mask:0xf
    v_add_f32_dpp v177, v177, v177 row_ror:8 row_mask:0xf bank_mask:0xf
    v_add_f32_dpp v178, v178, v178 row_ror:8 row_mask:0xf bank_mask:0xf
    v_add_f32_dpp v179, v179, v179 row_ror:8 row_mask:0xf bank_mask:0xf
    v_add_f32_dpp v180, v180, v180 row_ror:8 row_mask:0xf bank_mask:0xf
    v_add_f32_dpp v181, v181, v181 row_ror:8 row_mask:0xf bank_mask:0xf
    v_add_f32_dpp v182, v182, v182 row_ror:8 row_mask:0xf bank_mask:0xf
    v_add_f32_dpp v183, v183, v183 row_ror:8 row_mask:0xf bank_mask:0xf
    v_add_f32_dpp v176, v176, v176 row_ror:4 row_mask:0xf bank_mask:0xf
    v_add_f32_dpp v177, v177, v177 row_ror:4 row_mask:0xf bank_mask:0xf
    v_add_f32_dpp v178, v178, v178 row_ror:4 row_mask:0xf bank_mask:0xf
    v_add_f32_dpp v179, v179, v179 row_ror:4 row_mask:0xf bank_mask:0xf
    v_add_f32_dpp v180, v180, v180 row_ror:4 row_mask:0xf bank_mask:0xf
    v_add_f32_dpp v181, v181, v181 row_ror:4 row_mask:0xf bank_mask:0xf
    v_add_f32_dpp v182, v182, v182 row_ror:4 row_mask:0xf bank_mask:0xf
    v_add_f32_dpp v183, v183, v183 row_ror:4 row_mask:0xf bank_mask:0xf
    v_add_f32_dpp v176, v176, v176 row_ror:2 row_mask:0xf bank_mask:0xf
    v_add_f32_dpp v177, v177, v177 row_ror:2 row_mask:0xf bank_mask:0xf
    v_add_f32_dpp v178, v178, v178 row_ror:2 row_mask:0xf bank_mask:0xf
    v_add_f32_dpp v179, v179, v179 row_ror:2 row_mask:0xf bank_mask:0xf
    v_add_f32_dpp v180, v180, v180 row_ror:2 row_mask:0xf bank_mask:0xf
    v_add_f32_dpp v181, v181, v181 row_ror:2 row_mask:0xf bank_mask:0xf
    v_add_f32_dpp v182, v182, v182 row_ror:2 row_mask:0xf bank_mask:0xf
    v_add_f32_dpp v183, v183, v183 row_ror:2 row_mask:0xf bank_mask:0xf
    v_add_f32_dpp v176, v176, v176 row_ror:1 row_mask:0xf bank_mask:0xf
    v_add_f32_dpp v177, v177, v177 row_ror:1 row_mask:0xf bank_mask:0xf
    v_add_f32_dpp v178, v178, v178 row_ror:1 row_mask:0xf bank_mask:0xf
    v_add_f32_dpp v179, v179, v179 row_ror:1 row_mask:0xf bank_mask:0xf
    v_add_f32_dpp v180, v180, v180 row_ror:1 row_mask:0xf bank_mask:0xf
    v_add_f32_dpp v181, v181, v181 row_ror:1 row_mask:0xf bank_mask:0xf
    v_add_f32_dpp v182, v182, v182 row_ror:1 row_mask:0xf bank_mask:0xf
    v_add_f32_dpp v183, v183, v183 row_ror:1 row_mask:0xf bank_mask:0xf
    s_getreg_b32 s38, hwreg(HW_REG_XCC_ID, 0, 4)
    s_add_u32 s38, s38, 1
    s_getreg_b32 s38, hwreg(HW_REG_XCC_ID, 0, 4)
    s_add_u32 s38, s38, 1
    s_barrier
    ds_read_b128 v[124:127], v11 offset:0
    ds_read_b128 v[128:131], v11 offset:1024
    ds_read_b128 v[88:91], v9 offset:0
    ds_read_b128 v[92:95], v9 offset:1024
    ds_read_b128 v[96:99], v9 offset:2048
    ds_read_b128 v[100:103], v9 offset:3072
    ds_read_b128 v[104:107], v9 offset:4096
    ds_read_b128 v[108:111], v9 offset:5120
    ds_read_b128 v[112:115], v9 offset:6144
    ds_read_b128 v[116:119], v9 offset:7168
    ds_read_b128 v[120:123], v9 offset:8192
    s_waitcnt lgkmcnt(0)
    s_barrier
    v_mfma_f32_16x16x32_bf16 v[16:19], v[124:127], v[88:91], v[176:179]
    ds_read_b128 v[168:171], v11 offset:17408
    v_mfma_f32_16x16x32_bf16 v[52:55], v[128:131], v[88:91], v[180:183]
    ds_read_b128 v[172:175], v11 offset:18432
    v_mfma_f32_16x16x32_bf16 v[20:23], v[124:127], v[92:95], v[176:179]
    ds_read_b128 v[132:135], v9 offset:17408
    v_mfma_f32_16x16x32_bf16 v[56:59], v[128:131], v[92:95], v[180:183]
    ds_read_b128 v[136:139], v9 offset:18432
    v_mfma_f32_16x16x32_bf16 v[24:27], v[124:127], v[96:99], v[176:179]
    ds_read_b128 v[140:143], v9 offset:19456
    v_mfma_f32_16x16x32_bf16 v[60:63], v[128:131], v[96:99], v[180:183]
    ds_read_b128 v[144:147], v9 offset:20480
    v_mfma_f32_16x16x32_bf16 v[28:31], v[124:127], v[100:103], v[176:179]
    ds_read_b128 v[148:151], v9 offset:21504
    v_mfma_f32_16x16x32_bf16 v[64:67], v[128:131], v[100:103], v[180:183]
    ds_read_b128 v[152:155], v9 offset:22528
    v_mfma_f32_16x16x32_bf16 v[32:35], v[124:127], v[104:107], v[176:179]
    ds_read_b128 v[156:159], v9 offset:23552
    v_mfma_f32_16x16x32_bf16 v[68:71], v[128:131], v[104:107], v[180:183]
    ds_read_b128 v[160:163], v9 offset:24576
    v_mfma_f32_16x16x32_bf16 v[36:39], v[124:127], v[108:111], v[176:179]
    ds_read_b128 v[164:167], v9 offset:25600
    v_mfma_f32_16x16x32_bf16 v[72:75], v[128:131], v[108:111], v[180:183]
    v_mfma_f32_16x16x32_bf16 v[40:43], v[124:127], v[112:115], v[176:179]
    v_mfma_f32_16x16x32_bf16 v[76:79], v[128:131], v[112:115], v[180:183]
    v_mfma_f32_16x16x32_bf16 v[44:47], v[124:127], v[116:119], v[176:179]
    v_mfma_f32_16x16x32_bf16 v[80:83], v[128:131], v[116:119], v[180:183]
    v_mfma_f32_16x16x32_bf16 v[48:51], v[124:127], v[120:123], v[176:179]
    v_mfma_f32_16x16x32_bf16 v[84:87], v[128:131], v[120:123], v[180:183]
    s_waitcnt lgkmcnt(0)
    s_barrier
    v_mfma_f32_16x16x32_bf16 v[16:19], v[168:171], v[132:135], v[16:19]
    ds_read_b128 v[124:127], v11 offset:34816
    v_mfma_f32_16x16x32_bf16 v[52:55], v[172:175], v[132:135], v[52:55]
    ds_read_b128 v[128:131], v11 offset:35840
    v_mfma_f32_16x16x32_bf16 v[20:23], v[168:171], v[136:139], v[20:23]
    ds_read_b128 v[88:91], v9 offset:34816
    v_mfma_f32_16x16x32_bf16 v[56:59], v[172:175], v[136:139], v[56:59]
    ds_read_b128 v[92:95], v9 offset:35840
    v_mfma_f32_16x16x32_bf16 v[24:27], v[168:171], v[140:143], v[24:27]
    ds_read_b128 v[96:99], v9 offset:36864
    v_mfma_f32_16x16x32_bf16 v[60:63], v[172:175], v[140:143], v[60:63]
    ds_read_b128 v[100:103], v9 offset:37888
    v_mfma_f32_16x16x32_bf16 v[28:31], v[168:171], v[144:147], v[28:31]
    ds_read_b128 v[104:107], v9 offset:38912
    v_mfma_f32_16x16x32_bf16 v[64:67], v[172:175], v[144:147], v[64:67]
    ds_read_b128 v[108:111], v9 offset:39936
    v_mfma_f32_16x16x32_bf16 v[32:35], v[168:171], v[148:151], v[32:35]
    ds_read_b128 v[112:115], v9 offset:40960
    v_mfma_f32_16x16x32_bf16 v[68:71], v[172:175], v[148:151], v[68:71]
    ds_read_b128 v[116:119], v9 offset:41984
    v_mfma_f32_16x16x32_bf16 v[36:39], v[168:171], v[152:155], v[36:39]
    ds_read_b128 v[120:123], v9 offset:43008
    v_mfma_f32_16x16x32_bf16 v[72:75], v[172:175], v[152:155], v[72:75]
    v_mfma_f32_16x16x32_bf16 v[40:43], v[168:171], v[156:159], v[40:43]
    v_mfma_f32_16x16x32_bf16 v[76:79], v[172:175], v[156:159], v[76:79]
    v_mfma_f32_16x16x32_bf16 v[44:47], v[168:171], v[160:163], v[44:47]
    v_mfma_f32_16x16x32_bf16 v[80:83], v[172:175], v[160:163], v[80:83]
    v_mfma_f32_16x16x32_bf16 v[48:51], v[168:171], v[164:167], v[48:51]
    v_mfma_f32_16x16x32_bf16 v[84:87], v[172:175], v[164:167], v[84:87]
    s_waitcnt lgkmcnt(0)
    s_barrier
    v_mfma_f32_16x16x32_bf16 v[16:19], v[124:127], v[88:91], v[16:19]
    ds_read_b128 v[168:171], v11 offset:52224
    v_mfma_f32_16x16x32_bf16 v[52:55], v[128:131], v[88:91], v[52:55]
    ds_read_b128 v[172:175], v11 offset:53248
    v_mfma_f32_16x16x32_bf16 v[20:23], v[124:127], v[92:95], v[20:23]
    ds_read_b128 v[132:135], v9 offset:52224
    v_mfma_f32_16x16x32_bf16 v[56:59], v[128:131], v[92:95], v[56:59]
    ds_read_b128 v[136:139], v9 offset:53248
    v_mfma_f32_16x16x32_bf16 v[24:27], v[124:127], v[96:99], v[24:27]
    ds_read_b128 v[140:143], v9 offset:54272
    v_mfma_f32_16x16x32_bf16 v[60:63], v[128:131], v[96:99], v[60:63]
    ds_read_b128 v[144:147], v9 offset:55296
    v_mfma_f32_16x16x32_bf16 v[28:31], v[124:127], v[100:103], v[28:31]
    ds_read_b128 v[148:151], v9 offset:56320
    v_mfma_f32_16x16x32_bf16 v[64:67], v[128:131], v[100:103], v[64:67]
    ds_read_b128 v[152:155], v9 offset:57344
    v_mfma_f32_16x16x32_bf16 v[32:35], v[124:127], v[104:107], v[32:35]
    ds_read_b128 v[156:159], v9 offset:58368
    v_mfma_f32_16x16x32_bf16 v[68:71], v[128:131], v[104:107], v[68:71]
    ds_read_b128 v[160:163], v9 offset:59392
    v_mfma_f32_16x16x32_bf16 v[36:39], v[124:127], v[108:111], v[36:39]
    ds_read_b128 v[164:167], v9 offset:60416
    v_mfma_f32_16x16x32_bf16 v[72:75], v[128:131], v[108:111], v[72:75]
    v_mfma_f32_16x16x32_bf16 v[40:43], v[124:127], v[112:115], v[40:43]
    v_mfma_f32_16x16x32_bf16 v[76:79], v[128:131], v[112:115], v[76:79]
    v_mfma_f32_16x16x32_bf16 v[44:47], v[124:127], v[116:119], v[44:47]
    v_mfma_f32_16x16x32_bf16 v[80:83], v[128:131], v[116:119], v[80:83]
    v_mfma_f32_16x16x32_bf16 v[48:51], v[124:127], v[120:123], v[48:51]
    v_mfma_f32_16x16x32_bf16 v[84:87], v[128:131], v[120:123], v[84:87]
    s_waitcnt lgkmcnt(0)
    s_barrier
    v_mfma_f32_16x16x32_bf16 v[16:19], v[168:171], v[132:135], v[16:19]
    ds_read_b128 v[124:127], v11 offset:0
    v_mfma_f32_16x16x32_bf16 v[52:55], v[172:175], v[132:135], v[52:55]
    ds_read_b128 v[128:131], v11 offset:1024
    v_mfma_f32_16x16x32_bf16 v[20:23], v[168:171], v[136:139], v[20:23]
    ds_read_b128 v[88:91], v9 offset:0
    v_mfma_f32_16x16x32_bf16 v[56:59], v[172:175], v[136:139], v[56:59]
    ds_read_b128 v[92:95], v9 offset:1024
    v_mfma_f32_16x16x32_bf16 v[24:27], v[168:171], v[140:143], v[24:27]
    ds_read_b128 v[96:99], v9 offset:2048
    v_mfma_f32_16x16x32_bf16 v[60:63], v[172:175], v[140:143], v[60:63]
    ds_read_b128 v[100:103], v9 offset:3072
    v_mfma_f32_16x16x32_bf16 v[28:31], v[168:171], v[144:147], v[28:31]
    ds_read_b128 v[104:107], v9 offset:4096
    v_mfma_f32_16x16x32_bf16 v[64:67], v[172:175], v[144:147], v[64:67]
    ds_read_b128 v[108:111], v9 offset:5120
    v_mfma_f32_16x16x32_bf16 v[32:35], v[168:171], v[148:151], v[32:35]
    ds_read_b128 v[112:115], v9 offset:6144
    v_mfma_f32_16x16x32_bf16 v[68:71], v[172:175], v[148:151], v[68:71]
    ds_read_b128 v[116:119], v9 offset:7168
    v_mfma_f32_16x16x32_bf16 v[36:39], v[168:171], v[152:155], v[36:39]
    ds_read_b128 v[120:123], v9 offset:8192
    v_mfma_f32_16x16x32_bf16 v[72:75], v[172:175], v[152:155], v[72:75]
    v_mfma_f32_16x16x32_bf16 v[40:43], v[168:171], v[156:159], v[40:43]
    v_mfma_f32_16x16x32_bf16 v[76:79], v[172:175], v[156:159], v[76:79]
    v_mfma_f32_16x16x32_bf16 v[44:47], v[168:171], v[160:163], v[44:47]
    v_mfma_f32_16x16x32_bf16 v[80:83], v[172:175], v[160:163], v[80:83]
    v_mfma_f32_16x16x32_bf16 v[48:51], v[168:171], v[164:167], v[48:51]
    v_mfma_f32_16x16x32_bf16 v[84:87], v[172:175], v[164:167], v[84:87]
    s_waitcnt lgkmcnt(0)
    s_barrier
    v_mfma_f32_16x16x32_bf16 v[16:19], v[124:127], v[88:91], v[16:19]
    ds_read_b128 v[168:171], v11 offset:17408
    v_mfma_f32_16x16x32_bf16 v[52:55], v[128:131], v[88:91], v[52:55]
    ds_read_b128 v[172:175], v11 offset:18432
    v_mfma_f32_16x16x32_bf16 v[20:23], v[124:127], v[92:95], v[20:23]
    ds_read_b128 v[132:135], v9 offset:17408
    v_mfma_f32_16x16x32_bf16 v[56:59], v[128:131], v[92:95], v[56:59]
    ds_read_b128 v[136:139], v9 offset:18432
    v_mfma_f32_16x16x32_bf16 v[24:27], v[124:127], v[96:99], v[24:27]
    ds_read_b128 v[140:143], v9 offset:19456
    v_mfma_f32_16x16x32_bf16 v[60:63], v[128:131], v[96:99], v[60:63]
    ds_read_b128 v[144:147], v9 offset:20480
    v_mfma_f32_16x16x32_bf16 v[28:31], v[124:127], v[100:103], v[28:31]
    ds_read_b128 v[148:151], v9 offset:21504
    v_mfma_f32_16x16x32_bf16 v[64:67], v[128:131], v[100:103], v[64:67]
    ds_read_b128 v[152:155], v9 offset:22528
    v_mfma_f32_16x16x32_bf16 v[32:35], v[124:127], v[104:107], v[32:35]
    ds_read_b128 v[156:159], v9 offset:23552
    v_mfma_f32_16x16x32_bf16 v[68:71], v[128:131], v[104:107], v[68:71]
    ds_read_b128 v[160:163], v9 offset:24576
    v_mfma_f32_16x16x32_bf16 v[36:39], v[124:127], v[108:111], v[36:39]
    ds_read_b128 v[164:167], v9 offset:25600
    v_mfma_f32_16x16x32_bf16 v[72:75], v[128:131], v[108:111], v[72:75]
    v_mfma_f32_16x16x32_bf16 v[40:43], v[124:127], v[112:115], v[40:43]
    v_mfma_f32_16x16x32_bf16 v[76:79], v[128:131], v[112:115], v[76:79]
    v_mfma_f32_16x16x32_bf16 v[44:47], v[124:127], v[116:119], v[44:47]
    v_mfma_f32_16x16x32_bf16 v[80:83], v[128:131], v[116:119], v[80:83]
    v_mfma_f32_16x16x32_bf16 v[48:51], v[124:127], v[120:123], v[48:51]
    v_mfma_f32_16x16x32_bf16 v[84:87], v[128:131], v[120:123], v[84:87]
    s_waitcnt lgkmcnt(0)
    s_barrier
    v_mfma_f32_16x16x32_bf16 v[16:19], v[168:171], v[132:135], v[16:19]
    ds_read_b128 v[124:127], v11 offset:34816
    v_mfma_f32_16x16x32_bf16 v[52:55], v[172:175], v[132:135], v[52:55]
    ds_read_b128 v[128:131], v11 offset:35840
    v_mfma_f32_16x16x32_bf16 v[20:23], v[168:171], v[136:139], v[20:23]
    ds_read_b128 v[88:91], v9 offset:34816
    v_mfma_f32_16x16x32_bf16 v[56:59], v[172:175], v[136:139], v[56:59]
    ds_read_b128 v[92:95], v9 offset:35840
    v_mfma_f32_16x16x32_bf16 v[24:27], v[168:171], v[140:143], v[24:27]
    ds_read_b128 v[96:99], v9 offset:36864
    v_mfma_f32_16x16x32_bf16 v[60:63], v[172:175], v[140:143], v[60:63]
    ds_read_b128 v[100:103], v9 offset:37888
    v_mfma_f32_16x16x32_bf16 v[28:31], v[168:171], v[144:147], v[28:31]
    ds_read_b128 v[104:107], v9 offset:38912
    v_mfma_f32_16x16x32_bf16 v[64:67], v[172:175], v[144:147], v[64:67]
    ds_read_b128 v[108:111], v9 offset:39936
    v_mfma_f32_16x16x32_bf16 v[32:35], v[168:171], v[148:151], v[32:35]
    ds_read_b128 v[112:115], v9 offset:40960
    v_mfma_f32_16x16x32_bf16 v[68:71], v[172:175], v[148:151], v[68:71]
    ds_read_b128 v[116:119], v9 offset:41984
    v_mfma_f32_16x16x32_bf16 v[36:39], v[168:171], v[152:155], v[36:39]
    ds_read_b128 v[120:123], v9 offset:43008
    v_mfma_f32_16x16x32_bf16 v[72:75], v[172:175], v[152:155], v[72:75]
    v_mfma_f32_16x16x32_bf16 v[40:43], v[168:171], v[156:159], v[40:43]
    v_mfma_f32_16x16x32_bf16 v[76:79], v[172:175], v[156:159], v[76:79]
    v_mfma_f32_16x16x32_bf16 v[44:47], v[168:171], v[160:163], v[44:47]
    v_mfma_f32_16x16x32_bf16 v[80:83], v[172:175], v[160:163], v[80:83]
    v_mfma_f32_16x16x32_bf16 v[48:51], v[168:171], v[164:167], v[48:51]
    v_mfma_f32_16x16x32_bf16 v[84:87], v[172:175], v[164:167], v[84:87]
    s_waitcnt lgkmcnt(0)
    s_barrier
    v_mfma_f32_16x16x32_bf16 v[16:19], v[124:127], v[88:91], v[16:19]
    ds_read_b128 v[168:171], v11 offset:52224
    v_mfma_f32_16x16x32_bf16 v[52:55], v[128:131], v[88:91], v[52:55]
    ds_read_b128 v[172:175], v11 offset:53248
    v_mfma_f32_16x16x32_bf16 v[20:23], v[124:127], v[92:95], v[20:23]
    ds_read_b128 v[132:135], v9 offset:52224
    v_mfma_f32_16x16x32_bf16 v[56:59], v[128:131], v[92:95], v[56:59]
    ds_read_b128 v[136:139], v9 offset:53248
    v_mfma_f32_16x16x32_bf16 v[24:27], v[124:127], v[96:99], v[24:27]
    ds_read_b128 v[140:143], v9 offset:54272
    v_mfma_f32_16x16x32_bf16 v[60:63], v[128:131], v[96:99], v[60:63]
    ds_read_b128 v[144:147], v9 offset:55296
    v_mfma_f32_16x16x32_bf16 v[28:31], v[124:127], v[100:103], v[28:31]
    ds_read_b128 v[148:151], v9 offset:56320
    v_mfma_f32_16x16x32_bf16 v[64:67], v[128:131], v[100:103], v[64:67]
    ds_read_b128 v[152:155], v9 offset:57344
    v_mfma_f32_16x16x32_bf16 v[32:35], v[124:127], v[104:107], v[32:35]
    ds_read_b128 v[156:159], v9 offset:58368
    v_mfma_f32_16x16x32_bf16 v[68:71], v[128:131], v[104:107], v[68:71]
    ds_read_b128 v[160:163], v9 offset:59392
    v_mfma_f32_16x16x32_bf16 v[36:39], v[124:127], v[108:111], v[36:39]
    ds_read_b128 v[164:167], v9 offset:60416
    v_mfma_f32_16x16x32_bf16 v[72:75], v[128:131], v[108:111], v[72:75]
    v_mfma_f32_16x16x32_bf16 v[40:43], v[124:127], v[112:115], v[40:43]
    v_mfma_f32_16x16x32_bf16 v[76:79], v[128:131], v[112:115], v[76:79]
    v_mfma_f32_16x16x32_bf16 v[44:47], v[124:127], v[116:119], v[44:47]
    v_mfma_f32_16x16x32_bf16 v[80:83], v[128:131], v[116:119], v[80:83]
    v_mfma_f32_16x16x32_bf16 v[48:51], v[124:127], v[120:123], v[48:51]
    v_mfma_f32_16x16x32_bf16 v[84:87], v[128:131], v[120:123], v[84:87]
    s_waitcnt lgkmcnt(0)
    s_barrier
    v_mfma_f32_16x16x32_bf16 v[16:19], v[168:171], v[132:135], v[16:19]
    ds_read_b128 v[124:127], v11 offset:0
    v_mfma_f32_16x16x32_bf16 v[52:55], v[172:175], v[132:135], v[52:55]
    ds_read_b128 v[128:131], v11 offset:1024
    v_mfma_f32_16x16x32_bf16 v[20:23], v[168:171], v[136:139], v[20:23]
    ds_read_b128 v[88:91], v9 offset:0
    v_mfma_f32_16x16x32_bf16 v[56:59], v[172:175], v[136:139], v[56:59]
    ds_read_b128 v[92:95], v9 offset:1024
    v_mfma_f32_16x16x32_bf16 v[24:27], v[168:171], v[140:143], v[24:27]
    ds_read_b128 v[96:99], v9 offset:2048
    v_mfma_f32_16x16x32_bf16 v[60:63], v[172:175], v[140:143], v[60:63]
    ds_read_b128 v[100:103], v9 offset:3072
    v_mfma_f32_16x16x32_bf16 v[28:31], v[168:171], v[144:147], v[28:31]
    ds_read_b128 v[104:107], v9 offset:4096
    v_mfma_f32_16x16x32_bf16 v[64:67], v[172:175], v[144:147], v[64:67]
    ds_read_b128 v[108:111], v9 offset:5120
    v_mfma_f32_16x16x32_bf16 v[32:35], v[168:171], v[148:151], v[32:35]
    ds_read_b128 v[112:115], v9 offset:6144
    v_mfma_f32_16x16x32_bf16 v[68:71], v[172:175], v[148:151], v[68:71]
    ds_read_b128 v[116:119], v9 offset:7168
    v_mfma_f32_16x16x32_bf16 v[36:39], v[168:171], v[152:155], v[36:39]
    ds_read_b128 v[120:123], v9 offset:8192
    v_mfma_f32_16x16x32_bf16 v[72:75], v[172:175], v[152:155], v[72:75]
    v_mfma_f32_16x16x32_bf16 v[40:43], v[168:171], v[156:159], v[40:43]
    v_mfma_f32_16x16x32_bf16 v[76:79], v[172:175], v[156:159], v[76:79]
    v_mfma_f32_16x16x32_bf16 v[44:47], v[168:171], v[160:163], v[44:47]
    v_mfma_f32_16x16x32_bf16 v[80:83], v[172:175], v[160:163], v[80:83]
    v_mfma_f32_16x16x32_bf16 v[48:51], v[168:171], v[164:167], v[48:51]
    v_mfma_f32_16x16x32_bf16 v[84:87], v[172:175], v[164:167], v[84:87]
    s_waitcnt lgkmcnt(0)
    s_barrier
    v_mfma_f32_16x16x32_bf16 v[16:19], v[124:127], v[88:91], v[16:19]
    ds_read_b128 v[168:171], v11 offset:17408
    v_mfma_f32_16x16x32_bf16 v[52:55], v[128:131], v[88:91], v[52:55]
    ds_read_b128 v[172:175], v11 offset:18432
    v_mfma_f32_16x16x32_bf16 v[20:23], v[124:127], v[92:95], v[20:23]
    ds_read_b128 v[132:135], v9 offset:17408
    v_mfma_f32_16x16x32_bf16 v[56:59], v[128:131], v[92:95], v[56:59]
    ds_read_b128 v[136:139], v9 offset:18432
    v_mfma_f32_16x16x32_bf16 v[24:27], v[124:127], v[96:99], v[24:27]
    ds_read_b128 v[140:143], v9 offset:19456
    v_mfma_f32_16x16x32_bf16 v[60:63], v[128:131], v[96:99], v[60:63]
    ds_read_b128 v[144:147], v9 offset:20480
    v_mfma_f32_16x16x32_bf16 v[28:31], v[124:127], v[100:103], v[28:31]
    ds_read_b128 v[148:151], v9 offset:21504
    v_mfma_f32_16x16x32_bf16 v[64:67], v[128:131], v[100:103], v[64:67]
    ds_read_b128 v[152:155], v9 offset:22528
    v_mfma_f32_16x16x32_bf16 v[32:35], v[124:127], v[104:107], v[32:35]
    ds_read_b128 v[156:159], v9 offset:23552
    v_mfma_f32_16x16x32_bf16 v[68:71], v[128:131], v[104:107], v[68:71]
    ds_read_b128 v[160:163], v9 offset:24576
    v_mfma_f32_16x16x32_bf16 v[36:39], v[124:127], v[108:111], v[36:39]
    ds_read_b128 v[164:167], v9 offset:25600
    v_mfma_f32_16x16x32_bf16 v[72:75], v[128:131], v[108:111], v[72:75]
    v_mfma_f32_16x16x32_bf16 v[40:43], v[124:127], v[112:115], v[40:43]
    v_mfma_f32_16x16x32_bf16 v[76:79], v[128:131], v[112:115], v[76:79]
    v_mfma_f32_16x16x32_bf16 v[44:47], v[124:127], v[116:119], v[44:47]
    v_mfma_f32_16x16x32_bf16 v[80:83], v[128:131], v[116:119], v[80:83]
    v_mfma_f32_16x16x32_bf16 v[48:51], v[124:127], v[120:123], v[48:51]
    v_mfma_f32_16x16x32_bf16 v[84:87], v[128:131], v[120:123], v[84:87]
    s_waitcnt lgkmcnt(0)
    s_barrier
    v_mfma_f32_16x16x32_bf16 v[16:19], v[168:171], v[132:135], v[16:19]
    ds_read_b128 v[124:127], v11 offset:34816
    v_mfma_f32_16x16x32_bf16 v[52:55], v[172:175], v[132:135], v[52:55]
    ds_read_b128 v[128:131], v11 offset:35840
    v_mfma_f32_16x16x32_bf16 v[20:23], v[168:171], v[136:139], v[20:23]
    ds_read_b128 v[88:91], v9 offset:34816
    v_mfma_f32_16x16x32_bf16 v[56:59], v[172:175], v[136:139], v[56:59]
    ds_read_b128 v[92:95], v9 offset:35840
    v_mfma_f32_16x16x32_bf16 v[24:27], v[168:171], v[140:143], v[24:27]
    ds_read_b128 v[96:99], v9 offset:36864
    v_mfma_f32_16x16x32_bf16 v[60:63], v[172:175], v[140:143], v[60:63]
    ds_read_b128 v[100:103], v9 offset:37888
    v_mfma_f32_16x16x32_bf16 v[28:31], v[168:171], v[144:147], v[28:31]
    ds_read_b128 v[104:107], v9 offset:38912
    v_mfma_f32_16x16x32_bf16 v[64:67], v[172:175], v[144:147], v[64:67]
    ds_read_b128 v[108:111], v9 offset:39936
    v_mfma_f32_16x16x32_bf16 v[32:35], v[168:171], v[148:151], v[32:35]
    ds_read_b128 v[112:115], v9 offset:40960
    v_mfma_f32_16x16x32_bf16 v[68:71], v[172:175], v[148:151], v[68:71]
    ds_read_b128 v[116:119], v9 offset:41984
    v_mfma_f32_16x16x32_bf16 v[36:39], v[168:171], v[152:155], v[36:39]
    ds_read_b128 v[120:123], v9 offset:43008
    v_mfma_f32_16x16x32_bf16 v[72:75], v[172:175], v[152:155], v[72:75]
    v_mfma_f32_16x16x32_bf16 v[40:43], v[168:171], v[156:159], v[40:43]
    v_mfma_f32_16x16x32_bf16 v[76:79], v[172:175], v[156:159], v[76:79]
    v_mfma_f32_16x16x32_bf16 v[44:47], v[168:171], v[160:163], v[44:47]
    v_mfma_f32_16x16x32_bf16 v[80:83], v[172:175], v[160:163], v[80:83]
    v_mfma_f32_16x16x32_bf16 v[48:51], v[168:171], v[164:167], v[48:51]
    v_mfma_f32_16x16x32_bf16 v[84:87], v[172:175], v[164:167], v[84:87]
    s_waitcnt lgkmcnt(0)
    s_barrier
    v_mfma_f32_16x16x32_bf16 v[16:19], v[124:127], v[88:91], v[16:19]
    ds_read_b128 v[168:171], v11 offset:52224
    v_mfma_f32_16x16x32_bf16 v[52:55], v[128:131], v[88:91], v[52:55]
    ds_read_b128 v[172:175], v11 offset:53248
    v_mfma_f32_16x16x32_bf16 v[20:23], v[124:127], v[92:95], v[20:23]
    ds_read_b128 v[132:135], v9 offset:52224
    v_mfma_f32_16x16x32_bf16 v[56:59], v[128:131], v[92:95], v[56:59]
    ds_read_b128 v[136:139], v9 offset:53248
    v_mfma_f32_16x16x32_bf16 v[24:27], v[124:127], v[96:99], v[24:27]
    ds_read_b128 v[140:143], v9 offset:54272
    v_mfma_f32_16x16x32_bf16 v[60:63], v[128:131], v[96:99], v[60:63]
    ds_read_b128 v[144:147], v9 offset:55296
    v_mfma_f32_16x16x32_bf16 v[28:31], v[124:127], v[100:103], v[28:31]
    ds_read_b128 v[148:151], v9 offset:56320
    v_mfma_f32_16x16x32_bf16 v[64:67], v[128:131], v[100:103], v[64:67]
    ds_read_b128 v[152:155], v9 offset:57344
    v_mfma_f32_16x16x32_bf16 v[32:35], v[124:127], v[104:107], v[32:35]
    ds_read_b128 v[156:159], v9 offset:58368
    v_mfma_f32_16x16x32_bf16 v[68:71], v[128:131], v[104:107], v[68:71]
    ds_read_b128 v[160:163], v9 offset:59392
    v_mfma_f32_16x16x32_bf16 v[36:39], v[124:127], v[108:111], v[36:39]
    ds_read_b128 v[164:167], v9 offset:60416
    v_mfma_f32_16x16x32_bf16 v[72:75], v[128:131], v[108:111], v[72:75]
    v_mfma_f32_16x16x32_bf16 v[40:43], v[124:127], v[112:115], v[40:43]
    v_mfma_f32_16x16x32_bf16 v[76:79], v[128:131], v[112:115], v[76:79]
    v_mfma_f32_16x16x32_bf16 v[44:47], v[124:127], v[116:119], v[44:47]
    v_mfma_f32_16x16x32_bf16 v[80:83], v[128:131], v[116:119], v[80:83]
    v_mfma_f32_16x16x32_bf16 v[48:51], v[124:127], v[120:123], v[48:51]
    v_mfma_f32_16x16x32_bf16 v[84:87], v[128:131], v[120:123], v[84:87]
    s_waitcnt lgkmcnt(0)
    s_barrier
    v_mfma_f32_16x16x32_bf16 v[16:19], v[168:171], v[132:135], v[16:19]
    ds_read_b128 v[124:127], v11 offset:0
    v_mfma_f32_16x16x32_bf16 v[52:55], v[172:175], v[132:135], v[52:55]
    ds_read_b128 v[128:131], v11 offset:1024
    v_mfma_f32_16x16x32_bf16 v[20:23], v[168:171], v[136:139], v[20:23]
    ds_read_b128 v[88:91], v9 offset:0
    v_mfma_f32_16x16x32_bf16 v[56:59], v[172:175], v[136:139], v[56:59]
    ds_read_b128 v[92:95], v9 offset:1024
    v_mfma_f32_16x16x32_bf16 v[24:27], v[168:171], v[140:143], v[24:27]
    ds_read_b128 v[96:99], v9 offset:2048
    v_mfma_f32_16x16x32_bf16 v[60:63], v[172:175], v[140:143], v[60:63]
    ds_read_b128 v[100:103], v9 offset:3072
    v_mfma_f32_16x16x32_bf16 v[28:31], v[168:171], v[144:147], v[28:31]
    ds_read_b128 v[104:107], v9 offset:4096
    v_mfma_f32_16x16x32_bf16 v[64:67], v[172:175], v[144:147], v[64:67]
    ds_read_b128 v[108:111], v9 offset:5120
    v_mfma_f32_16x16x32_bf16 v[32:35], v[168:171], v[148:151], v[32:35]
    ds_read_b128 v[112:115], v9 offset:6144
    v_mfma_f32_16x16x32_bf16 v[68:71], v[172:175], v[148:151], v[68:71]
    ds_read_b128 v[116:119], v9 offset:7168
    v_mfma_f32_16x16x32_bf16 v[36:39], v[168:171], v[152:155], v[36:39]
    ds_read_b128 v[120:123], v9 offset:8192
    v_mfma_f32_16x16x32_bf16 v[72:75], v[172:175], v[152:155], v[72:75]
    v_mfma_f32_16x16x32_bf16 v[40:43], v[168:171], v[156:159], v[40:43]
    v_mfma_f32_16x16x32_bf16 v[76:79], v[172:175], v[156:159], v[76:79]
    v_mfma_f32_16x16x32_bf16 v[44:47], v[168:171], v[160:163], v[44:47]
    v_mfma_f32_16x16x32_bf16 v[80:83], v[172:175], v[160:163], v[80:83]
    v_mfma_f32_16x16x32_bf16 v[48:51], v[168:171], v[164:167], v[48:51]
    v_mfma_f32_16x16x32_bf16 v[84:87], v[172:175], v[164:167], v[84:87]
    s_waitcnt lgkmcnt(0)
    s_barrier
    v_mfma_f32_16x16x32_bf16 v[16:19], v[124:127], v[88:91], v[16:19]
    ds_read_b128 v[168:171], v11 offset:17408
    v_mfma_f32_16x16x32_bf16 v[52:55], v[128:131], v[88:91], v[52:55]
    ds_read_b128 v[172:175], v11 offset:18432
    v_mfma_f32_16x16x32_bf16 v[20:23], v[124:127], v[92:95], v[20:23]
    ds_read_b128 v[132:135], v9 offset:17408
    v_mfma_f32_16x16x32_bf16 v[56:59], v[128:131], v[92:95], v[56:59]
    ds_read_b128 v[136:139], v9 offset:18432
    v_mfma_f32_16x16x32_bf16 v[24:27], v[124:127], v[96:99], v[24:27]
    ds_read_b128 v[140:143], v9 offset:19456
    v_mfma_f32_16x16x32_bf16 v[60:63], v[128:131], v[96:99], v[60:63]
    ds_read_b128 v[144:147], v9 offset:20480
    v_mfma_f32_16x16x32_bf16 v[28:31], v[124:127], v[100:103], v[28:31]
    ds_read_b128 v[148:151], v9 offset:21504
    v_mfma_f32_16x16x32_bf16 v[64:67], v[128:131], v[100:103], v[64:67]
    ds_read_b128 v[152:155], v9 offset:22528
    v_mfma_f32_16x16x32_bf16 v[32:35], v[124:127], v[104:107], v[32:35]
    ds_read_b128 v[156:159], v9 offset:23552
    v_mfma_f32_16x16x32_bf16 v[68:71], v[128:131], v[104:107], v[68:71]
    ds_read_b128 v[160:163], v9 offset:24576
    v_mfma_f32_16x16x32_bf16 v[36:39], v[124:127], v[108:111], v[36:39]
    ds_read_b128 v[164:167], v9 offset:25600
    v_mfma_f32_16x16x32_bf16 v[72:75], v[128:131], v[108:111], v[72:75]
    v_mfma_f32_16x16x32_bf16 v[40:43], v[124:127], v[112:115], v[40:43]
    v_mfma_f32_16x16x32_bf16 v[76:79], v[128:131], v[112:115], v[76:79]
    v_mfma_f32_16x16x32_bf16 v[44:47], v[124:127], v[116:119], v[44:47]
    v_mfma_f32_16x16x32_bf16 v[80:83], v[128:131], v[116:119], v[80:83]
    v_mfma_f32_16x16x32_bf16 v[48:51], v[124:127], v[120:123], v[48:51]
    v_mfma_f32_16x16x32_bf16 v[84:87], v[128:131], v[120:123], v[84:87]
    s_waitcnt lgkmcnt(0)
    s_barrier
    v_mfma_f32_16x16x32_bf16 v[16:19], v[168:171], v[132:135], v[16:19]
    ds_read_b128 v[124:127], v11 offset:34816
    v_mfma_f32_16x16x32_bf16 v[52:55], v[172:175], v[132:135], v[52:55]
    ds_read_b128 v[128:131], v11 offset:35840
    v_mfma_f32_16x16x32_bf16 v[20:23], v[168:171], v[136:139], v[20:23]
    ds_read_b128 v[88:91], v9 offset:34816
    v_mfma_f32_16x16x32_bf16 v[56:59], v[172:175], v[136:139], v[56:59]
    ds_read_b128 v[92:95], v9 offset:35840
    v_mfma_f32_16x16x32_bf16 v[24:27], v[168:171], v[140:143], v[24:27]
    ds_read_b128 v[96:99], v9 offset:36864
    v_mfma_f32_16x16x32_bf16 v[60:63], v[172:175], v[140:143], v[60:63]
    ds_read_b128 v[100:103], v9 offset:37888
    v_mfma_f32_16x16x32_bf16 v[28:31], v[168:171], v[144:147], v[28:31]
    ds_read_b128 v[104:107], v9 offset:38912
    v_mfma_f32_16x16x32_bf16 v[64:67], v[172:175], v[144:147], v[64:67]
    ds_read_b128 v[108:111], v9 offset:39936
    v_mfma_f32_16x16x32_bf16 v[32:35], v[168:171], v[148:151], v[32:35]
    ds_read_b128 v[112:115], v9 offset:40960
    v_mfma_f32_16x16x32_bf16 v[68:71], v[172:175], v[148:151], v[68:71]
    ds_read_b128 v[116:119], v9 offset:41984
    v_mfma_f32_16x16x32_bf16 v[36:39], v[168:171], v[152:155], v[36:39]
    ds_read_b128 v[120:123], v9 offset:43008
    v_mfma_f32_16x16x32_bf16 v[72:75], v[172:175], v[152:155], v[72:75]
    v_mfma_f32_16x16x32_bf16 v[40:43], v[168:171], v[156:159], v[40:43]
    v_mfma_f32_16x16x32_bf16 v[76:79], v[172:175], v[156:159], v[76:79]
    v_mfma_f32_16x16x32_bf16 v[44:47], v[168:171], v[160:163], v[44:47]
    v_mfma_f32_16x16x32_bf16 v[80:83], v[172:175], v[160:163], v[80:83]
    v_mfma_f32_16x16x32_bf16 v[48:51], v[168:171], v[164:167], v[48:51]
    v_mfma_f32_16x16x32_bf16 v[84:87], v[172:175], v[164:167], v[84:87]
    s_waitcnt lgkmcnt(0)
    s_barrier
    v_mfma_f32_16x16x32_bf16 v[16:19], v[124:127], v[88:91], v[16:19]
    ds_read_b128 v[168:171], v11 offset:52224
    v_mfma_f32_16x16x32_bf16 v[52:55], v[128:131], v[88:91], v[52:55]
    ds_read_b128 v[172:175], v11 offset:53248
    v_mfma_f32_16x16x32_bf16 v[20:23], v[124:127], v[92:95], v[20:23]
    ds_read_b128 v[132:135], v9 offset:52224
    v_mfma_f32_16x16x32_bf16 v[56:59], v[128:131], v[92:95], v[56:59]
    ds_read_b128 v[136:139], v9 offset:53248
    v_mfma_f32_16x16x32_bf16 v[24:27], v[124:127], v[96:99], v[24:27]
    ds_read_b128 v[140:143], v9 offset:54272
    v_mfma_f32_16x16x32_bf16 v[60:63], v[128:131], v[96:99], v[60:63]
    ds_read_b128 v[144:147], v9 offset:55296
    v_mfma_f32_16x16x32_bf16 v[28:31], v[124:127], v[100:103], v[28:31]
    ds_read_b128 v[148:151], v9 offset:56320
    v_mfma_f32_16x16x32_bf16 v[64:67], v[128:131], v[100:103], v[64:67]
    ds_read_b128 v[152:155], v9 offset:57344
    v_mfma_f32_16x16x32_bf16 v[32:35], v[124:127], v[104:107], v[32:35]
    ds_read_b128 v[156:159], v9 offset:58368
    v_mfma_f32_16x16x32_bf16 v[68:71], v[128:131], v[104:107], v[68:71]
    ds_read_b128 v[160:163], v9 offset:59392
    v_mfma_f32_16x16x32_bf16 v[36:39], v[124:127], v[108:111], v[36:39]
    ds_read_b128 v[164:167], v9 offset:60416
    v_mfma_f32_16x16x32_bf16 v[72:75], v[128:131], v[108:111], v[72:75]
    v_mfma_f32_16x16x32_bf16 v[40:43], v[124:127], v[112:115], v[40:43]
    v_mfma_f32_16x16x32_bf16 v[76:79], v[128:131], v[112:115], v[76:79]
    v_mfma_f32_16x16x32_bf16 v[44:47], v[124:127], v[116:119], v[44:47]
    v_mfma_f32_16x16x32_bf16 v[80:83], v[128:131], v[116:119], v[80:83]
    v_mfma_f32_16x16x32_bf16 v[48:51], v[124:127], v[120:123], v[48:51]
    v_mfma_f32_16x16x32_bf16 v[84:87], v[128:131], v[120:123], v[84:87]
    s_waitcnt lgkmcnt(0)
    s_barrier
    v_mfma_f32_16x16x32_bf16 v[16:19], v[168:171], v[132:135], v[16:19]
    ds_read_b128 v[124:127], v11 offset:0
    v_mfma_f32_16x16x32_bf16 v[52:55], v[172:175], v[132:135], v[52:55]
    ds_read_b128 v[128:131], v11 offset:1024
    v_mfma_f32_16x16x32_bf16 v[20:23], v[168:171], v[136:139], v[20:23]
    ds_read_b128 v[88:91], v9 offset:0
    v_mfma_f32_16x16x32_bf16 v[56:59], v[172:175], v[136:139], v[56:59]
    ds_read_b128 v[92:95], v9 offset:1024
    v_mfma_f32_16x16x32_bf16 v[24:27], v[168:171], v[140:143], v[24:27]
    ds_read_b128 v[96:99], v9 offset:2048
    v_mfma_f32_16x16x32_bf16 v[60:63], v[172:175], v[140:143], v[60:63]
    ds_read_b128 v[100:103], v9 offset:3072
    v_mfma_f32_16x16x32_bf16 v[28:31], v[168:171], v[144:147], v[28:31]
    ds_read_b128 v[104:107], v9 offset:4096
    v_mfma_f32_16x16x32_bf16 v[64:67], v[172:175], v[144:147], v[64:67]
    ds_read_b128 v[108:111], v9 offset:5120
    v_mfma_f32_16x16x32_bf16 v[32:35], v[168:171], v[148:151], v[32:35]
    ds_read_b128 v[112:115], v9 offset:6144
    v_mfma_f32_16x16x32_bf16 v[68:71], v[172:175], v[148:151], v[68:71]
    ds_read_b128 v[116:119], v9 offset:7168
    v_mfma_f32_16x16x32_bf16 v[36:39], v[168:171], v[152:155], v[36:39]
    ds_read_b128 v[120:123], v9 offset:8192
    v_mfma_f32_16x16x32_bf16 v[72:75], v[172:175], v[152:155], v[72:75]
    v_mfma_f32_16x16x32_bf16 v[40:43], v[168:171], v[156:159], v[40:43]
    v_mfma_f32_16x16x32_bf16 v[76:79], v[172:175], v[156:159], v[76:79]
    v_mfma_f32_16x16x32_bf16 v[44:47], v[168:171], v[160:163], v[44:47]
    v_mfma_f32_16x16x32_bf16 v[80:83], v[172:175], v[160:163], v[80:83]
    v_mfma_f32_16x16x32_bf16 v[48:51], v[168:171], v[164:167], v[48:51]
    v_mfma_f32_16x16x32_bf16 v[84:87], v[172:175], v[164:167], v[84:87]
    s_waitcnt lgkmcnt(0)
    s_barrier
    v_mfma_f32_16x16x32_bf16 v[16:19], v[124:127], v[88:91], v[16:19]
    ds_read_b128 v[168:171], v11 offset:17408
    v_mfma_f32_16x16x32_bf16 v[52:55], v[128:131], v[88:91], v[52:55]
    ds_read_b128 v[172:175], v11 offset:18432
    v_mfma_f32_16x16x32_bf16 v[20:23], v[124:127], v[92:95], v[20:23]
    ds_read_b128 v[132:135], v9 offset:17408
    v_mfma_f32_16x16x32_bf16 v[56:59], v[128:131], v[92:95], v[56:59]
    ds_read_b128 v[136:139], v9 offset:18432
    v_mfma_f32_16x16x32_bf16 v[24:27], v[124:127], v[96:99], v[24:27]
    ds_read_b128 v[140:143], v9 offset:19456
    v_mfma_f32_16x16x32_bf16 v[60:63], v[128:131], v[96:99], v[60:63]
    ds_read_b128 v[144:147], v9 offset:20480
    v_mfma_f32_16x16x32_bf16 v[28:31], v[124:127], v[100:103], v[28:31]
    ds_read_b128 v[148:151], v9 offset:21504
    v_mfma_f32_16x16x32_bf16 v[64:67], v[128:131], v[100:103], v[64:67]
    ds_read_b128 v[152:155], v9 offset:22528
    v_mfma_f32_16x16x32_bf16 v[32:35], v[124:127], v[104:107], v[32:35]
    ds_read_b128 v[156:159], v9 offset:23552
    v_mfma_f32_16x16x32_bf16 v[68:71], v[128:131], v[104:107], v[68:71]
    ds_read_b128 v[160:163], v9 offset:24576
    v_mfma_f32_16x16x32_bf16 v[36:39], v[124:127], v[108:111], v[36:39]
    ds_read_b128 v[164:167], v9 offset:25600
    v_mfma_f32_16x16x32_bf16 v[72:75], v[128:131], v[108:111], v[72:75]
    v_mfma_f32_16x16x32_bf16 v[40:43], v[124:127], v[112:115], v[40:43]
    v_mfma_f32_16x16x32_bf16 v[76:79], v[128:131], v[112:115], v[76:79]
    v_mfma_f32_16x16x32_bf16 v[44:47], v[124:127], v[116:119], v[44:47]
    v_mfma_f32_16x16x32_bf16 v[80:83], v[128:131], v[116:119], v[80:83]
    v_mfma_f32_16x16x32_bf16 v[48:51], v[124:127], v[120:123], v[48:51]
    v_mfma_f32_16x16x32_bf16 v[84:87], v[128:131], v[120:123], v[84:87]
    s_waitcnt lgkmcnt(0)
    s_barrier
    v_mfma_f32_16x16x32_bf16 v[16:19], v[168:171], v[132:135], v[16:19]
    ds_read_b128 v[124:127], v11 offset:34816
    v_mfma_f32_16x16x32_bf16 v[52:55], v[172:175], v[132:135], v[52:55]
    ds_read_b128 v[128:131], v11 offset:35840
    v_mfma_f32_16x16x32_bf16 v[20:23], v[168:171], v[136:139], v[20:23]
    ds_read_b128 v[88:91], v9 offset:34816
    v_mfma_f32_16x16x32_bf16 v[56:59], v[172:175], v[136:139], v[56:59]
    ds_read_b128 v[92:95], v9 offset:35840
    v_mfma_f32_16x16x32_bf16 v[24:27], v[168:171], v[140:143], v[24:27]
    ds_read_b128 v[96:99], v9 offset:36864
    v_mfma_f32_16x16x32_bf16 v[60:63], v[172:175], v[140:143], v[60:63]
    ds_read_b128 v[100:103], v9 offset:37888
    v_mfma_f32_16x16x32_bf16 v[28:31], v[168:171], v[144:147], v[28:31]
    ds_read_b128 v[104:107], v9 offset:38912
    v_mfma_f32_16x16x32_bf16 v[64:67], v[172:175], v[144:147], v[64:67]
    ds_read_b128 v[108:111], v9 offset:39936
    v_mfma_f32_16x16x32_bf16 v[32:35], v[168:171], v[148:151], v[32:35]
    ds_read_b128 v[112:115], v9 offset:40960
    v_mfma_f32_16x16x32_bf16 v[68:71], v[172:175], v[148:151], v[68:71]
    ds_read_b128 v[116:119], v9 offset:41984
    v_mfma_f32_16x16x32_bf16 v[36:39], v[168:171], v[152:155], v[36:39]
    ds_read_b128 v[120:123], v9 offset:43008
    v_mfma_f32_16x16x32_bf16 v[72:75], v[172:175], v[152:155], v[72:75]
    v_mfma_f32_16x16x32_bf16 v[40:43], v[168:171], v[156:159], v[40:43]
    v_mfma_f32_16x16x32_bf16 v[76:79], v[172:175], v[156:159], v[76:79]
    v_mfma_f32_16x16x32_bf16 v[44:47], v[168:171], v[160:163], v[44:47]
    v_mfma_f32_16x16x32_bf16 v[80:83], v[172:175], v[160:163], v[80:83]
    v_mfma_f32_16x16x32_bf16 v[48:51], v[168:171], v[164:167], v[48:51]
    v_mfma_f32_16x16x32_bf16 v[84:87], v[172:175], v[164:167], v[84:87]
    s_waitcnt lgkmcnt(0)
    s_barrier
    v_mfma_f32_16x16x32_bf16 v[16:19], v[124:127], v[88:91], v[16:19]
    ds_read_b128 v[168:171], v11 offset:52224
    v_mfma_f32_16x16x32_bf16 v[52:55], v[128:131], v[88:91], v[52:55]
    ds_read_b128 v[172:175], v11 offset:53248
    v_mfma_f32_16x16x32_bf16 v[20:23], v[124:127], v[92:95], v[20:23]
    ds_read_b128 v[132:135], v9 offset:52224
    v_mfma_f32_16x16x32_bf16 v[56:59], v[128:131], v[92:95], v[56:59]
    ds_read_b128 v[136:139], v9 offset:53248
    v_mfma_f32_16x16x32_bf16 v[24:27], v[124:127], v[96:99], v[24:27]
    ds_read_b128 v[140:143], v9 offset:54272
    v_mfma_f32_16x16x32_bf16 v[60:63], v[128:131], v[96:99], v[60:63]
    ds_read_b128 v[144:147], v9 offset:55296
    v_mfma_f32_16x16x32_bf16 v[28:31], v[124:127], v[100:103], v[28:31]
    ds_read_b128 v[148:151], v9 offset:56320
    v_mfma_f32_16x16x32_bf16 v[64:67], v[128:131], v[100:103], v[64:67]
    ds_read_b128 v[152:155], v9 offset:57344
    v_mfma_f32_16x16x32_bf16 v[32:35], v[124:127], v[104:107], v[32:35]
    ds_read_b128 v[156:159], v9 offset:58368
    v_mfma_f32_16x16x32_bf16 v[68:71], v[128:131], v[104:107], v[68:71]
    ds_read_b128 v[160:163], v9 offset:59392
    v_mfma_f32_16x16x32_bf16 v[36:39], v[124:127], v[108:111], v[36:39]
    ds_read_b128 v[164:167], v9 offset:60416
    v_mfma_f32_16x16x32_bf16 v[72:75], v[128:131], v[108:111], v[72:75]
    v_mfma_f32_16x16x32_bf16 v[40:43], v[124:127], v[112:115], v[40:43]
    v_mfma_f32_16x16x32_bf16 v[76:79], v[128:131], v[112:115], v[76:79]
    v_mfma_f32_16x16x32_bf16 v[44:47], v[124:127], v[116:119], v[44:47]
    v_mfma_f32_16x16x32_bf16 v[80:83], v[128:131], v[116:119], v[80:83]
    v_mfma_f32_16x16x32_bf16 v[48:51], v[124:127], v[120:123], v[48:51]
    v_mfma_f32_16x16x32_bf16 v[84:87], v[128:131], v[120:123], v[84:87]
    s_waitcnt lgkmcnt(0)
    v_mfma_f32_16x16x32_bf16 v[16:19], v[168:171], v[132:135], v[16:19]
    v_mfma_f32_16x16x32_bf16 v[52:55], v[172:175], v[132:135], v[52:55]
    v_mfma_f32_16x16x32_bf16 v[20:23], v[168:171], v[136:139], v[20:23]
    v_mfma_f32_16x16x32_bf16 v[56:59], v[172:175], v[136:139], v[56:59]
    v_mfma_f32_16x16x32_bf16 v[24:27], v[168:171], v[140:143], v[24:27]
    v_mfma_f32_16x16x32_bf16 v[60:63], v[172:175], v[140:143], v[60:63]
    v_mfma_f32_16x16x32_bf16 v[28:31], v[168:171], v[144:147], v[28:31]
    v_mfma_f32_16x16x32_bf16 v[64:67], v[172:175], v[144:147], v[64:67]
    v_mfma_f32_16x16x32_bf16 v[32:35], v[168:171], v[148:151], v[32:35]
    v_mfma_f32_16x16x32_bf16 v[68:71], v[172:175], v[148:151], v[68:71]
    v_mfma_f32_16x16x32_bf16 v[36:39], v[168:171], v[152:155], v[36:39]
    v_mfma_f32_16x16x32_bf16 v[72:75], v[172:175], v[152:155], v[72:75]
    v_mfma_f32_16x16x32_bf16 v[40:43], v[168:171], v[156:159], v[40:43]
    v_mfma_f32_16x16x32_bf16 v[76:79], v[172:175], v[156:159], v[76:79]
    v_mfma_f32_16x16x32_bf16 v[44:47], v[168:171], v[160:163], v[44:47]
    v_mfma_f32_16x16x32_bf16 v[80:83], v[172:175], v[160:163], v[80:83]
    v_mfma_f32_16x16x32_bf16 v[48:51], v[168:171], v[164:167], v[48:51]
    v_mfma_f32_16x16x32_bf16 v[84:87], v[172:175], v[164:167], v[84:87]
    v_mov_b32 v5, 146944
    ds_read_b32 v250, v5
    s_lshl_b32 s40, s32, 1
    s_add_u32 s40, s40, 0
    s_cmp_lt_u32 s40, 5
    s_cbranch_scc0 kp_stf5
    v_cvt_pk_bf16_f32 v88, v16, v17
    v_cvt_pk_bf16_f32 v89, v18, v19
    ds_write_b64 v184, v[88:89] offset:0
    v_cvt_pk_bf16_f32 v90, v20, v21
    v_cvt_pk_bf16_f32 v91, v22, v23
    ds_write_b64 v184, v[90:91] offset:5888
    v_cvt_pk_bf16_f32 v92, v24, v25
    v_cvt_pk_bf16_f32 v93, v26, v27
    ds_write_b64 v184, v[92:93] offset:11776
    v_cvt_pk_bf16_f32 v94, v28, v29
    v_cvt_pk_bf16_f32 v95, v30, v31
    ds_write_b64 v184, v[94:95] offset:17664
    v_cvt_pk_bf16_f32 v96, v32, v33
    v_cvt_pk_bf16_f32 v97, v34, v35
    ds_write_b64 v184, v[96:97] offset:23552
    v_cvt_pk_bf16_f32 v98, v36, v37
    v_cvt_pk_bf16_f32 v99, v38, v39
    ds_write_b64 v184, v[98:99] offset:29440
    v_cvt_pk_bf16_f32 v100, v40, v41
    v_cvt_pk_bf16_f32 v101, v42, v43
    ds_write_b64 v184, v[100:101] offset:35328
    v_cvt_pk_bf16_f32 v102, v44, v45
    v_cvt_pk_bf16_f32 v103, v46, v47
    ds_write_b64 v184, v[102:103] offset:41216
    v_cvt_pk_bf16_f32 v104, v48, v49
    v_cvt_pk_bf16_f32 v105, v50, v51
    ds_write_b64 v184, v[104:105] offset:47104
    s_branch kp_std6
kp_stf5:
    s_nop 7
    s_nop 3
    ds_write_b128 v184, v[16:19] offset:0
    ds_write_b128 v184, v[20:23] offset:5888
    ds_write_b128 v184, v[24:27] offset:11776
    ds_write_b128 v184, v[28:31] offset:17664
    ds_write_b128 v184, v[32:35] offset:23552
    ds_write_b128 v184, v[36:39] offset:29440
    ds_write_b128 v184, v[40:43] offset:35328
    ds_write_b128 v184, v[44:47] offset:41216
    ds_write_b128 v184, v[48:51] offset:47104
kp_std6:
    s_lshl_b32 s40, s32, 1
    s_add_u32 s40, s40, 1
    s_cmp_lt_u32 s40, 5
    s_cbranch_scc0 kp_stf7
    v_cvt_pk_bf16_f32 v108, v52, v53
    v_cvt_pk_bf16_f32 v109, v54, v55
    ds_write_b64 v185, v[108:109] offset:0
    v_cvt_pk_bf16_f32 v110, v56, v57
    v_cvt_pk_bf16_f32 v111, v58, v59
    ds_write_b64 v185, v[110:111] offset:5888
    v_cvt_pk_bf16_f32 v112, v60, v61
    v_cvt_pk_bf16_f32 v113, v62, v63
    ds_write_b64 v185, v[112:113] offset:11776
    v_cvt_pk_bf16_f32 v114, v64, v65
    v_cvt_pk_bf16_f32 v115, v66, v67
    ds_write_b64 v185, v[114:115] offset:17664
    v_cvt_pk_bf16_f32 v116, v68, v69
    v_cvt_pk_bf16_f32 v117, v70, v71
    ds_write_b64 v185, v[116:117] offset:23552
    v_cvt_pk_bf16_f32 v118, v72, v73
    v_cvt_pk_bf16_f32 v119, v74, v75
    ds_write_b64 v185, v[118:119] offset:29440
    v_cvt_pk_bf16_f32 v120, v76, v77
    v_cvt_pk_bf16_f32 v121, v78, v79
    ds_write_b64 v185, v[120:121] offset:35328
    v_cvt_pk_bf16_f32 v122, v80, v81
    v_cvt_pk_bf16_f32 v123, v82, v83
    ds_write_b64 v185, v[122:123] offset:41216
    v_cvt_pk_bf16_f32 v124, v84, v85
    v_cvt_pk_bf16_f32 v125, v86, v87
    ds_write_b64 v185, v[124:125] offset:47104
    s_branch kp_std8
kp_stf7:
    s_nop 7
    s_nop 3
    ds_write_b128 v185, v[52:55] offset:0
    ds_write_b128 v185, v[56:59] offset:5888
    ds_write_b128 v185, v[60:63] offset:11776
    ds_write_b128 v185, v[64:67] offset:17664
    ds_write_b128 v185, v[68:71] offset:23552
    ds_write_b128 v185, v[72:75] offset:29440
    ds_write_b128 v185, v[76:79] offset:35328
    ds_write_b128 v185, v[80:83] offset:41216
    ds_write_b128 v185, v[84:87] offset:47104
kp_std8:
    s_waitcnt lgkmcnt(0)
    s_barrier
    ds_read_b128 v[16:19], v186 offset:5152
    ds_read_b128 v[20:23], v186 offset:5168
    ds_read_b64 v[24:25], v186 offset:5184
    ds_read_b128 v[28:31], v186 offset:5248
    ds_read_b128 v[32:35], v186 offset:5264
    ds_read_b64 v[36:37], v186 offset:5280
    ds_read_b128 v[40:43], v186 offset:4512
    ds_read_b128 v[44:47], v186 offset:4528
    ds_read_b64 v[48:49], v186 offset:4544
    ds_read_b128 v[52:55], v186 offset:3776
    ds_read_b128 v[56:59], v186 offset:3792
    ds_read_b64 v[60:61], v186 offset:3808
    ds_read_b128 v[64:67], v186 offset:3040
    ds_read_b128 v[68:71], v186 offset:3056
    ds_read_b64 v[72:73], v186 offset:3072
    s_waitcnt lgkmcnt(6)
    ds_read_b128 v[76:79], v186 offset:2304
    ds_read_b128 v[80:83], v186 offset:2320
    ds_read_b64 v[84:85], v186 offset:2336
    ds_read_b128 v[88:91], v186 offset:1568
    ds_read_b128 v[92:95], v186 offset:1584
    ds_read_b64 v[96:97], v186 offset:1600
    v_dot2_f32_bf16 v192, v16, v28, 0
    v_dot2_f32_bf16 v194, v16, v40, 0
    v_dot2_f32_bf16 v192, v17, v29, v192
    v_dot2_f32_bf16 v194, v17, v41, v194
    v_dot2_f32_bf16 v192, v18, v30, v192
    v_dot2_f32_bf16 v194, v18, v42, v194
    v_dot2_f32_bf16 v192, v19, v31, v192
    v_dot2_f32_bf16 v194, v19, v43, v194
    v_dot2_f32_bf16 v192, v20, v32, v192
    v_dot2_f32_bf16 v194, v20, v44, v194
    v_dot2_f32_bf16 v192, v21, v33, v192
    v_dot2_f32_bf16 v194, v21, v45, v194
    v_dot2_f32_bf16 v192, v22, v34, v192
    v_dot2_f32_bf16 v194, v22, v46, v194
    v_dot2_f32_bf16 v192, v23, v35, v192
    v_dot2_f32_bf16 v194, v23, v47, v194
    v_dot2_f32_bf16 v192, v24, v36, v192
    v_dot2_f32_bf16 v194, v24, v48, v194
    v_dot2_f32_bf16 v192, v25, v37, v192
    v_dot2_f32_bf16 v194, v25, v49, v194
    s_waitcnt lgkmcnt(6)
    ds_read_b128 v[100:103], v186 offset:832
    ds_read_b128 v[104:107], v186 offset:848
    ds_read_b64 v[108:109], v186 offset:864
    ds_read_b128 v[112:115], v186 offset:96
    ds_read_b128 v[116:119], v186 offset:112
    ds_read_b64 v[120:121], v186 offset:128
    v_dot2_f32_bf16 v196, v16, v52, 0
    v_dot2_f32_bf16 v198, v16, v64, 0
    v_dot2_f32_bf16 v196, v17, v53, v196
    v_dot2_f32_bf16 v198, v17, v65, v198
    v_dot2_f32_bf16 v196, v18, v54, v196
    v_dot2_f32_bf16 v198, v18, v66, v198
    v_dot2_f32_bf16 v196, v19, v55, v196
    v_dot2_f32_bf16 v198, v19, v67, v198
    v_dot2_f32_bf16 v196, v20, v56, v196
    v_dot2_f32_bf16 v198, v20, v68, v198
    v_dot2_f32_bf16 v196, v21, v57, v196
    v_dot2_f32_bf16 v198, v21, v69, v198
    v_dot2_f32_bf16 v196, v22, v58, v196
    v_dot2_f32_bf16 v198, v22, v70, v198
    v_dot2_f32_bf16 v196, v23, v59, v196
    v_dot2_f32_bf16 v198, v23, v71, v198
    v_dot2_f32_bf16 v196, v24, v60, v196
    v_dot2_f32_bf16 v198, v24, v72, v198
    v_dot2_f32_bf16 v196, v25, v61, v196
    v_dot2_f32_bf16 v198, v25, v73, v198
    s_waitcnt lgkmcnt(6)
    ds_read_b128 v[124:127], v187 offset:5344
    ds_read_b128 v[128:131], v187 offset:5360
    ds_read_b128 v[132:135], v187 offset:5376
    ds_read_b128 v[136:139], v187 offset:5392
    ds_read_b128 v[140:143], v187 offset:5408
    v_dot2_f32_bf16 v200, v16, v76, 0
    v_dot2_f32_bf16 v202, v16, v88, 0
    v_dot2_f32_bf16 v200, v17, v77, v200
    v_dot2_f32_bf16 v202, v17, v89, v202
    v_dot2_f32_bf16 v200, v18, v78, v200
    v_dot2_f32_bf16 v202, v18, v90, v202
    v_dot2_f32_bf16 v200, v19, v79, v200
    v_dot2_f32_bf16 v202, v19, v91, v202
    v_dot2_f32_bf16 v200, v20, v80, v200
    v_dot2_f32_bf16 v202, v20, v92, v202
    v_dot2_f32_bf16 v200, v21, v81, v200
    v_dot2_f32_bf16 v202, v21, v93, v202
    v_dot2_f32_bf16 v200, v22, v82, v200
    v_dot2_f32_bf16 v202, v22, v94, v202
    v_dot2_f32_bf16 v200, v23, v83, v200
    v_dot2_f32_bf16 v202, v23, v95, v202
    v_dot2_f32_bf16 v200, v24, v84, v200
    v_dot2_f32_bf16 v202, v24, v96, v202
    v_dot2_f32_bf16 v200, v25, v85, v200
    v_dot2_f32_bf16 v202, v25, v97, v202
    s_waitcnt lgkmcnt(5)
    ds_read_b128 v[144:147], v187 offset:4608
    ds_read_b128 v[148:151], v187 offset:4624
    ds_read_b128 v[152:155], v187 offset:4640
    ds_read_b128 v[156:159], v187 offset:4656
    ds_read_b128 v[160:163], v187 offset:4672
    ds_read_b128 v[164:167], v187 offset:3872
    ds_read_b128 v[168:171], v187 offset:3888
    ds_read_b128 v[172:175], v187 offset:3904
    ds_read_b128 v[176:179], v187 offset:3920
    ds_read_b128 v[180:183], v187 offset:3936
    v_dot2_f32_bf16 v204, v16, v100, 0
    v_dot2_f32_bf16 v206, v16, v112, 0
    v_dot2_f32_bf16 v204, v17, v101, v204
    v_dot2_f32_bf16 v206, v17, v113, v206
    v_dot2_f32_bf16 v204, v18, v102, v204
    v_dot2_f32_bf16 v206, v18, v114, v206
    v_dot2_f32_bf16 v204, v19, v103, v204
    v_dot2_f32_bf16 v206, v19, v115, v206
    v_dot2_f32_bf16 v204, v20, v104, v204
    v_dot2_f32_bf16 v206, v20, v116, v206
    v_dot2_f32_bf16 v204, v21, v105, v204
    v_dot2_f32_bf16 v206, v21, v117, v206
    v_dot2_f32_bf16 v204, v22, v106, v204
    v_dot2_f32_bf16 v206, v22, v118, v206
    v_dot2_f32_bf16 v204, v23, v107, v204
    v_dot2_f32_bf16 v206, v23, v119, v206
    v_dot2_f32_bf16 v204, v24, v108, v204
    v_dot2_f32_bf16 v206, v24, v120, v206
    v_dot2_f32_bf16 v204, v25, v109, v204
    v_dot2_f32_bf16 v206, v25, v121, v206
    s_cmp_lg_u32 s33, 0
    s_cbranch_scc1 kp_nomask9
    s_nop 2
    v_mov_b32 v228, 0xf149f2ca
    v_cndmask_b32 v194, v228, v194, s[60:61]
    v_cndmask_b32 v196, v228, v196, s[62:63]
    v_cndmask_b32 v198, v228, v198, s[64:65]
    v_cndmask_b32 v200, v228, v200, s[66:67]
    v_cndmask_b32 v202, v228, v202, s[68:69]
    v_cndmask_b32 v204, v228, v204, s[70:71]
    v_cndmask_b32 v206, v228, v206, s[72:73]
kp_nomask9:
    s_nop 2
    v_max3_f32 v228, v192, v194, v196
    v_max3_f32 v229, v198, v200, v202
    v_max3_f32 v228, v228, v204, v206
    v_max_f32 v228, v228, v229
    s_mov_b32 s40, 0x3ea52b5c
    v_mul_f32 v228, 0xbea52b5c, v228
    v_fma_f32 v192, v192, s40, v228
    v_fma_f32 v194, v194, s40, v228
    v_fma_f32 v196, v196, s40, v228
    v_fma_f32 v198, v198, s40, v228
    v_fma_f32 v200, v200, s40, v228
    v_fma_f32 v202, v202, s40, v228
    v_fma_f32 v204, v204, s40, v228
    v_fma_f32 v206, v206, s40, v228
    v_exp_f32 v192, v192
    v_exp_f32 v194, v194
    v_exp_f32 v196, v196
    v_exp_f32 v198, v198
    v_exp_f32 v200, v200
    v_exp_f32 v202, v202
    v_exp_f32 v204, v204
    v_exp_f32 v206, v206
    v_add_f32 v230, v192, v194
    v_add_f32 v231, v196, v198
    v_add_f32 v228, v200, v202
    v_add_f32 v229, v204, v206
    v_pk_add_f32 v[230:231], v[230:231], v[228:229]
    v_add_f32 v230, v230, v231
    v_rcp_f32 v230, v230
    s_waitcnt lgkmcnt(10)
    v_pk_mul_f32 v[208:209], v[124:125], v[192:193] op_sel_hi:[1,0]
    v_pk_mul_f32 v[210:211], v[126:127], v[192:193] op_sel_hi:[1,0]
    v_pk_mul_f32 v[212:213], v[128:129], v[192:193] op_sel_hi:[1,0]
    v_pk_mul_f32 v[214:215], v[130:131], v[192:193] op_sel_hi:[1,0]
    v_pk_mul_f32 v[216:217], v[132:133], v[192:193] op_sel_hi:[1,0]
    v_pk_mul_f32 v[218:219], v[134:135], v[192:193] op_sel_hi:[1,0]
    v_pk_mul_f32 v[220:221], v[136:137], v[192:193] op_sel_hi:[1,0]
    v_pk_mul_f32 v[222:223], v[138:139], v[192:193] op_sel_hi:[1,0]
    v_pk_mul_f32 v[224:225], v[140:141], v[192:193] op_sel_hi:[1,0]
    v_pk_mul_f32 v[226:227], v[142:143], v[192:193] op_sel_hi:[1,0]
    ds_read_b128 v[124:127], v187 offset:3136
    ds_read_b128 v[128:131], v187 offset:3152
    ds_read_b128 v[132:135], v187 offset:3168
    ds_read_b128 v[136:139], v187 offset:3184
    ds_read_b128 v[140:143], v187 offset:3200
    s_waitcnt lgkmcnt(10)
    v_pk_fma_f32 v[208:209], v[144:145], v[194:195], v[208:209] op_sel_hi:[1,0,1]
    v_pk_fma_f32 v[210:211], v[146:147], v[194:195], v[210:211] op_sel_hi:[1,0,1]
    v_pk_fma_f32 v[212:213], v[148:149], v[194:195], v[212:213] op_sel_hi:[1,0,1]
    v_pk_fma_f32 v[214:215], v[150:151], v[194:195], v[214:215] op_sel_hi:[1,0,1]
    v_pk_fma_f32 v[216:217], v[152:153], v[194:195], v[216:217] op_sel_hi:[1,0,1]
    v_pk_fma_f32 v[218:219], v[154:155], v[194:195], v[218:219] op_sel_hi:[1,0,1]
    v_pk_fma_f32 v[220:221], v[156:157], v[194:195], v[220:221] op_sel_hi:[1,0,1]
    v_pk_fma_f32 v[222:223], v[158:159], v[194:195], v[222:223] op_sel_hi:[1,0,1]
    v_pk_fma_f32 v[224:225], v[160:161], v[194:195], v[224:225] op_sel_hi:[1,0,1]
    v_pk_fma_f32 v[226:227], v[162:163], v[194:195], v[226:227] op_sel_hi:[1,0,1]
    ds_read_b128 v[144:147], v187 offset:2400
    ds_read_b128 v[148:151], v187 offset:2416
    ds_read_b128 v[152:155], v187 offset:2432
    ds_read_b128 v[156:159], v187 offset:2448
    ds_read_b128 v[160:163], v187 offset:2464
    s_waitcnt lgkmcnt(10)
    v_pk_fma_f32 v[208:209], v[164:165], v[196:197], v[208:209] op_sel_hi:[1,0,1]
    v_pk_fma_f32 v[210:211], v[166:167], v[196:197], v[210:211] op_sel_hi:[1,0,1]
    v_pk_fma_f32 v[212:213], v[168:169], v[196:197], v[212:213] op_sel_hi:[1,0,1]
    v_pk_fma_f32 v[214:215], v[170:171], v[196:197], v[214:215] op_sel_hi:[1,0,1]
    v_pk_fma_f32 v[216:217], v[172:173], v[196:197], v[216:217] op_sel_hi:[1,0,1]
    v_pk_fma_f32 v[218:219], v[174:175], v[196:197], v[218:219] op_sel_hi:[1,0,1]
    v_pk_fma_f32 v[220:221], v[176:177], v[196:197], v[220:221] op_sel_hi:[1,0,1]
    v_pk_fma_f32 v[222:223], v[178:179], v[196:197], v[222:223] op_sel_hi:[1,0,1]
    v_pk_fma_f32 v[224:225], v[180:181], v[196:197], v[224:225] op_sel_hi:[1,0,1]
    v_pk_fma_f32 v[226:227], v[182:183], v[196:197], v[226:227] op_sel_hi:[1,0,1]
    ds_read_b128 v[164:167], v187 offset:1664
    ds_read_b128 v[168:171], v187 offset:1680
    ds_read_b128 v[172:175], v187 offset:1696
    ds_read_b128 v[176:179], v187 offset:1712
    ds_read_b128 v[180:183], v187 offset:1728
    s_waitcnt lgkmcnt(10)
    v_pk_fma_f32 v[208:209], v[124:125], v[198:199], v[208:209] op_sel_hi:[1,0,1]
    v_pk_fma_f32 v[210:211], v[126:127], v[198:199], v[210:211] op_sel_hi:[1,0,1]
    v_pk_fma_f32 v[212:213], v[128:129], v[198:199], v[212:213] op_sel_hi:[1,0,1]
    v_pk_fma_f32 v[214:215], v[130:131], v[198:199], v[214:215] op_sel_hi:[1,0,1]
    v_pk_fma_f32 v[216:217], v[132:133], v[198:199], v[216:217] op_sel_hi:[1,0,1]
    v_pk_fma_f32 v[218:219], v[134:135], v[198:199], v[218:219] op_sel_hi:[1,0,1]
    v_pk_fma_f32 v[220:221], v[136:137], v[198:199], v[220:221] op_sel_hi:[1,0,1]
    v_pk_fma_f32 v[222:223], v[138:139], v[198:199], v[222:223] op_sel_hi:[1,0,1]
    v_pk_fma_f32 v[224:225], v[140:141], v[198:199], v[224:225] op_sel_hi:[1,0,1]
    v_pk_fma_f32 v[226:227], v[142:143], v[198:199], v[226:227] op_sel_hi:[1,0,1]
    ds_read_b128 v[124:127], v187 offset:928
    ds_read_b128 v[128:131], v187 offset:944
    ds_read_b128 v[132:135], v187 offset:960
    ds_read_b128 v[136:139], v187 offset:976
    ds_read_b128 v[140:143], v187 offset:992
    s_waitcnt lgkmcnt(10)
    v_pk_fma_f32 v[208:209], v[144:145], v[200:201], v[208:209] op_sel_hi:[1,0,1]
    v_pk_fma_f32 v[210:211], v[146:147], v[200:201], v[210:211] op_sel_hi:[1,0,1]
    v_pk_fma_f32 v[212:213], v[148:149], v[200:201], v[212:213] op_sel_hi:[1,0,1]
    v_pk_fma_f32 v[214:215], v[150:151], v[200:201], v[214:215] op_sel_hi:[1,0,1]
    v_pk_fma_f32 v[216:217], v[152:153], v[200:201], v[216:217] op_sel_hi:[1,0,1]
    v_pk_fma_f32 v[218:219], v[154:155], v[200:201], v[218:219] op_sel_hi:[1,0,1]
    v_pk_fma_f32 v[220:221], v[156:157], v[200:201], v[220:221] op_sel_hi:[1,0,1]
    v_pk_fma_f32 v[222:223], v[158:159], v[200:201], v[222:223] op_sel_hi:[1,0,1]
    v_pk_fma_f32 v[224:225], v[160:161], v[200:201], v[224:225] op_sel_hi:[1,0,1]
    v_pk_fma_f32 v[226:227], v[162:163], v[200:201], v[226:227] op_sel_hi:[1,0,1]
    ds_read_b128 v[144:147], v187 offset:192
    ds_read_b128 v[148:151], v187 offset:208
    ds_read_b128 v[152:155], v187 offset:224
    ds_read_b128 v[156:159], v187 offset:240
    ds_read_b128 v[160:163], v187 offset:256
    s_waitcnt lgkmcnt(10)
    v_pk_fma_f32 v[208:209], v[164:165], v[202:203], v[208:209] op_sel_hi:[1,0,1]
    v_pk_fma_f32 v[210:211], v[166:167], v[202:203], v[210:211] op_sel_hi:[1,0,1]
    v_pk_fma_f32 v[212:213], v[168:169], v[202:203], v[212:213] op_sel_hi:[1,0,1]
    v_pk_fma_f32 v[214:215], v[170:171], v[202:203], v[214:215] op_sel_hi:[1,0,1]
    v_pk_fma_f32 v[216:217], v[172:173], v[202:203], v[216:217] op_sel_hi:[1,0,1]
    v_pk_fma_f32 v[218:219], v[174:175], v[202:203], v[218:219] op_sel_hi:[1,0,1]
    v_pk_fma_f32 v[220:221], v[176:177], v[202:203], v[220:221] op_sel_hi:[1,0,1]
    v_pk_fma_f32 v[222:223], v[178:179], v[202:203], v[222:223] op_sel_hi:[1,0,1]
    v_pk_fma_f32 v[224:225], v[180:181], v[202:203], v[224:225] op_sel_hi:[1,0,1]
    v_pk_fma_f32 v[226:227], v[182:183], v[202:203], v[226:227] op_sel_hi:[1,0,1]
    s_waitcnt lgkmcnt(5)
    v_pk_fma_f32 v[208:209], v[124:125], v[204:205], v[208:209] op_sel_hi:[1,0,1]
    v_pk_fma_f32 v[210:211], v[126:127], v[204:205], v[210:211] op_sel_hi:[1,0,1]
    v_pk_fma_f32 v[212:213], v[128:129], v[204:205], v[212:213] op_sel_hi:[1,0,1]
    v_pk_fma_f32 v[214:215], v[130:131], v[204:205], v[214:215] op_sel_hi:[1,0,1]
    v_pk_fma_f32 v[216:217], v[132:133], v[204:205], v[216:217] op_sel_hi:[1,0,1]
    v_pk_fma_f32 v[218:219], v[134:135], v[204:205], v[218:219] op_sel_hi:[1,0,1]
    v_pk_fma_f32 v[220:221], v[136:137], v[204:205], v[220:221] op_sel_hi:[1,0,1]
    v_pk_fma_f32 v[222:223], v[138:139], v[204:205], v[222:223] op_sel_hi:[1,0,1]
    v_pk_fma_f32 v[224:225], v[140:141], v[204:205], v[224:225] op_sel_hi:[1,0,1]
    v_pk_fma_f32 v[226:227], v[142:143], v[204:205], v[226:227] op_sel_hi:[1,0,1]
    s_waitcnt lgkmcnt(0)
    v_pk_fma_f32 v[208:209], v[144:145], v[206:207], v[208:209] op_sel_hi:[1,0,1]
    v_pk_fma_f32 v[210:211], v[146:147], v[206:207], v[210:211] op_sel_hi:[1,0,1]
    v_pk_fma_f32 v[212:213], v[148:149], v[206:207], v[212:213] op_sel_hi:[1,0,1]
    v_pk_fma_f32 v[214:215], v[150:151], v[206:207], v[214:215] op_sel_hi:[1,0,1]
    v_pk_fma_f32 v[216:217], v[152:153], v[206:207], v[216:217] op_sel_hi:[1,0,1]
    v_pk_fma_f32 v[218:219], v[154:155], v[206:207], v[218:219] op_sel_hi:[1,0,1]
    v_pk_fma_f32 v[220:221], v[156:157], v[206:207], v[220:221] op_sel_hi:[1,0,1]
    v_pk_fma_f32 v[222:223], v[158:159], v[206:207], v[222:223] op_sel_hi:[1,0,1]
    v_pk_fma_f32 v[224:225], v[160:161], v[206:207], v[224:225] op_sel_hi:[1,0,1]
    v_pk_fma_f32 v[226:227], v[162:163], v[206:207], v[226:227] op_sel_hi:[1,0,1]
    v_pk_mul_f32 v[208:209], v[208:209], v[230:231] op_sel_hi:[1,0]
    v_pk_mul_f32 v[210:211], v[210:211], v[230:231] op_sel_hi:[1,0]
    v_pk_mul_f32 v[212:213], v[212:213], v[230:231] op_sel_hi:[1,0]
    v_pk_mul_f32 v[214:215], v[214:215], v[230:231] op_sel_hi:[1,0]
    v_pk_mul_f32 v[216:217], v[216:217], v[230:231] op_sel_hi:[1,0]
    v_pk_mul_f32 v[218:219], v[218:219], v[230:231] op_sel_hi:[1,0]
    v_pk_mul_f32 v[220:221], v[220:221], v[230:231] op_sel_hi:[1,0]
    v_pk_mul_f32 v[222:223], v[222:223], v[230:231] op_sel_hi:[1,0]
    v_pk_mul_f32 v[224:225], v[224:225], v[230:231] op_sel_hi:[1,0]
    v_pk_mul_f32 v[226:227], v[226:227], v[230:231] op_sel_hi:[1,0]
    v_cvt_pk_bf16_f32 v16, v208, v209
    v_cvt_pk_bf16_f32 v17, v210, v211
    v_cvt_pk_bf16_f32 v18, v212, v213
    v_cvt_pk_bf16_f32 v19, v214, v215
    v_cvt_pk_bf16_f32 v20, v216, v217
    v_cvt_pk_bf16_f32 v21, v218, v219
    v_cvt_pk_bf16_f32 v22, v220, v221
    v_cvt_pk_bf16_f32 v23, v222, v223
    v_cvt_pk_bf16_f32 v24, v224, v225
    v_cvt_pk_bf16_f32 v25, v226, v227
    v_readfirstlane_b32 s37, v250
    s_nop 3
    s_cmp_eq_u32 s37, 0
    s_cbranch_scc1 kp_s10
    buffer_store_dwordx2 v[16:17], v188, s[8:11], s74 offen
    buffer_store_dwordx2 v[18:19], v188, s[8:11], s75 offen
    buffer_store_dwordx2 v[20:21], v188, s[8:11], s76 offen
    buffer_store_dwordx2 v[22:23], v188, s[8:11], s77 offen
    buffer_store_dwordx2 v[24:25], v188, s[8:11], s78 offen
    s_branch kp_d11
kp_s10:
    buffer_store_dwordx2 v[16:17], v188, s[8:11], s74 offen sc1
    buffer_store_dwordx2 v[18:19], v188, s[8:11], s75 offen sc1
    buffer_store_dwordx2 v[20:21], v188, s[8:11], s76 offen sc1
    buffer_store_dwordx2 v[22:23], v188, s[8:11], s77 offen sc1
    buffer_store_dwordx2 v[24:25], v188, s[8:11], s78 offen sc1
kp_d11:
    s_lshl_b32 s40, s33, 8
    s_lshl_b32 s41, s34, 4
    s_add_u32 s40, s40, s41
    s_lshl_b32 s41, s32, 2
    s_add_u32 s40, s40, s41
    s_add_u32 s40, s40, 26484736
    v_mov_b32 v5, s96
    s_waitcnt vmcnt(0)
    s_mov_b64 exec, 1
    s_cmp_eq_u32 s37, 0
    s_cbranch_scc1 kp_s12
    buffer_store_dword v5, v4, s[8:11], s40 offen
    s_branch kp_d13
kp_s12:
    buffer_store_dword v5, v4, s[8:11], s40 offen sc1
kp_d13:
    s_mov_b64 exec, -1
    v_add_u32 v9, 0, v2
    v_add_u32 v10, 0x10000, v9
    s_lshl_b32 s40, s32, 10
    s_add_u32 s40, s40, 61440
    v_add_u32 v11, s40, v2
    v_add_u32 v12, 0x10000, v11
    v_and_b32 v5, 15, v1
    v_lshlrev_b32 v210, 6, v5
    s_lshl_b32 s40, s32, 4
    v_add_u32 v5, s40, v5
    v_mul_u32_u24 v5, 160, v5
    v_lshrrev_b32 v6, 1, v3
    v_add_u32 v5, v5, v6
    v_add_u32 v208, 131072, v5
    v_add_u32 v209, 141312, v3
    s_mul_i32 s41, s33, 163840
    s_and_b32 s42, s35, 1
    s_lshl_b32 s42, s42, 2
    s_add_u32 s42, s42, s32
    s_lshl_b32 s42, s42, 10
    s_add_u32 s41, s41, s42
    s_add_u32 s41, s41, 17440768
    s_mul_i32 s42, s36, 5
    s_add_u32 s43, s42, 0
    s_lshr_b32 s44, s43, 1
    s_lshl_b32 s44, s44, 13
    s_and_b32 s43, s43, 1
    s_lshl_b32 s43, s43, 3
    s_add_u32 s43, s43, s44
    s_add_u32 s60, s43, s41
    s_add_u32 s43, s42, 1
    s_lshr_b32 s44, s43, 1
    s_lshl_b32 s44, s44, 13
    s_and_b32 s43, s43, 1
    s_lshl_b32 s43, s43, 3
    s_add_u32 s43, s43, s44
    s_add_u32 s61, s43, s41
    s_add_u32 s43, s42, 2
    s_lshr_b32 s44, s43, 1
    s_lshl_b32 s44, s44, 13
    s_and_b32 s43, s43, 1
    s_lshl_b32 s43, s43, 3
    s_add_u32 s43, s43, s44
    s_add_u32 s62, s43, s41
    s_add_u32 s43, s42, 3
    s_lshr_b32 s44, s43, 1
    s_lshl_b32 s44, s44, 13
    s_and_b32 s43, s43, 1
    s_lshl_b32 s43, s43, 3
    s_add_u32 s43, s43, s44
    s_add_u32 s63, s43, s41
    s_add_u32 s43, s42, 4
    s_lshr_b32 s44, s43, 1
    s_lshl_b32 s44, s44, 13
    s_and_b32 s43, s43, 1
    s_lshl_b32 s43, s43, 3
    s_add_u32 s43, s43, s44
    s_add_u32 s64, s43, s41
    s_lshl_b32 s40, s35, 2
    s_add_u32 s40, s40, s32
    s_lshl_b32 s40, s40, 10
    s_lshl_b32 s41, s36, 3
    s_add_u32 s40, s40, s41
    s_add_u32 s65, s40, 20062208
    s_barrier
    ds_read_b128 v[80:83], v11 offset:0
    ds_read_b128 v[40:43], v9 offset:0
    ds_read_b128 v[44:47], v9 offset:1024
    ds_read_b128 v[48:51], v9 offset:2048
    ds_read_b128 v[52:55], v9 offset:3072
    ds_read_b128 v[56:59], v9 offset:4096
    ds_read_b128 v[84:87], v11 offset:4096
    ds_read_b128 v[60:63], v9 offset:5120
    ds_read_b128 v[64:67], v9 offset:6144
    ds_read_b128 v[68:71], v9 offset:7168
    ds_read_b128 v[72:75], v9 offset:8192
    ds_read_b128 v[76:79], v9 offset:9216
    s_waitcnt lgkmcnt(0)
    s_barrier
    v_mfma_f32_16x16x32_bf16 v[16:19], v[40:43], v[80:83], 0
    ds_read_b128 v[128:131], v11 offset:8192
    v_mfma_f32_16x16x32_bf16 v[20:23], v[44:47], v[80:83], 0
    ds_read_b128 v[88:91], v9 offset:10240
    v_mfma_f32_16x16x32_bf16 v[24:27], v[48:51], v[80:83], 0
    ds_read_b128 v[92:95], v9 offset:11264
    v_mfma_f32_16x16x32_bf16 v[28:31], v[52:55], v[80:83], 0
    ds_read_b128 v[96:99], v9 offset:12288
    v_mfma_f32_16x16x32_bf16 v[32:35], v[56:59], v[80:83], 0
    ds_read_b128 v[100:103], v9 offset:13312
    v_mfma_f32_16x16x32_bf16 v[16:19], v[60:63], v[84:87], v[16:19]
    ds_read_b128 v[104:107], v9 offset:14336
    v_mfma_f32_16x16x32_bf16 v[20:23], v[64:67], v[84:87], v[20:23]
    ds_read_b128 v[132:135], v11 offset:12288
    v_mfma_f32_16x16x32_bf16 v[24:27], v[68:71], v[84:87], v[24:27]
    ds_read_b128 v[108:111], v9 offset:15360
    v_mfma_f32_16x16x32_bf16 v[28:31], v[72:75], v[84:87], v[28:31]
    ds_read_b128 v[112:115], v9 offset:16384
    v_mfma_f32_16x16x32_bf16 v[32:35], v[76:79], v[84:87], v[32:35]
    ds_read_b128 v[116:119], v9 offset:17408
    ds_read_b128 v[120:123], v9 offset:18432
    ds_read_b128 v[124:127], v9 offset:19456
    s_waitcnt lgkmcnt(0)
    s_barrier
    v_mfma_f32_16x16x32_bf16 v[16:19], v[88:91], v[128:131], v[16:19]
    ds_read_b128 v[80:83], v11 offset:16384
    v_mfma_f32_16x16x32_bf16 v[20:23], v[92:95], v[128:131], v[20:23]
    ds_read_b128 v[40:43], v9 offset:20480
    v_mfma_f32_16x16x32_bf16 v[24:27], v[96:99], v[128:131], v[24:27]
    ds_read_b128 v[44:47], v9 offset:21504
    v_mfma_f32_16x16x32_bf16 v[28:31], v[100:103], v[128:131], v[28:31]
    ds_read_b128 v[48:51], v9 offset:22528
    v_mfma_f32_16x16x32_bf16 v[32:35], v[104:107], v[128:131], v[32:35]
    ds_read_b128 v[52:55], v9 offset:23552
    v_mfma_f32_16x16x32_bf16 v[16:19], v[108:111], v[132:135], v[16:19]
    ds_read_b128 v[56:59], v9 offset:24576
    v_mfma_f32_16x16x32_bf16 v[20:23], v[112:115], v[132:135], v[20:23]
    ds_read_b128 v[84:87], v11 offset:20480
    v_mfma_f32_16x16x32_bf16 v[24:27], v[116:119], v[132:135], v[24:27]
    ds_read_b128 v[60:63], v9 offset:25600
    v_mfma_f32_16x16x32_bf16 v[28:31], v[120:123], v[132:135], v[28:31]
    ds_read_b128 v[64:67], v9 offset:26624
    v_mfma_f32_16x16x32_bf16 v[32:35], v[124:127], v[132:135], v[32:35]
    ds_read_b128 v[68:71], v9 offset:27648
    ds_read_b128 v[72:75], v9 offset:28672
    ds_read_b128 v[76:79], v9 offset:29696
    s_waitcnt lgkmcnt(0)
    s_barrier
    v_mfma_f32_16x16x32_bf16 v[16:19], v[40:43], v[80:83], v[16:19]
    ds_read_b128 v[128:131], v11 offset:24576
    v_mfma_f32_16x16x32_bf16 v[20:23], v[44:47], v[80:83], v[20:23]
    ds_read_b128 v[88:91], v9 offset:30720
    v_mfma_f32_16x16x32_bf16 v[24:27], v[48:51], v[80:83], v[24:27]
    ds_read_b128 v[92:95], v9 offset:31744
    v_mfma_f32_16x16x32_bf16 v[28:31], v[52:55], v[80:83], v[28:31]
    ds_read_b128 v[96:99], v9 offset:32768
    v_mfma_f32_16x16x32_bf16 v[32:35], v[56:59], v[80:83], v[32:35]
    ds_read_b128 v[100:103], v9 offset:33792
    v_mfma_f32_16x16x32_bf16 v[16:19], v[60:63], v[84:87], v[16:19]
    ds_read_b128 v[104:107], v9 offset:34816
    v_mfma_f32_16x16x32_bf16 v[20:23], v[64:67], v[84:87], v[20:23]
    ds_read_b128 v[132:135], v11 offset:28672
    v_mfma_f32_16x16x32_bf16 v[24:27], v[68:71], v[84:87], v[24:27]
    ds_read_b128 v[108:111], v9 offset:35840
    v_mfma_f32_16x16x32_bf16 v[28:31], v[72:75], v[84:87], v[28:31]
    ds_read_b128 v[112:115], v9 offset:36864
    v_mfma_f32_16x16x32_bf16 v[32:35], v[76:79], v[84:87], v[32:35]
    ds_read_b128 v[116:119], v9 offset:37888
    ds_read_b128 v[120:123], v9 offset:38912
    ds_read_b128 v[124:127], v9 offset:39936
    s_waitcnt lgkmcnt(0)
    s_barrier
    v_mfma_f32_16x16x32_bf16 v[16:19], v[88:91], v[128:131], v[16:19]
    ds_read_b128 v[80:83], v11 offset:0
    v_mfma_f32_16x16x32_bf16 v[20:23], v[92:95], v[128:131], v[20:23]
    ds_read_b128 v[40:43], v9 offset:40960
    v_mfma_f32_16x16x32_bf16 v[24:27], v[96:99], v[128:131], v[24:27]
    ds_read_b128 v[44:47], v9 offset:41984
    v_mfma_f32_16x16x32_bf16 v[28:31], v[100:103], v[128:131], v[28:31]
    ds_read_b128 v[48:51], v9 offset:43008
    v_mfma_f32_16x16x32_bf16 v[32:35], v[104:107], v[128:131], v[32:35]
    ds_read_b128 v[52:55], v9 offset:44032
    v_mfma_f32_16x16x32_bf16 v[16:19], v[108:111], v[132:135], v[16:19]
    ds_read_b128 v[56:59], v9 offset:45056
    v_mfma_f32_16x16x32_bf16 v[20:23], v[112:115], v[132:135], v[20:23]
    ds_read_b128 v[84:87], v11 offset:4096
    v_mfma_f32_16x16x32_bf16 v[24:27], v[116:119], v[132:135], v[24:27]
    ds_read_b128 v[60:63], v9 offset:46080
    v_mfma_f32_16x16x32_bf16 v[28:31], v[120:123], v[132:135], v[28:31]
    ds_read_b128 v[64:67], v9 offset:47104
    v_mfma_f32_16x16x32_bf16 v[32:35], v[124:127], v[132:135], v[32:35]
    ds_read_b128 v[68:71], v9 offset:48128
    ds_read_b128 v[72:75], v9 offset:49152
    ds_read_b128 v[76:79], v9 offset:50176
    s_waitcnt lgkmcnt(0)
    s_barrier
    v_mfma_f32_16x16x32_bf16 v[16:19], v[40:43], v[80:83], v[16:19]
    ds_read_b128 v[128:131], v11 offset:8192
    v_mfma_f32_16x16x32_bf16 v[20:23], v[44:47], v[80:83], v[20:23]
    ds_read_b128 v[88:91], v9 offset:51200
    v_mfma_f32_16x16x32_bf16 v[24:27], v[48:51], v[80:83], v[24:27]
    ds_read_b128 v[92:95], v9 offset:52224
    v_mfma_f32_16x16x32_bf16 v[28:31], v[52:55], v[80:83], v[28:31]
    ds_read_b128 v[96:99], v9 offset:53248
    v_mfma_f32_16x16x32_bf16 v[32:35], v[56:59], v[80:83], v[32:35]
    ds_read_b128 v[100:103], v9 offset:54272
    v_mfma_f32_16x16x32_bf16 v[16:19], v[60:63], v[84:87], v[16:19]
    ds_read_b128 v[104:107], v9 offset:55296
    v_mfma_f32_16x16x32_bf16 v[20:23], v[64:67], v[84:87], v[20:23]
    ds_read_b128 v[132:135], v11 offset:12288
    v_mfma_f32_16x16x32_bf16 v[24:27], v[68:71], v[84:87], v[24:27]
    ds_read_b128 v[108:111], v9 offset:56320
    v_mfma_f32_16x16x32_bf16 v[28:31], v[72:75], v[84:87], v[28:31]
    ds_read_b128 v[112:115], v9 offset:57344
    v_mfma_f32_16x16x32_bf16 v[32:35], v[76:79], v[84:87], v[32:35]
    ds_read_b128 v[116:119], v9 offset:58368
    ds_read_b128 v[120:123], v9 offset:59392
    ds_read_b128 v[124:127], v9 offset:60416
    s_waitcnt lgkmcnt(0)
    s_barrier
    v_mfma_f32_16x16x32_bf16 v[16:19], v[88:91], v[128:131], v[16:19]
    ds_read_b128 v[80:83], v11 offset:16384
    v_mfma_f32_16x16x32_bf16 v[20:23], v[92:95], v[128:131], v[20:23]
    ds_read_b128 v[40:43], v9 offset:0
    v_mfma_f32_16x16x32_bf16 v[24:27], v[96:99], v[128:131], v[24:27]
    ds_read_b128 v[44:47], v9 offset:1024
    v_mfma_f32_16x16x32_bf16 v[28:31], v[100:103], v[128:131], v[28:31]
    ds_read_b128 v[48:51], v9 offset:2048
    v_mfma_f32_16x16x32_bf16 v[32:35], v[104:107], v[128:131], v[32:35]
    ds_read_b128 v[52:55], v9 offset:3072
    v_mfma_f32_16x16x32_bf16 v[16:19], v[108:111], v[132:135], v[16:19]
    ds_read_b128 v[56:59], v9 offset:4096
    v_mfma_f32_16x16x32_bf16 v[20:23], v[112:115], v[132:135], v[20:23]
    ds_read_b128 v[84:87], v11 offset:20480
    v_mfma_f32_16x16x32_bf16 v[24:27], v[116:119], v[132:135], v[24:27]
    ds_read_b128 v[60:63], v9 offset:5120
    v_mfma_f32_16x16x32_bf16 v[28:31], v[120:123], v[132:135], v[28:31]
    ds_read_b128 v[64:67], v9 offset:6144
    v_mfma_f32_16x16x32_bf16 v[32:35], v[124:127], v[132:135], v[32:35]
    ds_read_b128 v[68:71], v9 offset:7168
    ds_read_b128 v[72:75], v9 offset:8192
    ds_read_b128 v[76:79], v9 offset:9216
    s_waitcnt lgkmcnt(0)
    s_barrier
    v_mfma_f32_16x16x32_bf16 v[16:19], v[40:43], v[80:83], v[16:19]
    ds_read_b128 v[128:131], v11 offset:24576
    v_mfma_f32_16x16x32_bf16 v[20:23], v[44:47], v[80:83], v[20:23]
    ds_read_b128 v[88:91], v9 offset:10240
    v_mfma_f32_16x16x32_bf16 v[24:27], v[48:51], v[80:83], v[24:27]
    ds_read_b128 v[92:95], v9 offset:11264
    v_mfma_f32_16x16x32_bf16 v[28:31], v[52:55], v[80:83], v[28:31]
    ds_read_b128 v[96:99], v9 offset:12288
    v_mfma_f32_16x16x32_bf16 v[32:35], v[56:59], v[80:83], v[32:35]
    ds_read_b128 v[100:103], v9 offset:13312
    v_mfma_f32_16x16x32_bf16 v[16:19], v[60:63], v[84:87], v[16:19]
    ds_read_b128 v[104:107], v9 offset:14336
    v_mfma_f32_16x16x32_bf16 v[20:23], v[64:67], v[84:87], v[20:23]
    ds_read_b128 v[132:135], v11 offset:28672
    v_mfma_f32_16x16x32_bf16 v[24:27], v[68:71], v[84:87], v[24:27]
    ds_read_b128 v[108:111], v9 offset:15360
    v_mfma_f32_16x16x32_bf16 v[28:31], v[72:75], v[84:87], v[28:31]
    ds_read_b128 v[112:115], v9 offset:16384
    v_mfma_f32_16x16x32_bf16 v[32:35], v[76:79], v[84:87], v[32:35]
    ds_read_b128 v[116:119], v9 offset:17408
    ds_read_b128 v[120:123], v9 offset:18432
    ds_read_b128 v[124:127], v9 offset:19456
    s_waitcnt lgkmcnt(0)
    s_barrier
    v_mfma_f32_16x16x32_bf16 v[16:19], v[88:91], v[128:131], v[16:19]
    ds_read_b128 v[80:83], v11 offset:0
    v_mfma_f32_16x16x32_bf16 v[20:23], v[92:95], v[128:131], v[20:23]
    ds_read_b128 v[40:43], v9 offset:20480
    v_mfma_f32_16x16x32_bf16 v[24:27], v[96:99], v[128:131], v[24:27]
    ds_read_b128 v[44:47], v9 offset:21504
    v_mfma_f32_16x16x32_bf16 v[28:31], v[100:103], v[128:131], v[28:31]
    ds_read_b128 v[48:51], v9 offset:22528
    v_mfma_f32_16x16x32_bf16 v[32:35], v[104:107], v[128:131], v[32:35]
    ds_read_b128 v[52:55], v9 offset:23552
    v_mfma_f32_16x16x32_bf16 v[16:19], v[108:111], v[132:135], v[16:19]
    ds_read_b128 v[56:59], v9 offset:24576
    v_mfma_f32_16x16x32_bf16 v[20:23], v[112:115], v[132:135], v[20:23]
    ds_read_b128 v[84:87], v11 offset:4096
    v_mfma_f32_16x16x32_bf16 v[24:27], v[116:119], v[132:135], v[24:27]
    ds_read_b128 v[60:63], v9 offset:25600
    v_mfma_f32_16x16x32_bf16 v[28:31], v[120:123], v[132:135], v[28:31]
    ds_read_b128 v[64:67], v9 offset:26624
    v_mfma_f32_16x16x32_bf16 v[32:35], v[124:127], v[132:135], v[32:35]
    ds_read_b128 v[68:71], v9 offset:27648
    ds_read_b128 v[72:75], v9 offset:28672
    ds_read_b128 v[76:79], v9 offset:29696
    s_waitcnt lgkmcnt(0)
    s_barrier
    v_mfma_f32_16x16x32_bf16 v[16:19], v[40:43], v[80:83], v[16:19]
    ds_read_b128 v[128:131], v11 offset:8192
    v_mfma_f32_16x16x32_bf16 v[20:23], v[44:47], v[80:83], v[20:23]
    ds_read_b128 v[88:91], v9 offset:30720
    v_mfma_f32_16x16x32_bf16 v[24:27], v[48:51], v[80:83], v[24:27]
    ds_read_b128 v[92:95], v9 offset:31744
    v_mfma_f32_16x16x32_bf16 v[28:31], v[52:55], v[80:83], v[28:31]
    ds_read_b128 v[96:99], v9 offset:32768
    v_mfma_f32_16x16x32_bf16 v[32:35], v[56:59], v[80:83], v[32:35]
    ds_read_b128 v[100:103], v9 offset:33792
    v_mfma_f32_16x16x32_bf16 v[16:19], v[60:63], v[84:87], v[16:19]
    ds_read_b128 v[104:107], v9 offset:34816
    v_mfma_f32_16x16x32_bf16 v[20:23], v[64:67], v[84:87], v[20:23]
    ds_read_b128 v[132:135], v11 offset:12288
    v_mfma_f32_16x16x32_bf16 v[24:27], v[68:71], v[84:87], v[24:27]
    ds_read_b128 v[108:111], v9 offset:35840
    v_mfma_f32_16x16x32_bf16 v[28:31], v[72:75], v[84:87], v[28:31]
    ds_read_b128 v[112:115], v9 offset:36864
    v_mfma_f32_16x16x32_bf16 v[32:35], v[76:79], v[84:87], v[32:35]
    ds_read_b128 v[116:119], v9 offset:37888
    ds_read_b128 v[120:123], v9 offset:38912
    ds_read_b128 v[124:127], v9 offset:39936
    s_waitcnt lgkmcnt(0)
    v_mfma_f32_16x16x32_bf16 v[16:19], v[88:91], v[128:131], v[16:19]
    ds_read_b64 v[136:137], v208 offset:0
    ds_read_b64 v[138:139], v208 offset:32
    v_mfma_f32_16x16x32_bf16 v[20:23], v[92:95], v[128:131], v[20:23]
    ds_read_b64 v[140:141], v208 offset:64
    ds_read_b64 v[142:143], v208 offset:96
    v_mfma_f32_16x16x32_bf16 v[24:27], v[96:99], v[128:131], v[24:27]
    ds_read_b64 v[144:145], v208 offset:128
    ds_read_b128 v[148:151], v209 offset:0
    v_mfma_f32_16x16x32_bf16 v[28:31], v[100:103], v[128:131], v[28:31]
    ds_read_b128 v[152:155], v209 offset:64
    ds_read_b128 v[156:159], v209 offset:128
    v_mfma_f32_16x16x32_bf16 v[32:35], v[104:107], v[128:131], v[32:35]
    ds_read_b128 v[160:163], v209 offset:192
    ds_read_b128 v[164:167], v209 offset:256
    v_mfma_f32_16x16x32_bf16 v[16:19], v[108:111], v[132:135], v[16:19]
    ds_read_b128 v[168:171], v209 offset:1024
    v_mfma_f32_16x16x32_bf16 v[20:23], v[112:115], v[132:135], v[20:23]
    ds_read_b128 v[172:175], v209 offset:1088
    v_mfma_f32_16x16x32_bf16 v[24:27], v[116:119], v[132:135], v[24:27]
    ds_read_b128 v[176:179], v209 offset:1152
    v_mfma_f32_16x16x32_bf16 v[28:31], v[120:123], v[132:135], v[28:31]
    ds_read_b128 v[180:183], v209 offset:1216
    v_mfma_f32_16x16x32_bf16 v[32:35], v[124:127], v[132:135], v[32:35]
    ds_read_b128 v[184:187], v209 offset:1280
    s_waitcnt lgkmcnt(0)
    v_lshlrev_b32 v188, 16, v136
    v_and_b32 v189, 0xffff0000, v136
    v_lshlrev_b32 v190, 16, v137
    v_and_b32 v191, 0xffff0000, v137
    v_lshlrev_b32 v192, 16, v138
    v_and_b32 v193, 0xffff0000, v138
    v_lshlrev_b32 v194, 16, v139
    v_and_b32 v195, 0xffff0000, v139
    v_lshlrev_b32 v196, 16, v140
    v_and_b32 v197, 0xffff0000, v140
    v_lshlrev_b32 v198, 16, v141
    v_and_b32 v199, 0xffff0000, v141
    v_lshlrev_b32 v200, 16, v142
    v_and_b32 v201, 0xffff0000, v142
    v_lshlrev_b32 v202, 16, v143
    v_and_b32 v203, 0xffff0000, v143
    v_lshlrev_b32 v204, 16, v144
    v_and_b32 v205, 0xffff0000, v144
    v_lshlrev_b32 v206, 16, v145
    v_and_b32 v207, 0xffff0000, v145
    v_pk_fma_f32 v[188:189], v[148:149], v[16:17], v[188:189]
    v_pk_fma_f32 v[190:191], v[150:151], v[18:19], v[190:191]
    v_pk_fma_f32 v[192:193], v[152:153], v[20:21], v[192:193]
    v_pk_fma_f32 v[194:195], v[154:155], v[22:23], v[194:195]
    v_pk_fma_f32 v[196:197], v[156:157], v[24:25], v[196:197]
    v_pk_fma_f32 v[198:199], v[158:159], v[26:27], v[198:199]
    v_pk_fma_f32 v[200:201], v[160:161], v[28:29], v[200:201]
    v_pk_fma_f32 v[202:203], v[162:163], v[30:31], v[202:203]
    v_pk_fma_f32 v[204:205], v[164:165], v[32:33], v[204:205]
    v_pk_fma_f32 v[206:207], v[166:167], v[34:35], v[206:207]
    v_pk_mul_f32 v[16:17], v[188:189], v[168:169]
    v_pk_mul_f32 v[18:19], v[190:191], v[170:171]
    v_pk_mul_f32 v[20:21], v[192:193], v[172:173]
    v_pk_mul_f32 v[22:23], v[194:195], v[174:175]
    v_pk_mul_f32 v[24:25], v[196:197], v[176:177]
    v_pk_mul_f32 v[26:27], v[198:199], v[178:179]
    v_pk_mul_f32 v[28:29], v[200:201], v[180:181]
    v_pk_mul_f32 v[30:31], v[202:203], v[182:183]
    v_pk_mul_f32 v[32:33], v[204:205], v[184:185]
    v_pk_mul_f32 v[34:35], v[206:207], v[186:187]
    v_pk_add_f32 v[136:137], v[188:189], v[190:191]
    v_pk_mul_f32 v[140:141], v[188:189], v[188:189]
    v_pk_add_f32 v[138:139], v[192:193], v[194:195]
    v_pk_mul_f32 v[142:143], v[190:191], v[190:191]
    v_cvt_pk_bf16_f32 v148, v16, v17
    v_cvt_pk_bf16_f32 v149, v18, v19
    v_cvt_pk_bf16_f32 v150, v20, v21
    v_cvt_pk_bf16_f32 v151, v22, v23
    v_cvt_pk_bf16_f32 v152, v24, v25
    v_cvt_pk_bf16_f32 v153, v26, v27
    v_cvt_pk_bf16_f32 v154, v28, v29
    v_cvt_pk_bf16_f32 v155, v30, v31
    v_cvt_pk_bf16_f32 v156, v32, v33
    v_cvt_pk_bf16_f32 v157, v34, v35
    s_cmp_eq_u32 s37, 0
    s_cbranch_scc1 kp_s14
    buffer_store_dwordx2 v[148:149], v2, s[8:11], s60 offen
    buffer_store_dwordx2 v[150:151], v2, s[8:11], s61 offen
    buffer_store_dwordx2 v[152:153], v2, s[8:11], s62 offen
    buffer_store_dwordx2 v[154:155], v2, s[8:11], s63 offen
    buffer_store_dwordx2 v[156:157], v2, s[8:11], s64 offen
    s_branch kp_d15
kp_s14:
    buffer_store_dwordx2 v[148:149], v2, s[8:11], s60 offen sc1
    buffer_store_dwordx2 v[150:151], v2, s[8:11], s61 offen sc1
    buffer_store_dwordx2 v[152:153], v2, s[8:11], s62 offen sc1
    buffer_store_dwordx2 v[154:155], v2, s[8:11], s63 offen sc1
    buffer_store_dwordx2 v[156:157], v2, s[8:11], s64 offen sc1
kp_d15:
    v_pk_fma_f32 v[140:141], v[192:193], v[192:193], v[140:141]
    v_pk_fma_f32 v[142:143], v[194:195], v[194:195], v[142:143]
    v_pk_fma_f32 v[140:141], v[196:197], v[196:197], v[140:141]
    v_pk_fma_f32 v[142:143], v[198:199], v[198:199], v[142:143]
    v_pk_add_f32 v[136:137], v[136:137], v[196:197]
    v_pk_add_f32 v[138:139], v[138:139], v[198:199]
    v_pk_fma_f32 v[140:141], v[200:201], v[200:201], v[140:141]
    v_pk_fma_f32 v[142:143], v[202:203], v[202:203], v[142:143]
    v_pk_add_f32 v[136:137], v[136:137], v[200:201]
    v_pk_add_f32 v[138:139], v[138:139], v[202:203]
    v_pk_fma_f32 v[140:141], v[204:205], v[204:205], v[140:141]
    v_pk_fma_f32 v[142:143], v[206:207], v[206:207], v[142:143]
    v_pk_add_f32 v[136:137], v[136:137], v[204:205]
    v_pk_add_f32 v[138:139], v[138:139], v[206:207]
    v_pk_add_f32 v[136:137], v[136:137], v[138:139]
    v_pk_add_f32 v[140:141], v[140:141], v[142:143]
    v_add_f32 v136, v136, v137
    v_add_f32 v137, v140, v141
    v_mov_b32 v138, v136
    v_mov_b32 v139, v137
    s_nop 0
    v_permlane32_swap_b32 v136, v138
    v_permlane32_swap_b32 v137, v139
    v_pk_add_f32 v[136:137], v[136:137], v[138:139]
    v_mov_b32 v138, v136
    v_mov_b32 v139, v137
    s_nop 0
    v_permlane16_swap_b32 v136, v138
    v_permlane16_swap_b32 v137, v139
    v_pk_add_f32 v[136:137], v[136:137], v[138:139]
    v_mul_f32 v138, 0x3c4ccccd, v136
    v_fma_f32 v137, -v136, v138, v137
    v_max_f32 v137, 0, v137
    v_mov_b32 v136, v138
    s_mov_b64 exec, 0xffff
    s_cmp_eq_u32 s37, 0
    s_cbranch_scc1 kp_s16
    buffer_store_dwordx2 v[136:137], v210, s[8:11], s65 offen
    s_branch kp_d17
kp_s16:
    buffer_store_dwordx2 v[136:137], v210, s[8:11], s65 offen sc1
kp_d17:
    s_mov_b64 exec, -1
    s_lshl_b32 s40, s33, 8
    s_lshl_b32 s41, s34, 4
    s_add_u32 s40, s40, s41
    s_lshl_b32 s41, s32, 2
    s_add_u32 s40, s40, s41
    s_add_u32 s40, s40, 26488832
    v_mov_b32 v5, s96
    s_waitcnt vmcnt(0)
    s_mov_b64 exec, 1
    s_cmp_eq_u32 s37, 0
    s_cbranch_scc1 kp_s18
    buffer_store_dword v5, v4, s[8:11], s40 offen
    s_branch kp_d19
kp_s18:
    buffer_store_dword v5, v4, s[8:11], s40 offen sc1
kp_d19:
    s_mov_b64 exec, -1
    v_cvt_pk_bf16_f32 v240, v188, v189
    v_cvt_pk_bf16_f32 v241, v190, v191
    v_cvt_pk_bf16_f32 v242, v192, v193
    v_cvt_pk_bf16_f32 v243, v194, v195
    v_cvt_pk_bf16_f32 v244, v196, v197
    v_cvt_pk_bf16_f32 v245, v198, v199
    v_cvt_pk_bf16_f32 v246, v200, v201
    v_cvt_pk_bf16_f32 v247, v202, v203
    v_cvt_pk_bf16_f32 v248, v204, v205
    v_cvt_pk_bf16_f32 v249, v206, v207
    v_add_u32 v9, 94208, v2
    v_add_u32 v10, 0x10000, v9
    s_lshl_b32 s40, s32, 11
    s_add_u32 s40, s40, 0
    v_add_u32 v11, s40, v2
    v_add_u32 v12, 0x10000, v11
    v_add_u32 v228, 143360, v3
    v_and_b32 v229, 15, v1
    v_lshlrev_b32 v229, 3, v229
    s_lshl_b32 s40, s32, 8
    s_add_u32 s40, s40, 144896
    v_add_u32 v229, s40, v229
    s_mov_b32 s64, 0xbdd2d3e8
    s_mov_b32 s65, 0xbdd2d3e8
    v_mov_b32 v230, 0xc0135761
    v_mov_b32 v231, 0xc0135761
    s_lshl_b32 s60, s33, 1
    s_lshr_b32 s61, s32, 1
    s_add_u32 s60, s60, s61
    s_mul_i32 s60, s60, 48
    s_mul_i32 s61, s34, 3
    s_add_u32 s60, s60, s61
    s_lshl_b32 s60, s60, 12
    s_and_b32 s61, s32, 1
    s_lshl_b32 s61, s61, 11
    s_add_u32 s60, s60, s61
    s_add_u32 s60, s60, 20193280
    s_add_u32 s61, s60, 4096
    s_add_u32 s62, s60, 8192
    s_barrier
    ds_read_b128 v[160:163], v11 offset:0
    ds_read_b128 v[164:167], v11 offset:1024
    ds_read_b128 v[112:115], v9 offset:0
    ds_read_b128 v[116:119], v9 offset:1024
    ds_read_b128 v[120:123], v9 offset:2048
    ds_read_b128 v[124:127], v9 offset:3072
    ds_read_b128 v[128:131], v9 offset:4096
    ds_read_b128 v[132:135], v9 offset:5120
    ds_read_b128 v[136:139], v9 offset:6144
    ds_read_b128 v[140:143], v9 offset:7168
    ds_read_b128 v[144:147], v9 offset:8192
    ds_read_b128 v[148:151], v9 offset:9216
    ds_read_b128 v[152:155], v9 offset:10240
    ds_read_b128 v[156:159], v9 offset:11264
    s_waitcnt lgkmcnt(0)
    s_barrier
    v_mfma_f32_16x16x32_bf16 v[16:19], v[112:115], v[160:163], 0
    ds_read_b128 v[216:219], v11 offset:8192
    v_mfma_f32_16x16x32_bf16 v[64:67], v[112:115], v[164:167], 0
    ds_read_b128 v[220:223], v11 offset:9216
    v_mfma_f32_16x16x32_bf16 v[20:23], v[116:119], v[160:163], 0
    ds_read_b128 v[168:171], v9 offset:12288
    v_mfma_f32_16x16x32_bf16 v[68:71], v[116:119], v[164:167], 0
    ds_read_b128 v[172:175], v9 offset:13312
    v_mfma_f32_16x16x32_bf16 v[24:27], v[120:123], v[160:163], 0
    ds_read_b128 v[176:179], v9 offset:14336
    v_mfma_f32_16x16x32_bf16 v[72:75], v[120:123], v[164:167], 0
    ds_read_b128 v[180:183], v9 offset:15360
    v_mfma_f32_16x16x32_bf16 v[28:31], v[124:127], v[160:163], 0
    ds_read_b128 v[184:187], v9 offset:16384
    v_mfma_f32_16x16x32_bf16 v[76:79], v[124:127], v[164:167], 0
    ds_read_b128 v[188:191], v9 offset:17408
    v_mfma_f32_16x16x32_bf16 v[32:35], v[128:131], v[160:163], 0
    ds_read_b128 v[192:195], v9 offset:18432
    v_mfma_f32_16x16x32_bf16 v[80:83], v[128:131], v[164:167], 0
    ds_read_b128 v[196:199], v9 offset:19456
    v_mfma_f32_16x16x32_bf16 v[36:39], v[132:135], v[160:163], 0
    ds_read_b128 v[200:203], v9 offset:20480
    v_mfma_f32_16x16x32_bf16 v[84:87], v[132:135], v[164:167], 0
    ds_read_b128 v[204:207], v9 offset:21504
    v_mfma_f32_16x16x32_bf16 v[40:43], v[136:139], v[160:163], 0
    ds_read_b128 v[208:211], v9 offset:22528
    v_mfma_f32_16x16x32_bf16 v[88:91], v[136:139], v[164:167], 0
    ds_read_b128 v[212:215], v9 offset:23552
    v_mfma_f32_16x16x32_bf16 v[44:47], v[140:143], v[160:163], 0
    v_mfma_f32_16x16x32_bf16 v[92:95], v[140:143], v[164:167], 0
    v_mfma_f32_16x16x32_bf16 v[48:51], v[144:147], v[160:163], 0
    v_mfma_f32_16x16x32_bf16 v[96:99], v[144:147], v[164:167], 0
    v_mfma_f32_16x16x32_bf16 v[52:55], v[148:151], v[160:163], 0
    v_mfma_f32_16x16x32_bf16 v[100:103], v[148:151], v[164:167], 0
    v_mfma_f32_16x16x32_bf16 v[56:59], v[152:155], v[160:163], 0
    v_mfma_f32_16x16x32_bf16 v[104:107], v[152:155], v[164:167], 0
    v_mfma_f32_16x16x32_bf16 v[60:63], v[156:159], v[160:163], 0
    v_mfma_f32_16x16x32_bf16 v[108:111], v[156:159], v[164:167], 0
    s_waitcnt lgkmcnt(0)
    s_barrier
    v_mfma_f32_16x16x32_bf16 v[16:19], v[168:171], v[216:219], v[16:19]
    ds_read_b128 v[160:163], v11 offset:16384
    v_mfma_f32_16x16x32_bf16 v[64:67], v[168:171], v[220:223], v[64:67]
    ds_read_b128 v[164:167], v11 offset:17408
    v_mfma_f32_16x16x32_bf16 v[20:23], v[172:175], v[216:219], v[20:23]
    ds_read_b128 v[112:115], v9 offset:24576
    v_mfma_f32_16x16x32_bf16 v[68:71], v[172:175], v[220:223], v[68:71]
    ds_read_b128 v[116:119], v9 offset:25600
    v_mfma_f32_16x16x32_bf16 v[24:27], v[176:179], v[216:219], v[24:27]
    ds_read_b128 v[120:123], v9 offset:26624
    v_mfma_f32_16x16x32_bf16 v[72:75], v[176:179], v[220:223], v[72:75]
    ds_read_b128 v[124:127], v9 offset:27648
    v_mfma_f32_16x16x32_bf16 v[28:31], v[180:183], v[216:219], v[28:31]
    ds_read_b128 v[128:131], v9 offset:28672
    v_mfma_f32_16x16x32_bf16 v[76:79], v[180:183], v[220:223], v[76:79]
    ds_read_b128 v[132:135], v9 offset:29696
    v_mfma_f32_16x16x32_bf16 v[32:35], v[184:187], v[216:219], v[32:35]
    ds_read_b128 v[136:139], v9 offset:30720
    v_mfma_f32_16x16x32_bf16 v[80:83], v[184:187], v[220:223], v[80:83]
    ds_read_b128 v[140:143], v9 offset:31744
    v_mfma_f32_16x16x32_bf16 v[36:39], v[188:191], v[216:219], v[36:39]
    ds_read_b128 v[144:147], v9 offset:32768
    v_mfma_f32_16x16x32_bf16 v[84:87], v[188:191], v[220:223], v[84:87]
    ds_read_b128 v[148:151], v9 offset:33792
    v_mfma_f32_16x16x32_bf16 v[40:43], v[192:195], v[216:219], v[40:43]
    ds_read_b128 v[152:155], v9 offset:34816
    v_mfma_f32_16x16x32_bf16 v[88:91], v[192:195], v[220:223], v[88:91]
    ds_read_b128 v[156:159], v9 offset:35840
    v_mfma_f32_16x16x32_bf16 v[44:47], v[196:199], v[216:219], v[44:47]
    v_mfma_f32_16x16x32_bf16 v[92:95], v[196:199], v[220:223], v[92:95]
    v_mfma_f32_16x16x32_bf16 v[48:51], v[200:203], v[216:219], v[48:51]
    v_mfma_f32_16x16x32_bf16 v[96:99], v[200:203], v[220:223], v[96:99]
    v_mfma_f32_16x16x32_bf16 v[52:55], v[204:207], v[216:219], v[52:55]
    v_mfma_f32_16x16x32_bf16 v[100:103], v[204:207], v[220:223], v[100:103]
    v_mfma_f32_16x16x32_bf16 v[56:59], v[208:211], v[216:219], v[56:59]
    v_mfma_f32_16x16x32_bf16 v[104:107], v[208:211], v[220:223], v[104:107]
    v_mfma_f32_16x16x32_bf16 v[60:63], v[212:215], v[216:219], v[60:63]
    v_mfma_f32_16x16x32_bf16 v[108:111], v[212:215], v[220:223], v[108:111]
    s_waitcnt lgkmcnt(0)
    s_barrier
    v_mfma_f32_16x16x32_bf16 v[16:19], v[112:115], v[160:163], v[16:19]
    ds_read_b128 v[216:219], v11 offset:24576
    v_mfma_f32_16x16x32_bf16 v[64:67], v[112:115], v[164:167], v[64:67]
    ds_read_b128 v[220:223], v11 offset:25600
    v_mfma_f32_16x16x32_bf16 v[20:23], v[116:119], v[160:163], v[20:23]
    ds_read_b128 v[168:171], v9 offset:36864
    v_mfma_f32_16x16x32_bf16 v[68:71], v[116:119], v[164:167], v[68:71]
    ds_read_b128 v[172:175], v9 offset:37888
    v_mfma_f32_16x16x32_bf16 v[24:27], v[120:123], v[160:163], v[24:27]
    ds_read_b128 v[176:179], v9 offset:38912
    v_mfma_f32_16x16x32_bf16 v[72:75], v[120:123], v[164:167], v[72:75]
    ds_read_b128 v[180:183], v9 offset:39936
    v_mfma_f32_16x16x32_bf16 v[28:31], v[124:127], v[160:163], v[28:31]
    ds_read_b128 v[184:187], v9 offset:40960
    v_mfma_f32_16x16x32_bf16 v[76:79], v[124:127], v[164:167], v[76:79]
    ds_read_b128 v[188:191], v9 offset:41984
    v_mfma_f32_16x16x32_bf16 v[32:35], v[128:131], v[160:163], v[32:35]
    ds_read_b128 v[192:195], v9 offset:43008
    v_mfma_f32_16x16x32_bf16 v[80:83], v[128:131], v[164:167], v[80:83]
    ds_read_b128 v[196:199], v9 offset:44032
    v_mfma_f32_16x16x32_bf16 v[36:39], v[132:135], v[160:163], v[36:39]
    ds_read_b128 v[200:203], v9 offset:45056
    v_mfma_f32_16x16x32_bf16 v[84:87], v[132:135], v[164:167], v[84:87]
    ds_read_b128 v[204:207], v9 offset:46080
    v_mfma_f32_16x16x32_bf16 v[40:43], v[136:139], v[160:163], v[40:43]
    ds_read_b128 v[208:211], v9 offset:47104
    v_mfma_f32_16x16x32_bf16 v[88:91], v[136:139], v[164:167], v[88:91]
    ds_read_b128 v[212:215], v9 offset:48128
    v_mfma_f32_16x16x32_bf16 v[44:47], v[140:143], v[160:163], v[44:47]
    v_mfma_f32_16x16x32_bf16 v[92:95], v[140:143], v[164:167], v[92:95]
    v_mfma_f32_16x16x32_bf16 v[48:51], v[144:147], v[160:163], v[48:51]
    v_mfma_f32_16x16x32_bf16 v[96:99], v[144:147], v[164:167], v[96:99]
    v_mfma_f32_16x16x32_bf16 v[52:55], v[148:151], v[160:163], v[52:55]
    v_mfma_f32_16x16x32_bf16 v[100:103], v[148:151], v[164:167], v[100:103]
    v_mfma_f32_16x16x32_bf16 v[56:59], v[152:155], v[160:163], v[56:59]
    v_mfma_f32_16x16x32_bf16 v[104:107], v[152:155], v[164:167], v[104:107]
    v_mfma_f32_16x16x32_bf16 v[60:63], v[156:159], v[160:163], v[60:63]
    v_mfma_f32_16x16x32_bf16 v[108:111], v[156:159], v[164:167], v[108:111]
    s_waitcnt lgkmcnt(0)
    s_barrier
    v_mfma_f32_16x16x32_bf16 v[16:19], v[168:171], v[216:219], v[16:19]
    ds_read_b128 v[160:163], v11 offset:0
    v_mfma_f32_16x16x32_bf16 v[64:67], v[168:171], v[220:223], v[64:67]
    ds_read_b128 v[164:167], v11 offset:1024
    v_mfma_f32_16x16x32_bf16 v[20:23], v[172:175], v[216:219], v[20:23]
    ds_read_b128 v[112:115], v9 offset:0
    v_mfma_f32_16x16x32_bf16 v[68:71], v[172:175], v[220:223], v[68:71]
    ds_read_b128 v[116:119], v9 offset:1024
    v_mfma_f32_16x16x32_bf16 v[24:27], v[176:179], v[216:219], v[24:27]
    ds_read_b128 v[120:123], v9 offset:2048
    v_mfma_f32_16x16x32_bf16 v[72:75], v[176:179], v[220:223], v[72:75]
    ds_read_b128 v[124:127], v9 offset:3072
    v_mfma_f32_16x16x32_bf16 v[28:31], v[180:183], v[216:219], v[28:31]
    ds_read_b128 v[128:131], v9 offset:4096
    v_mfma_f32_16x16x32_bf16 v[76:79], v[180:183], v[220:223], v[76:79]
    ds_read_b128 v[132:135], v9 offset:5120
    v_mfma_f32_16x16x32_bf16 v[32:35], v[184:187], v[216:219], v[32:35]
    ds_read_b128 v[136:139], v9 offset:6144
    v_mfma_f32_16x16x32_bf16 v[80:83], v[184:187], v[220:223], v[80:83]
    ds_read_b128 v[140:143], v9 offset:7168
    v_mfma_f32_16x16x32_bf16 v[36:39], v[188:191], v[216:219], v[36:39]
    ds_read_b128 v[144:147], v9 offset:8192
    v_mfma_f32_16x16x32_bf16 v[84:87], v[188:191], v[220:223], v[84:87]
    ds_read_b128 v[148:151], v9 offset:9216
    v_mfma_f32_16x16x32_bf16 v[40:43], v[192:195], v[216:219], v[40:43]
    ds_read_b128 v[152:155], v9 offset:10240
    v_mfma_f32_16x16x32_bf16 v[88:91], v[192:195], v[220:223], v[88:91]
    ds_read_b128 v[156:159], v9 offset:11264
    v_mfma_f32_16x16x32_bf16 v[44:47], v[196:199], v[216:219], v[44:47]
    v_mfma_f32_16x16x32_bf16 v[92:95], v[196:199], v[220:223], v[92:95]
    v_mfma_f32_16x16x32_bf16 v[48:51], v[200:203], v[216:219], v[48:51]
    v_mfma_f32_16x16x32_bf16 v[96:99], v[200:203], v[220:223], v[96:99]
    v_mfma_f32_16x16x32_bf16 v[52:55], v[204:207], v[216:219], v[52:55]
    v_mfma_f32_16x16x32_bf16 v[100:103], v[204:207], v[220:223], v[100:103]
    v_mfma_f32_16x16x32_bf16 v[56:59], v[208:211], v[216:219], v[56:59]
    v_mfma_f32_16x16x32_bf16 v[104:107], v[208:211], v[220:223], v[104:107]
    v_mfma_f32_16x16x32_bf16 v[60:63], v[212:215], v[216:219], v[60:63]
    v_mfma_f32_16x16x32_bf16 v[108:111], v[212:215], v[220:223], v[108:111]
    s_waitcnt lgkmcnt(0)
    s_barrier
    v_mfma_f32_16x16x32_bf16 v[16:19], v[112:115], v[160:163], v[16:19]
    ds_read_b128 v[216:219], v11 offset:8192
    v_mfma_f32_16x16x32_bf16 v[64:67], v[112:115], v[164:167], v[64:67]
    ds_read_b128 v[220:223], v11 offset:9216
    v_mfma_f32_16x16x32_bf16 v[20:23], v[116:119], v[160:163], v[20:23]
    ds_read_b128 v[168:171], v9 offset:12288
    v_mfma_f32_16x16x32_bf16 v[68:71], v[116:119], v[164:167], v[68:71]
    ds_read_b128 v[172:175], v9 offset:13312
    v_mfma_f32_16x16x32_bf16 v[24:27], v[120:123], v[160:163], v[24:27]
    ds_read_b128 v[176:179], v9 offset:14336
    v_mfma_f32_16x16x32_bf16 v[72:75], v[120:123], v[164:167], v[72:75]
    ds_read_b128 v[180:183], v9 offset:15360
    v_mfma_f32_16x16x32_bf16 v[28:31], v[124:127], v[160:163], v[28:31]
    ds_read_b128 v[184:187], v9 offset:16384
    v_mfma_f32_16x16x32_bf16 v[76:79], v[124:127], v[164:167], v[76:79]
    ds_read_b128 v[188:191], v9 offset:17408
    v_mfma_f32_16x16x32_bf16 v[32:35], v[128:131], v[160:163], v[32:35]
    ds_read_b128 v[192:195], v9 offset:18432
    v_mfma_f32_16x16x32_bf16 v[80:83], v[128:131], v[164:167], v[80:83]
    ds_read_b128 v[196:199], v9 offset:19456
    v_mfma_f32_16x16x32_bf16 v[36:39], v[132:135], v[160:163], v[36:39]
    ds_read_b128 v[200:203], v9 offset:20480
    v_mfma_f32_16x16x32_bf16 v[84:87], v[132:135], v[164:167], v[84:87]
    ds_read_b128 v[204:207], v9 offset:21504
    v_mfma_f32_16x16x32_bf16 v[40:43], v[136:139], v[160:163], v[40:43]
    ds_read_b128 v[208:211], v9 offset:22528
    v_mfma_f32_16x16x32_bf16 v[88:91], v[136:139], v[164:167], v[88:91]
    ds_read_b128 v[212:215], v9 offset:23552
    v_mfma_f32_16x16x32_bf16 v[44:47], v[140:143], v[160:163], v[44:47]
    v_mfma_f32_16x16x32_bf16 v[92:95], v[140:143], v[164:167], v[92:95]
    v_mfma_f32_16x16x32_bf16 v[48:51], v[144:147], v[160:163], v[48:51]
    v_mfma_f32_16x16x32_bf16 v[96:99], v[144:147], v[164:167], v[96:99]
    v_mfma_f32_16x16x32_bf16 v[52:55], v[148:151], v[160:163], v[52:55]
    v_mfma_f32_16x16x32_bf16 v[100:103], v[148:151], v[164:167], v[100:103]
    v_mfma_f32_16x16x32_bf16 v[56:59], v[152:155], v[160:163], v[56:59]
    v_mfma_f32_16x16x32_bf16 v[104:107], v[152:155], v[164:167], v[104:107]
    v_mfma_f32_16x16x32_bf16 v[60:63], v[156:159], v[160:163], v[60:63]
    v_mfma_f32_16x16x32_bf16 v[108:111], v[156:159], v[164:167], v[108:111]
    s_waitcnt lgkmcnt(0)
    s_barrier
    v_mfma_f32_16x16x32_bf16 v[16:19], v[168:171], v[216:219], v[16:19]
    ds_read_b128 v[160:163], v11 offset:16384
    v_mfma_f32_16x16x32_bf16 v[64:67], v[168:171], v[220:223], v[64:67]
    ds_read_b128 v[164:167], v11 offset:17408
    v_mfma_f32_16x16x32_bf16 v[20:23], v[172:175], v[216:219], v[20:23]
    ds_read_b128 v[112:115], v9 offset:24576
    v_mfma_f32_16x16x32_bf16 v[68:71], v[172:175], v[220:223], v[68:71]
    ds_read_b128 v[116:119], v9 offset:25600
    v_mfma_f32_16x16x32_bf16 v[24:27], v[176:179], v[216:219], v[24:27]
    ds_read_b128 v[120:123], v9 offset:26624
    v_mfma_f32_16x16x32_bf16 v[72:75], v[176:179], v[220:223], v[72:75]
    ds_read_b128 v[124:127], v9 offset:27648
    v_mfma_f32_16x16x32_bf16 v[28:31], v[180:183], v[216:219], v[28:31]
    ds_read_b128 v[128:131], v9 offset:28672
    v_mfma_f32_16x16x32_bf16 v[76:79], v[180:183], v[220:223], v[76:79]
    ds_read_b128 v[132:135], v9 offset:29696
    v_mfma_f32_16x16x32_bf16 v[32:35], v[184:187], v[216:219], v[32:35]
    ds_read_b128 v[136:139], v9 offset:30720
    v_mfma_f32_16x16x32_bf16 v[80:83], v[184:187], v[220:223], v[80:83]
    ds_read_b128 v[140:143], v9 offset:31744
    v_mfma_f32_16x16x32_bf16 v[36:39], v[188:191], v[216:219], v[36:39]
    ds_read_b128 v[144:147], v9 offset:32768
    v_mfma_f32_16x16x32_bf16 v[84:87], v[188:191], v[220:223], v[84:87]
    ds_read_b128 v[148:151], v9 offset:33792
    v_mfma_f32_16x16x32_bf16 v[40:43], v[192:195], v[216:219], v[40:43]
    ds_read_b128 v[152:155], v9 offset:34816
    v_mfma_f32_16x16x32_bf16 v[88:91], v[192:195], v[220:223], v[88:91]
    ds_read_b128 v[156:159], v9 offset:35840
    v_mfma_f32_16x16x32_bf16 v[44:47], v[196:199], v[216:219], v[44:47]
    v_mfma_f32_16x16x32_bf16 v[92:95], v[196:199], v[220:223], v[92:95]
    v_mfma_f32_16x16x32_bf16 v[48:51], v[200:203], v[216:219], v[48:51]
    v_mfma_f32_16x16x32_bf16 v[96:99], v[200:203], v[220:223], v[96:99]
    v_mfma_f32_16x16x32_bf16 v[52:55], v[204:207], v[216:219], v[52:55]
    v_mfma_f32_16x16x32_bf16 v[100:103], v[204:207], v[220:223], v[100:103]
    v_mfma_f32_16x16x32_bf16 v[56:59], v[208:211], v[216:219], v[56:59]
    v_mfma_f32_16x16x32_bf16 v[104:107], v[208:211], v[220:223], v[104:107]
    v_mfma_f32_16x16x32_bf16 v[60:63], v[212:215], v[216:219], v[60:63]
    v_mfma_f32_16x16x32_bf16 v[108:111], v[212:215], v[220:223], v[108:111]
    s_waitcnt lgkmcnt(0)
    s_barrier
    v_mfma_f32_16x16x32_bf16 v[16:19], v[112:115], v[160:163], v[16:19]
    ds_read_b128 v[216:219], v11 offset:24576
    v_mfma_f32_16x16x32_bf16 v[64:67], v[112:115], v[164:167], v[64:67]
    ds_read_b128 v[220:223], v11 offset:25600
    v_mfma_f32_16x16x32_bf16 v[20:23], v[116:119], v[160:163], v[20:23]
    ds_read_b128 v[168:171], v9 offset:36864
    v_mfma_f32_16x16x32_bf16 v[68:71], v[116:119], v[164:167], v[68:71]
    ds_read_b128 v[172:175], v9 offset:37888
    v_mfma_f32_16x16x32_bf16 v[24:27], v[120:123], v[160:163], v[24:27]
    ds_read_b128 v[176:179], v9 offset:38912
    v_mfma_f32_16x16x32_bf16 v[72:75], v[120:123], v[164:167], v[72:75]
    ds_read_b128 v[180:183], v9 offset:39936
    v_mfma_f32_16x16x32_bf16 v[28:31], v[124:127], v[160:163], v[28:31]
    ds_read_b128 v[184:187], v9 offset:40960
    v_mfma_f32_16x16x32_bf16 v[76:79], v[124:127], v[164:167], v[76:79]
    ds_read_b128 v[188:191], v9 offset:41984
    v_mfma_f32_16x16x32_bf16 v[32:35], v[128:131], v[160:163], v[32:35]
    ds_read_b128 v[192:195], v9 offset:43008
    v_mfma_f32_16x16x32_bf16 v[80:83], v[128:131], v[164:167], v[80:83]
    ds_read_b128 v[196:199], v9 offset:44032
    v_mfma_f32_16x16x32_bf16 v[36:39], v[132:135], v[160:163], v[36:39]
    ds_read_b128 v[200:203], v9 offset:45056
    v_mfma_f32_16x16x32_bf16 v[84:87], v[132:135], v[164:167], v[84:87]
    ds_read_b128 v[204:207], v9 offset:46080
    v_mfma_f32_16x16x32_bf16 v[40:43], v[136:139], v[160:163], v[40:43]
    ds_read_b128 v[208:211], v9 offset:47104
    v_mfma_f32_16x16x32_bf16 v[88:91], v[136:139], v[164:167], v[88:91]
    ds_read_b128 v[212:215], v9 offset:48128
    v_mfma_f32_16x16x32_bf16 v[44:47], v[140:143], v[160:163], v[44:47]
    v_mfma_f32_16x16x32_bf16 v[92:95], v[140:143], v[164:167], v[92:95]
    v_mfma_f32_16x16x32_bf16 v[48:51], v[144:147], v[160:163], v[48:51]
    v_mfma_f32_16x16x32_bf16 v[96:99], v[144:147], v[164:167], v[96:99]
    v_mfma_f32_16x16x32_bf16 v[52:55], v[148:151], v[160:163], v[52:55]
    v_mfma_f32_16x16x32_bf16 v[100:103], v[148:151], v[164:167], v[100:103]
    v_mfma_f32_16x16x32_bf16 v[56:59], v[152:155], v[160:163], v[56:59]
    v_mfma_f32_16x16x32_bf16 v[104:107], v[152:155], v[164:167], v[104:107]
    v_mfma_f32_16x16x32_bf16 v[60:63], v[156:159], v[160:163], v[60:63]
    v_mfma_f32_16x16x32_bf16 v[108:111], v[156:159], v[164:167], v[108:111]
    s_waitcnt lgkmcnt(0)
    s_barrier
    v_mfma_f32_16x16x32_bf16 v[16:19], v[168:171], v[216:219], v[16:19]
    ds_read_b128 v[160:163], v11 offset:0
    v_mfma_f32_16x16x32_bf16 v[64:67], v[168:171], v[220:223], v[64:67]
    ds_read_b128 v[164:167], v11 offset:1024
    v_mfma_f32_16x16x32_bf16 v[20:23], v[172:175], v[216:219], v[20:23]
    ds_read_b128 v[112:115], v9 offset:0
    v_mfma_f32_16x16x32_bf16 v[68:71], v[172:175], v[220:223], v[68:71]
    ds_read_b128 v[116:119], v9 offset:1024
    v_mfma_f32_16x16x32_bf16 v[24:27], v[176:179], v[216:219], v[24:27]
    ds_read_b128 v[120:123], v9 offset:2048
    v_mfma_f32_16x16x32_bf16 v[72:75], v[176:179], v[220:223], v[72:75]
    ds_read_b128 v[124:127], v9 offset:3072
    v_mfma_f32_16x16x32_bf16 v[28:31], v[180:183], v[216:219], v[28:31]
    ds_read_b128 v[128:131], v9 offset:4096
    v_mfma_f32_16x16x32_bf16 v[76:79], v[180:183], v[220:223], v[76:79]
    ds_read_b128 v[132:135], v9 offset:5120
    v_mfma_f32_16x16x32_bf16 v[32:35], v[184:187], v[216:219], v[32:35]
    ds_read_b128 v[136:139], v9 offset:6144
    v_mfma_f32_16x16x32_bf16 v[80:83], v[184:187], v[220:223], v[80:83]
    ds_read_b128 v[140:143], v9 offset:7168
    v_mfma_f32_16x16x32_bf16 v[36:39], v[188:191], v[216:219], v[36:39]
    ds_read_b128 v[144:147], v9 offset:8192
    v_mfma_f32_16x16x32_bf16 v[84:87], v[188:191], v[220:223], v[84:87]
    ds_read_b128 v[148:151], v9 offset:9216
    v_mfma_f32_16x16x32_bf16 v[40:43], v[192:195], v[216:219], v[40:43]
    ds_read_b128 v[152:155], v9 offset:10240
    v_mfma_f32_16x16x32_bf16 v[88:91], v[192:195], v[220:223], v[88:91]
    ds_read_b128 v[156:159], v9 offset:11264
    v_mfma_f32_16x16x32_bf16 v[44:47], v[196:199], v[216:219], v[44:47]
    v_mfma_f32_16x16x32_bf16 v[92:95], v[196:199], v[220:223], v[92:95]
    v_mfma_f32_16x16x32_bf16 v[48:51], v[200:203], v[216:219], v[48:51]
    v_mfma_f32_16x16x32_bf16 v[96:99], v[200:203], v[220:223], v[96:99]
    v_mfma_f32_16x16x32_bf16 v[52:55], v[204:207], v[216:219], v[52:55]
    v_mfma_f32_16x16x32_bf16 v[100:103], v[204:207], v[220:223], v[100:103]
    v_mfma_f32_16x16x32_bf16 v[56:59], v[208:211], v[216:219], v[56:59]
    v_mfma_f32_16x16x32_bf16 v[104:107], v[208:211], v[220:223], v[104:107]
    v_mfma_f32_16x16x32_bf16 v[60:63], v[212:215], v[216:219], v[60:63]
    v_mfma_f32_16x16x32_bf16 v[108:111], v[212:215], v[220:223], v[108:111]
    s_waitcnt lgkmcnt(0)
    s_barrier
    v_mfma_f32_16x16x32_bf16 v[16:19], v[112:115], v[160:163], v[16:19]
    ds_read_b128 v[216:219], v11 offset:8192
    v_mfma_f32_16x16x32_bf16 v[64:67], v[112:115], v[164:167], v[64:67]
    ds_read_b128 v[220:223], v11 offset:9216
    v_mfma_f32_16x16x32_bf16 v[20:23], v[116:119], v[160:163], v[20:23]
    ds_read_b128 v[168:171], v9 offset:12288
    v_mfma_f32_16x16x32_bf16 v[68:71], v[116:119], v[164:167], v[68:71]
    ds_read_b128 v[172:175], v9 offset:13312
    v_mfma_f32_16x16x32_bf16 v[24:27], v[120:123], v[160:163], v[24:27]
    ds_read_b128 v[176:179], v9 offset:14336
    v_mfma_f32_16x16x32_bf16 v[72:75], v[120:123], v[164:167], v[72:75]
    ds_read_b128 v[180:183], v9 offset:15360
    v_mfma_f32_16x16x32_bf16 v[28:31], v[124:127], v[160:163], v[28:31]
    ds_read_b128 v[184:187], v9 offset:16384
    v_mfma_f32_16x16x32_bf16 v[76:79], v[124:127], v[164:167], v[76:79]
    ds_read_b128 v[188:191], v9 offset:17408
    v_mfma_f32_16x16x32_bf16 v[32:35], v[128:131], v[160:163], v[32:35]
    ds_read_b128 v[192:195], v9 offset:18432
    v_mfma_f32_16x16x32_bf16 v[80:83], v[128:131], v[164:167], v[80:83]
    ds_read_b128 v[196:199], v9 offset:19456
    v_mfma_f32_16x16x32_bf16 v[36:39], v[132:135], v[160:163], v[36:39]
    ds_read_b128 v[200:203], v9 offset:20480
    v_mfma_f32_16x16x32_bf16 v[84:87], v[132:135], v[164:167], v[84:87]
    ds_read_b128 v[204:207], v9 offset:21504
    v_mfma_f32_16x16x32_bf16 v[40:43], v[136:139], v[160:163], v[40:43]
    ds_read_b128 v[208:211], v9 offset:22528
    v_mfma_f32_16x16x32_bf16 v[88:91], v[136:139], v[164:167], v[88:91]
    ds_read_b128 v[212:215], v9 offset:23552
    v_mfma_f32_16x16x32_bf16 v[44:47], v[140:143], v[160:163], v[44:47]
    v_mfma_f32_16x16x32_bf16 v[92:95], v[140:143], v[164:167], v[92:95]
    v_mfma_f32_16x16x32_bf16 v[48:51], v[144:147], v[160:163], v[48:51]
    v_mfma_f32_16x16x32_bf16 v[96:99], v[144:147], v[164:167], v[96:99]
    v_mfma_f32_16x16x32_bf16 v[52:55], v[148:151], v[160:163], v[52:55]
    v_mfma_f32_16x16x32_bf16 v[100:103], v[148:151], v[164:167], v[100:103]
    v_mfma_f32_16x16x32_bf16 v[56:59], v[152:155], v[160:163], v[56:59]
    v_mfma_f32_16x16x32_bf16 v[104:107], v[152:155], v[164:167], v[104:107]
    v_mfma_f32_16x16x32_bf16 v[60:63], v[156:159], v[160:163], v[60:63]
    v_mfma_f32_16x16x32_bf16 v[108:111], v[156:159], v[164:167], v[108:111]
    s_waitcnt lgkmcnt(0)
    s_barrier
    v_mfma_f32_16x16x32_bf16 v[16:19], v[168:171], v[216:219], v[16:19]
    ds_read_b128 v[160:163], v11 offset:16384
    v_mfma_f32_16x16x32_bf16 v[64:67], v[168:171], v[220:223], v[64:67]
    ds_read_b128 v[164:167], v11 offset:17408
    v_mfma_f32_16x16x32_bf16 v[20:23], v[172:175], v[216:219], v[20:23]
    ds_read_b128 v[112:115], v9 offset:24576
    v_mfma_f32_16x16x32_bf16 v[68:71], v[172:175], v[220:223], v[68:71]
    ds_read_b128 v[116:119], v9 offset:25600
    v_mfma_f32_16x16x32_bf16 v[24:27], v[176:179], v[216:219], v[24:27]
    ds_read_b128 v[120:123], v9 offset:26624
    v_mfma_f32_16x16x32_bf16 v[72:75], v[176:179], v[220:223], v[72:75]
    ds_read_b128 v[124:127], v9 offset:27648
    v_mfma_f32_16x16x32_bf16 v[28:31], v[180:183], v[216:219], v[28:31]
    ds_read_b128 v[128:131], v9 offset:28672
    v_mfma_f32_16x16x32_bf16 v[76:79], v[180:183], v[220:223], v[76:79]
    ds_read_b128 v[132:135], v9 offset:29696
    v_mfma_f32_16x16x32_bf16 v[32:35], v[184:187], v[216:219], v[32:35]
    ds_read_b128 v[136:139], v9 offset:30720
    v_mfma_f32_16x16x32_bf16 v[80:83], v[184:187], v[220:223], v[80:83]
    ds_read_b128 v[140:143], v9 offset:31744
    v_mfma_f32_16x16x32_bf16 v[36:39], v[188:191], v[216:219], v[36:39]
    ds_read_b128 v[144:147], v9 offset:32768
    v_mfma_f32_16x16x32_bf16 v[84:87], v[188:191], v[220:223], v[84:87]
    ds_read_b128 v[148:151], v9 offset:33792
    v_mfma_f32_16x16x32_bf16 v[40:43], v[192:195], v[216:219], v[40:43]
    ds_read_b128 v[152:155], v9 offset:34816
    v_mfma_f32_16x16x32_bf16 v[88:91], v[192:195], v[220:223], v[88:91]
    ds_read_b128 v[156:159], v9 offset:35840
    v_mfma_f32_16x16x32_bf16 v[44:47], v[196:199], v[216:219], v[44:47]
    v_mfma_f32_16x16x32_bf16 v[92:95], v[196:199], v[220:223], v[92:95]
    v_mfma_f32_16x16x32_bf16 v[48:51], v[200:203], v[216:219], v[48:51]
    v_mfma_f32_16x16x32_bf16 v[96:99], v[200:203], v[220:223], v[96:99]
    v_mfma_f32_16x16x32_bf16 v[52:55], v[204:207], v[216:219], v[52:55]
    v_mfma_f32_16x16x32_bf16 v[100:103], v[204:207], v[220:223], v[100:103]
    v_mfma_f32_16x16x32_bf16 v[56:59], v[208:211], v[216:219], v[56:59]
    v_mfma_f32_16x16x32_bf16 v[104:107], v[208:211], v[220:223], v[104:107]
    v_mfma_f32_16x16x32_bf16 v[60:63], v[212:215], v[216:219], v[60:63]
    v_mfma_f32_16x16x32_bf16 v[108:111], v[212:215], v[220:223], v[108:111]
    s_waitcnt lgkmcnt(0)
    s_barrier
    v_mfma_f32_16x16x32_bf16 v[16:19], v[112:115], v[160:163], v[16:19]
    ds_read_b128 v[216:219], v11 offset:24576
    v_mfma_f32_16x16x32_bf16 v[64:67], v[112:115], v[164:167], v[64:67]
    ds_read_b128 v[220:223], v11 offset:25600
    v_mfma_f32_16x16x32_bf16 v[20:23], v[116:119], v[160:163], v[20:23]
    ds_read_b128 v[168:171], v9 offset:36864
    v_mfma_f32_16x16x32_bf16 v[68:71], v[116:119], v[164:167], v[68:71]
    ds_read_b128 v[172:175], v9 offset:37888
    v_mfma_f32_16x16x32_bf16 v[24:27], v[120:123], v[160:163], v[24:27]
    ds_read_b128 v[176:179], v9 offset:38912
    v_mfma_f32_16x16x32_bf16 v[72:75], v[120:123], v[164:167], v[72:75]
    ds_read_b128 v[180:183], v9 offset:39936
    v_mfma_f32_16x16x32_bf16 v[28:31], v[124:127], v[160:163], v[28:31]
    ds_read_b128 v[184:187], v9 offset:40960
    v_mfma_f32_16x16x32_bf16 v[76:79], v[124:127], v[164:167], v[76:79]
    ds_read_b128 v[188:191], v9 offset:41984
    v_mfma_f32_16x16x32_bf16 v[32:35], v[128:131], v[160:163], v[32:35]
    ds_read_b128 v[192:195], v9 offset:43008
    v_mfma_f32_16x16x32_bf16 v[80:83], v[128:131], v[164:167], v[80:83]
    ds_read_b128 v[196:199], v9 offset:44032
    v_mfma_f32_16x16x32_bf16 v[36:39], v[132:135], v[160:163], v[36:39]
    ds_read_b128 v[200:203], v9 offset:45056
    v_mfma_f32_16x16x32_bf16 v[84:87], v[132:135], v[164:167], v[84:87]
    ds_read_b128 v[204:207], v9 offset:46080
    v_mfma_f32_16x16x32_bf16 v[40:43], v[136:139], v[160:163], v[40:43]
    ds_read_b128 v[208:211], v9 offset:47104
    v_mfma_f32_16x16x32_bf16 v[88:91], v[136:139], v[164:167], v[88:91]
    ds_read_b128 v[212:215], v9 offset:48128
    v_mfma_f32_16x16x32_bf16 v[44:47], v[140:143], v[160:163], v[44:47]
    v_mfma_f32_16x16x32_bf16 v[92:95], v[140:143], v[164:167], v[92:95]
    v_mfma_f32_16x16x32_bf16 v[48:51], v[144:147], v[160:163], v[48:51]
    v_mfma_f32_16x16x32_bf16 v[96:99], v[144:147], v[164:167], v[96:99]
    v_mfma_f32_16x16x32_bf16 v[52:55], v[148:151], v[160:163], v[52:55]
    v_mfma_f32_16x16x32_bf16 v[100:103], v[148:151], v[164:167], v[100:103]
    v_mfma_f32_16x16x32_bf16 v[56:59], v[152:155], v[160:163], v[56:59]
    v_mfma_f32_16x16x32_bf16 v[104:107], v[152:155], v[164:167], v[104:107]
    v_mfma_f32_16x16x32_bf16 v[60:63], v[156:159], v[160:163], v[60:63]
    v_mfma_f32_16x16x32_bf16 v[108:111], v[156:159], v[164:167], v[108:111]
    s_waitcnt lgkmcnt(0)
    s_barrier
    v_mfma_f32_16x16x32_bf16 v[16:19], v[168:171], v[216:219], v[16:19]
    ds_read_b128 v[160:163], v11 offset:0
    v_mfma_f32_16x16x32_bf16 v[64:67], v[168:171], v[220:223], v[64:67]
    ds_read_b128 v[164:167], v11 offset:1024
    v_mfma_f32_16x16x32_bf16 v[20:23], v[172:175], v[216:219], v[20:23]
    ds_read_b128 v[112:115], v9 offset:0
    v_mfma_f32_16x16x32_bf16 v[68:71], v[172:175], v[220:223], v[68:71]
    ds_read_b128 v[116:119], v9 offset:1024
    v_mfma_f32_16x16x32_bf16 v[24:27], v[176:179], v[216:219], v[24:27]
    ds_read_b128 v[120:123], v9 offset:2048
    v_mfma_f32_16x16x32_bf16 v[72:75], v[176:179], v[220:223], v[72:75]
    ds_read_b128 v[124:127], v9 offset:3072
    v_mfma_f32_16x16x32_bf16 v[28:31], v[180:183], v[216:219], v[28:31]
    ds_read_b128 v[128:131], v9 offset:4096
    v_mfma_f32_16x16x32_bf16 v[76:79], v[180:183], v[220:223], v[76:79]
    ds_read_b128 v[132:135], v9 offset:5120
    v_mfma_f32_16x16x32_bf16 v[32:35], v[184:187], v[216:219], v[32:35]
    ds_read_b128 v[136:139], v9 offset:6144
    v_mfma_f32_16x16x32_bf16 v[80:83], v[184:187], v[220:223], v[80:83]
    ds_read_b128 v[140:143], v9 offset:7168
    v_mfma_f32_16x16x32_bf16 v[36:39], v[188:191], v[216:219], v[36:39]
    ds_read_b128 v[144:147], v9 offset:8192
    v_mfma_f32_16x16x32_bf16 v[84:87], v[188:191], v[220:223], v[84:87]
    ds_read_b128 v[148:151], v9 offset:9216
    v_mfma_f32_16x16x32_bf16 v[40:43], v[192:195], v[216:219], v[40:43]
    ds_read_b128 v[152:155], v9 offset:10240
    v_mfma_f32_16x16x32_bf16 v[88:91], v[192:195], v[220:223], v[88:91]
    ds_read_b128 v[156:159], v9 offset:11264
    v_mfma_f32_16x16x32_bf16 v[44:47], v[196:199], v[216:219], v[44:47]
    v_mfma_f32_16x16x32_bf16 v[92:95], v[196:199], v[220:223], v[92:95]
    v_mfma_f32_16x16x32_bf16 v[48:51], v[200:203], v[216:219], v[48:51]
    v_mfma_f32_16x16x32_bf16 v[96:99], v[200:203], v[220:223], v[96:99]
    v_mfma_f32_16x16x32_bf16 v[52:55], v[204:207], v[216:219], v[52:55]
    v_mfma_f32_16x16x32_bf16 v[100:103], v[204:207], v[220:223], v[100:103]
    v_mfma_f32_16x16x32_bf16 v[56:59], v[208:211], v[216:219], v[56:59]
    v_mfma_f32_16x16x32_bf16 v[104:107], v[208:211], v[220:223], v[104:107]
    v_mfma_f32_16x16x32_bf16 v[60:63], v[212:215], v[216:219], v[60:63]
    v_mfma_f32_16x16x32_bf16 v[108:111], v[212:215], v[220:223], v[108:111]
    s_waitcnt lgkmcnt(0)
    s_barrier
    v_mfma_f32_16x16x32_bf16 v[16:19], v[112:115], v[160:163], v[16:19]
    ds_read_b128 v[216:219], v11 offset:8192
    v_mfma_f32_16x16x32_bf16 v[64:67], v[112:115], v[164:167], v[64:67]
    ds_read_b128 v[220:223], v11 offset:9216
    v_mfma_f32_16x16x32_bf16 v[20:23], v[116:119], v[160:163], v[20:23]
    ds_read_b128 v[168:171], v9 offset:12288
    v_mfma_f32_16x16x32_bf16 v[68:71], v[116:119], v[164:167], v[68:71]
    ds_read_b128 v[172:175], v9 offset:13312
    v_mfma_f32_16x16x32_bf16 v[24:27], v[120:123], v[160:163], v[24:27]
    ds_read_b128 v[176:179], v9 offset:14336
    v_mfma_f32_16x16x32_bf16 v[72:75], v[120:123], v[164:167], v[72:75]
    ds_read_b128 v[180:183], v9 offset:15360
    v_mfma_f32_16x16x32_bf16 v[28:31], v[124:127], v[160:163], v[28:31]
    ds_read_b128 v[184:187], v9 offset:16384
    v_mfma_f32_16x16x32_bf16 v[76:79], v[124:127], v[164:167], v[76:79]
    ds_read_b128 v[188:191], v9 offset:17408
    v_mfma_f32_16x16x32_bf16 v[32:35], v[128:131], v[160:163], v[32:35]
    ds_read_b128 v[192:195], v9 offset:18432
    v_mfma_f32_16x16x32_bf16 v[80:83], v[128:131], v[164:167], v[80:83]
    ds_read_b128 v[196:199], v9 offset:19456
    v_mfma_f32_16x16x32_bf16 v[36:39], v[132:135], v[160:163], v[36:39]
    ds_read_b128 v[200:203], v9 offset:20480
    v_mfma_f32_16x16x32_bf16 v[84:87], v[132:135], v[164:167], v[84:87]
    ds_read_b128 v[204:207], v9 offset:21504
    v_mfma_f32_16x16x32_bf16 v[40:43], v[136:139], v[160:163], v[40:43]
    ds_read_b128 v[208:211], v9 offset:22528
    v_mfma_f32_16x16x32_bf16 v[88:91], v[136:139], v[164:167], v[88:91]
    ds_read_b128 v[212:215], v9 offset:23552
    v_mfma_f32_16x16x32_bf16 v[44:47], v[140:143], v[160:163], v[44:47]
    v_mfma_f32_16x16x32_bf16 v[92:95], v[140:143], v[164:167], v[92:95]
    v_mfma_f32_16x16x32_bf16 v[48:51], v[144:147], v[160:163], v[48:51]
    v_mfma_f32_16x16x32_bf16 v[96:99], v[144:147], v[164:167], v[96:99]
    v_mfma_f32_16x16x32_bf16 v[52:55], v[148:151], v[160:163], v[52:55]
    v_mfma_f32_16x16x32_bf16 v[100:103], v[148:151], v[164:167], v[100:103]
    v_mfma_f32_16x16x32_bf16 v[56:59], v[152:155], v[160:163], v[56:59]
    v_mfma_f32_16x16x32_bf16 v[104:107], v[152:155], v[164:167], v[104:107]
    v_mfma_f32_16x16x32_bf16 v[60:63], v[156:159], v[160:163], v[60:63]
    v_mfma_f32_16x16x32_bf16 v[108:111], v[156:159], v[164:167], v[108:111]
    s_waitcnt lgkmcnt(0)
    s_barrier
    v_mfma_f32_16x16x32_bf16 v[16:19], v[168:171], v[216:219], v[16:19]
    ds_read_b128 v[160:163], v11 offset:16384
    v_mfma_f32_16x16x32_bf16 v[64:67], v[168:171], v[220:223], v[64:67]
    ds_read_b128 v[164:167], v11 offset:17408
    v_mfma_f32_16x16x32_bf16 v[20:23], v[172:175], v[216:219], v[20:23]
    ds_read_b128 v[112:115], v9 offset:24576
    v_mfma_f32_16x16x32_bf16 v[68:71], v[172:175], v[220:223], v[68:71]
    ds_read_b128 v[116:119], v9 offset:25600
    v_mfma_f32_16x16x32_bf16 v[24:27], v[176:179], v[216:219], v[24:27]
    ds_read_b128 v[120:123], v9 offset:26624
    v_mfma_f32_16x16x32_bf16 v[72:75], v[176:179], v[220:223], v[72:75]
    ds_read_b128 v[124:127], v9 offset:27648
    v_mfma_f32_16x16x32_bf16 v[28:31], v[180:183], v[216:219], v[28:31]
    ds_read_b128 v[128:131], v9 offset:28672
    v_mfma_f32_16x16x32_bf16 v[76:79], v[180:183], v[220:223], v[76:79]
    ds_read_b128 v[132:135], v9 offset:29696
    v_mfma_f32_16x16x32_bf16 v[32:35], v[184:187], v[216:219], v[32:35]
    ds_read_b128 v[136:139], v9 offset:30720
    v_mfma_f32_16x16x32_bf16 v[80:83], v[184:187], v[220:223], v[80:83]
    ds_read_b128 v[140:143], v9 offset:31744
    v_mfma_f32_16x16x32_bf16 v[36:39], v[188:191], v[216:219], v[36:39]
    ds_read_b128 v[144:147], v9 offset:32768
    v_mfma_f32_16x16x32_bf16 v[84:87], v[188:191], v[220:223], v[84:87]
    ds_read_b128 v[148:151], v9 offset:33792
    v_mfma_f32_16x16x32_bf16 v[40:43], v[192:195], v[216:219], v[40:43]
    ds_read_b128 v[152:155], v9 offset:34816
    v_mfma_f32_16x16x32_bf16 v[88:91], v[192:195], v[220:223], v[88:91]
    ds_read_b128 v[156:159], v9 offset:35840
    v_mfma_f32_16x16x32_bf16 v[44:47], v[196:199], v[216:219], v[44:47]
    v_mfma_f32_16x16x32_bf16 v[92:95], v[196:199], v[220:223], v[92:95]
    v_mfma_f32_16x16x32_bf16 v[48:51], v[200:203], v[216:219], v[48:51]
    v_mfma_f32_16x16x32_bf16 v[96:99], v[200:203], v[220:223], v[96:99]
    v_mfma_f32_16x16x32_bf16 v[52:55], v[204:207], v[216:219], v[52:55]
    v_mfma_f32_16x16x32_bf16 v[100:103], v[204:207], v[220:223], v[100:103]
    v_mfma_f32_16x16x32_bf16 v[56:59], v[208:211], v[216:219], v[56:59]
    v_mfma_f32_16x16x32_bf16 v[104:107], v[208:211], v[220:223], v[104:107]
    v_mfma_f32_16x16x32_bf16 v[60:63], v[212:215], v[216:219], v[60:63]
    v_mfma_f32_16x16x32_bf16 v[108:111], v[212:215], v[220:223], v[108:111]
    s_waitcnt lgkmcnt(0)
    s_barrier
    v_mfma_f32_16x16x32_bf16 v[16:19], v[112:115], v[160:163], v[16:19]
    ds_read_b128 v[216:219], v11 offset:24576
    v_mfma_f32_16x16x32_bf16 v[64:67], v[112:115], v[164:167], v[64:67]
    ds_read_b128 v[220:223], v11 offset:25600
    v_mfma_f32_16x16x32_bf16 v[20:23], v[116:119], v[160:163], v[20:23]
    ds_read_b128 v[168:171], v9 offset:36864
    v_mfma_f32_16x16x32_bf16 v[68:71], v[116:119], v[164:167], v[68:71]
    ds_read_b128 v[172:175], v9 offset:37888
    v_mfma_f32_16x16x32_bf16 v[24:27], v[120:123], v[160:163], v[24:27]
    ds_read_b128 v[176:179], v9 offset:38912
    v_mfma_f32_16x16x32_bf16 v[72:75], v[120:123], v[164:167], v[72:75]
    ds_read_b128 v[180:183], v9 offset:39936
    v_mfma_f32_16x16x32_bf16 v[28:31], v[124:127], v[160:163], v[28:31]
    ds_read_b128 v[184:187], v9 offset:40960
    v_mfma_f32_16x16x32_bf16 v[76:79], v[124:127], v[164:167], v[76:79]
    ds_read_b128 v[188:191], v9 offset:41984
    v_mfma_f32_16x16x32_bf16 v[32:35], v[128:131], v[160:163], v[32:35]
    ds_read_b128 v[192:195], v9 offset:43008
    v_mfma_f32_16x16x32_bf16 v[80:83], v[128:131], v[164:167], v[80:83]
    ds_read_b128 v[196:199], v9 offset:44032
    v_mfma_f32_16x16x32_bf16 v[36:39], v[132:135], v[160:163], v[36:39]
    ds_read_b128 v[200:203], v9 offset:45056
    v_mfma_f32_16x16x32_bf16 v[84:87], v[132:135], v[164:167], v[84:87]
    ds_read_b128 v[204:207], v9 offset:46080
    v_mfma_f32_16x16x32_bf16 v[40:43], v[136:139], v[160:163], v[40:43]
    ds_read_b128 v[208:211], v9 offset:47104
    v_mfma_f32_16x16x32_bf16 v[88:91], v[136:139], v[164:167], v[88:91]
    ds_read_b128 v[212:215], v9 offset:48128
    v_mfma_f32_16x16x32_bf16 v[44:47], v[140:143], v[160:163], v[44:47]
    v_mfma_f32_16x16x32_bf16 v[92:95], v[140:143], v[164:167], v[92:95]
    v_mfma_f32_16x16x32_bf16 v[48:51], v[144:147], v[160:163], v[48:51]
    v_mfma_f32_16x16x32_bf16 v[96:99], v[144:147], v[164:167], v[96:99]
    v_mfma_f32_16x16x32_bf16 v[52:55], v[148:151], v[160:163], v[52:55]
    v_mfma_f32_16x16x32_bf16 v[100:103], v[148:151], v[164:167], v[100:103]
    v_mfma_f32_16x16x32_bf16 v[56:59], v[152:155], v[160:163], v[56:59]
    v_mfma_f32_16x16x32_bf16 v[104:107], v[152:155], v[164:167], v[104:107]
    v_mfma_f32_16x16x32_bf16 v[60:63], v[156:159], v[160:163], v[60:63]
    v_mfma_f32_16x16x32_bf16 v[108:111], v[156:159], v[164:167], v[108:111]
    s_waitcnt lgkmcnt(0)
    s_barrier
    v_mfma_f32_16x16x32_bf16 v[16:19], v[168:171], v[216:219], v[16:19]
    ds_read_b128 v[160:163], v11 offset:0
    v_mfma_f32_16x16x32_bf16 v[64:67], v[168:171], v[220:223], v[64:67]
    ds_read_b128 v[164:167], v11 offset:1024
    v_mfma_f32_16x16x32_bf16 v[20:23], v[172:175], v[216:219], v[20:23]
    ds_read_b128 v[112:115], v9 offset:0
    v_mfma_f32_16x16x32_bf16 v[68:71], v[172:175], v[220:223], v[68:71]
    ds_read_b128 v[116:119], v9 offset:1024
    v_mfma_f32_16x16x32_bf16 v[24:27], v[176:179], v[216:219], v[24:27]
    ds_read_b128 v[120:123], v9 offset:2048
    v_mfma_f32_16x16x32_bf16 v[72:75], v[176:179], v[220:223], v[72:75]
    ds_read_b128 v[124:127], v9 offset:3072
    v_mfma_f32_16x16x32_bf16 v[28:31], v[180:183], v[216:219], v[28:31]
    ds_read_b128 v[128:131], v9 offset:4096
    v_mfma_f32_16x16x32_bf16 v[76:79], v[180:183], v[220:223], v[76:79]
    ds_read_b128 v[132:135], v9 offset:5120
    v_mfma_f32_16x16x32_bf16 v[32:35], v[184:187], v[216:219], v[32:35]
    ds_read_b128 v[136:139], v9 offset:6144
    v_mfma_f32_16x16x32_bf16 v[80:83], v[184:187], v[220:223], v[80:83]
    ds_read_b128 v[140:143], v9 offset:7168
    v_mfma_f32_16x16x32_bf16 v[36:39], v[188:191], v[216:219], v[36:39]
    ds_read_b128 v[144:147], v9 offset:8192
    v_mfma_f32_16x16x32_bf16 v[84:87], v[188:191], v[220:223], v[84:87]
    ds_read_b128 v[148:151], v9 offset:9216
    v_mfma_f32_16x16x32_bf16 v[40:43], v[192:195], v[216:219], v[40:43]
    ds_read_b128 v[152:155], v9 offset:10240
    v_mfma_f32_16x16x32_bf16 v[88:91], v[192:195], v[220:223], v[88:91]
    ds_read_b128 v[156:159], v9 offset:11264
    v_mfma_f32_16x16x32_bf16 v[44:47], v[196:199], v[216:219], v[44:47]
    v_mfma_f32_16x16x32_bf16 v[92:95], v[196:199], v[220:223], v[92:95]
    v_mfma_f32_16x16x32_bf16 v[48:51], v[200:203], v[216:219], v[48:51]
    v_mfma_f32_16x16x32_bf16 v[96:99], v[200:203], v[220:223], v[96:99]
    v_mfma_f32_16x16x32_bf16 v[52:55], v[204:207], v[216:219], v[52:55]
    v_mfma_f32_16x16x32_bf16 v[100:103], v[204:207], v[220:223], v[100:103]
    v_mfma_f32_16x16x32_bf16 v[56:59], v[208:211], v[216:219], v[56:59]
    v_mfma_f32_16x16x32_bf16 v[104:107], v[208:211], v[220:223], v[104:107]
    v_mfma_f32_16x16x32_bf16 v[60:63], v[212:215], v[216:219], v[60:63]
    v_mfma_f32_16x16x32_bf16 v[108:111], v[212:215], v[220:223], v[108:111]
    s_waitcnt lgkmcnt(0)
    s_barrier
    v_mfma_f32_16x16x32_bf16 v[16:19], v[112:115], v[160:163], v[16:19]
    ds_read_b128 v[216:219], v11 offset:8192
    v_mfma_f32_16x16x32_bf16 v[64:67], v[112:115], v[164:167], v[64:67]
    ds_read_b128 v[220:223], v11 offset:9216
    v_mfma_f32_16x16x32_bf16 v[20:23], v[116:119], v[160:163], v[20:23]
    ds_read_b128 v[168:171], v9 offset:12288
    v_mfma_f32_16x16x32_bf16 v[68:71], v[116:119], v[164:167], v[68:71]
    ds_read_b128 v[172:175], v9 offset:13312
    v_mfma_f32_16x16x32_bf16 v[24:27], v[120:123], v[160:163], v[24:27]
    ds_read_b128 v[176:179], v9 offset:14336
    v_mfma_f32_16x16x32_bf16 v[72:75], v[120:123], v[164:167], v[72:75]
    ds_read_b128 v[180:183], v9 offset:15360
    v_mfma_f32_16x16x32_bf16 v[28:31], v[124:127], v[160:163], v[28:31]
    ds_read_b128 v[184:187], v9 offset:16384
    v_mfma_f32_16x16x32_bf16 v[76:79], v[124:127], v[164:167], v[76:79]
    ds_read_b128 v[188:191], v9 offset:17408
    v_mfma_f32_16x16x32_bf16 v[32:35], v[128:131], v[160:163], v[32:35]
    ds_read_b128 v[192:195], v9 offset:18432
    v_mfma_f32_16x16x32_bf16 v[80:83], v[128:131], v[164:167], v[80:83]
    ds_read_b128 v[196:199], v9 offset:19456
    v_mfma_f32_16x16x32_bf16 v[36:39], v[132:135], v[160:163], v[36:39]
    ds_read_b128 v[200:203], v9 offset:20480
    v_mfma_f32_16x16x32_bf16 v[84:87], v[132:135], v[164:167], v[84:87]
    ds_read_b128 v[204:207], v9 offset:21504
    v_mfma_f32_16x16x32_bf16 v[40:43], v[136:139], v[160:163], v[40:43]
    ds_read_b128 v[208:211], v9 offset:22528
    v_mfma_f32_16x16x32_bf16 v[88:91], v[136:139], v[164:167], v[88:91]
    ds_read_b128 v[212:215], v9 offset:23552
    v_mfma_f32_16x16x32_bf16 v[44:47], v[140:143], v[160:163], v[44:47]
    v_mfma_f32_16x16x32_bf16 v[92:95], v[140:143], v[164:167], v[92:95]
    v_mfma_f32_16x16x32_bf16 v[48:51], v[144:147], v[160:163], v[48:51]
    v_mfma_f32_16x16x32_bf16 v[96:99], v[144:147], v[164:167], v[96:99]
    v_mfma_f32_16x16x32_bf16 v[52:55], v[148:151], v[160:163], v[52:55]
    v_mfma_f32_16x16x32_bf16 v[100:103], v[148:151], v[164:167], v[100:103]
    v_mfma_f32_16x16x32_bf16 v[56:59], v[152:155], v[160:163], v[56:59]
    v_mfma_f32_16x16x32_bf16 v[104:107], v[152:155], v[164:167], v[104:107]
    v_mfma_f32_16x16x32_bf16 v[60:63], v[156:159], v[160:163], v[60:63]
    v_mfma_f32_16x16x32_bf16 v[108:111], v[156:159], v[164:167], v[108:111]
    s_waitcnt lgkmcnt(0)
    s_barrier
    v_mfma_f32_16x16x32_bf16 v[16:19], v[168:171], v[216:219], v[16:19]
    ds_read_b128 v[160:163], v11 offset:16384
    v_mfma_f32_16x16x32_bf16 v[64:67], v[168:171], v[220:223], v[64:67]
    ds_read_b128 v[164:167], v11 offset:17408
    v_mfma_f32_16x16x32_bf16 v[20:23], v[172:175], v[216:219], v[20:23]
    ds_read_b128 v[112:115], v9 offset:24576
    v_mfma_f32_16x16x32_bf16 v[68:71], v[172:175], v[220:223], v[68:71]
    ds_read_b128 v[116:119], v9 offset:25600
    v_mfma_f32_16x16x32_bf16 v[24:27], v[176:179], v[216:219], v[24:27]
    ds_read_b128 v[120:123], v9 offset:26624
    v_mfma_f32_16x16x32_bf16 v[72:75], v[176:179], v[220:223], v[72:75]
    ds_read_b128 v[124:127], v9 offset:27648
    v_mfma_f32_16x16x32_bf16 v[28:31], v[180:183], v[216:219], v[28:31]
    ds_read_b128 v[128:131], v9 offset:28672
    v_mfma_f32_16x16x32_bf16 v[76:79], v[180:183], v[220:223], v[76:79]
    ds_read_b128 v[132:135], v9 offset:29696
    v_mfma_f32_16x16x32_bf16 v[32:35], v[184:187], v[216:219], v[32:35]
    ds_read_b128 v[136:139], v9 offset:30720
    v_mfma_f32_16x16x32_bf16 v[80:83], v[184:187], v[220:223], v[80:83]
    ds_read_b128 v[140:143], v9 offset:31744
    v_mfma_f32_16x16x32_bf16 v[36:39], v[188:191], v[216:219], v[36:39]
    ds_read_b128 v[144:147], v9 offset:32768
    v_mfma_f32_16x16x32_bf16 v[84:87], v[188:191], v[220:223], v[84:87]
    ds_read_b128 v[148:151], v9 offset:33792
    v_mfma_f32_16x16x32_bf16 v[40:43], v[192:195], v[216:219], v[40:43]
    ds_read_b128 v[152:155], v9 offset:34816
    v_mfma_f32_16x16x32_bf16 v[88:91], v[192:195], v[220:223], v[88:91]
    ds_read_b128 v[156:159], v9 offset:35840
    v_mfma_f32_16x16x32_bf16 v[44:47], v[196:199], v[216:219], v[44:47]
    v_mfma_f32_16x16x32_bf16 v[92:95], v[196:199], v[220:223], v[92:95]
    v_mfma_f32_16x16x32_bf16 v[48:51], v[200:203], v[216:219], v[48:51]
    v_mfma_f32_16x16x32_bf16 v[96:99], v[200:203], v[220:223], v[96:99]
    v_mfma_f32_16x16x32_bf16 v[52:55], v[204:207], v[216:219], v[52:55]
    v_mfma_f32_16x16x32_bf16 v[100:103], v[204:207], v[220:223], v[100:103]
    v_mfma_f32_16x16x32_bf16 v[56:59], v[208:211], v[216:219], v[56:59]
    v_mfma_f32_16x16x32_bf16 v[104:107], v[208:211], v[220:223], v[104:107]
    v_mfma_f32_16x16x32_bf16 v[60:63], v[212:215], v[216:219], v[60:63]
    v_mfma_f32_16x16x32_bf16 v[108:111], v[212:215], v[220:223], v[108:111]
    s_waitcnt lgkmcnt(0)
    s_barrier
    v_mfma_f32_16x16x32_bf16 v[16:19], v[112:115], v[160:163], v[16:19]
    ds_read_b128 v[216:219], v11 offset:24576
    v_mfma_f32_16x16x32_bf16 v[64:67], v[112:115], v[164:167], v[64:67]
    ds_read_b128 v[220:223], v11 offset:25600
    v_mfma_f32_16x16x32_bf16 v[20:23], v[116:119], v[160:163], v[20:23]
    ds_read_b128 v[168:171], v9 offset:36864
    v_mfma_f32_16x16x32_bf16 v[68:71], v[116:119], v[164:167], v[68:71]
    ds_read_b128 v[172:175], v9 offset:37888
    v_mfma_f32_16x16x32_bf16 v[24:27], v[120:123], v[160:163], v[24:27]
    ds_read_b128 v[176:179], v9 offset:38912
    v_mfma_f32_16x16x32_bf16 v[72:75], v[120:123], v[164:167], v[72:75]
    ds_read_b128 v[180:183], v9 offset:39936
    v_mfma_f32_16x16x32_bf16 v[28:31], v[124:127], v[160:163], v[28:31]
    ds_read_b128 v[184:187], v9 offset:40960
    v_mfma_f32_16x16x32_bf16 v[76:79], v[124:127], v[164:167], v[76:79]
    ds_read_b128 v[188:191], v9 offset:41984
    v_mfma_f32_16x16x32_bf16 v[32:35], v[128:131], v[160:163], v[32:35]
    ds_read_b128 v[192:195], v9 offset:43008
    v_mfma_f32_16x16x32_bf16 v[80:83], v[128:131], v[164:167], v[80:83]
    ds_read_b128 v[196:199], v9 offset:44032
    v_mfma_f32_16x16x32_bf16 v[36:39], v[132:135], v[160:163], v[36:39]
    ds_read_b128 v[200:203], v9 offset:45056
    v_mfma_f32_16x16x32_bf16 v[84:87], v[132:135], v[164:167], v[84:87]
    ds_read_b128 v[204:207], v9 offset:46080
    v_mfma_f32_16x16x32_bf16 v[40:43], v[136:139], v[160:163], v[40:43]
    ds_read_b128 v[208:211], v9 offset:47104
    v_mfma_f32_16x16x32_bf16 v[88:91], v[136:139], v[164:167], v[88:91]
    ds_read_b128 v[212:215], v9 offset:48128
    v_mfma_f32_16x16x32_bf16 v[44:47], v[140:143], v[160:163], v[44:47]
    v_mfma_f32_16x16x32_bf16 v[92:95], v[140:143], v[164:167], v[92:95]
    v_mfma_f32_16x16x32_bf16 v[48:51], v[144:147], v[160:163], v[48:51]
    v_mfma_f32_16x16x32_bf16 v[96:99], v[144:147], v[164:167], v[96:99]
    v_mfma_f32_16x16x32_bf16 v[52:55], v[148:151], v[160:163], v[52:55]
    v_mfma_f32_16x16x32_bf16 v[100:103], v[148:151], v[164:167], v[100:103]
    v_mfma_f32_16x16x32_bf16 v[56:59], v[152:155], v[160:163], v[56:59]
    v_mfma_f32_16x16x32_bf16 v[104:107], v[152:155], v[164:167], v[104:107]
    v_mfma_f32_16x16x32_bf16 v[60:63], v[156:159], v[160:163], v[60:63]
    v_mfma_f32_16x16x32_bf16 v[108:111], v[156:159], v[164:167], v[108:111]
    s_waitcnt lgkmcnt(0)
    v_mfma_f32_16x16x32_bf16 v[16:19], v[168:171], v[216:219], v[16:19]
    ds_read_b64 v[224:225], v229 offset:0
    v_mfma_f32_16x16x32_bf16 v[64:67], v[168:171], v[220:223], v[64:67]
    ds_read_b64 v[226:227], v229 offset:128
    v_mfma_f32_16x16x32_bf16 v[20:23], v[172:175], v[216:219], v[20:23]
    ds_read_b128 v[112:115], v228 offset:0
    v_mfma_f32_16x16x32_bf16 v[68:71], v[172:175], v[220:223], v[68:71]
    ds_read_b128 v[116:119], v228 offset:384
    v_mfma_f32_16x16x32_bf16 v[24:27], v[176:179], v[216:219], v[24:27]
    ds_read_b128 v[120:123], v228 offset:768
    v_mfma_f32_16x16x32_bf16 v[72:75], v[176:179], v[220:223], v[72:75]
    ds_read_b128 v[124:127], v228 offset:1152
    v_mfma_f32_16x16x32_bf16 v[28:31], v[180:183], v[216:219], v[28:31]
    v_mfma_f32_16x16x32_bf16 v[76:79], v[180:183], v[220:223], v[76:79]
    v_mfma_f32_16x16x32_bf16 v[32:35], v[184:187], v[216:219], v[32:35]
    v_mfma_f32_16x16x32_bf16 v[80:83], v[184:187], v[220:223], v[80:83]
    v_mfma_f32_16x16x32_bf16 v[36:39], v[188:191], v[216:219], v[36:39]
    v_mfma_f32_16x16x32_bf16 v[84:87], v[188:191], v[220:223], v[84:87]
    v_mfma_f32_16x16x32_bf16 v[40:43], v[192:195], v[216:219], v[40:43]
    v_mfma_f32_16x16x32_bf16 v[88:91], v[192:195], v[220:223], v[88:91]
    v_mfma_f32_16x16x32_bf16 v[44:47], v[196:199], v[216:219], v[44:47]
    v_mfma_f32_16x16x32_bf16 v[92:95], v[196:199], v[220:223], v[92:95]
    v_mfma_f32_16x16x32_bf16 v[48:51], v[200:203], v[216:219], v[48:51]
    v_mfma_f32_16x16x32_bf16 v[96:99], v[200:203], v[220:223], v[96:99]
    v_mfma_f32_16x16x32_bf16 v[52:55], v[204:207], v[216:219], v[52:55]
    v_mfma_f32_16x16x32_bf16 v[100:103], v[204:207], v[220:223], v[100:103]
    v_mfma_f32_16x16x32_bf16 v[56:59], v[208:211], v[216:219], v[56:59]
    v_mfma_f32_16x16x32_bf16 v[104:107], v[208:211], v[220:223], v[104:107]
    v_mfma_f32_16x16x32_bf16 v[60:63], v[212:215], v[216:219], v[60:63]
    v_mfma_f32_16x16x32_bf16 v[108:111], v[212:215], v[220:223], v[108:111]
    s_waitcnt lgkmcnt(0)
    ds_read_b128 v[128:131], v228 offset:64
    ds_read_b128 v[132:135], v228 offset:448
    ds_read_b128 v[136:139], v228 offset:832
    ds_read_b128 v[140:143], v228 offset:1216
    v_pk_fma_f32 v[144:145], v[112:113], v[224:225], v[120:121] op_sel:[0,1,0] op_sel_hi:[1,1,1]
    v_pk_fma_f32 v[148:149], v[116:117], v[224:225], v[124:125] op_sel:[0,1,0] op_sel_hi:[1,1,1]
    v_pk_fma_f32 v[146:147], v[114:115], v[224:225], v[122:123] op_sel:[0,1,0] op_sel_hi:[1,1,1]
    v_pk_fma_f32 v[150:151], v[118:119], v[224:225], v[126:127] op_sel:[0,1,0] op_sel_hi:[1,1,1]
    v_pk_fma_f32 v[16:17], v[16:17], v[224:225], v[144:145] op_sel_hi:[1,0,1]
    v_pk_fma_f32 v[40:41], v[40:41], v[224:225], v[148:149] op_sel_hi:[1,0,1]
    v_pk_fma_f32 v[18:19], v[18:19], v[224:225], v[146:147] op_sel_hi:[1,0,1]
    v_pk_fma_f32 v[42:43], v[42:43], v[224:225], v[150:151] op_sel_hi:[1,0,1]
    v_pk_mul_f32 v[144:145], v[16:17], v[16:17]
    v_pk_mul_f32 v[146:147], v[18:19], v[18:19]
    v_pk_mul_f32 v[40:41], v[40:41], v[16:17]
    v_pk_mul_f32 v[42:43], v[42:43], v[18:19]
    v_pk_fma_f32 v[144:145], v[144:145], s[64:65], v[230:231]
    v_pk_fma_f32 v[146:147], v[146:147], s[64:65], v[230:231]
    v_pk_mul_f32 v[144:145], v[144:145], v[16:17]
    v_pk_mul_f32 v[146:147], v[146:147], v[18:19]
    v_exp_f32 v144, v144
    v_exp_f32 v145, v145
    v_exp_f32 v146, v146
    v_exp_f32 v147, v147
    v_pk_fma_f32 v[160:161], v[112:113], v[226:227], v[120:121] op_sel:[0,1,0] op_sel_hi:[1,1,1]
    v_pk_fma_f32 v[164:165], v[116:117], v[226:227], v[124:125] op_sel:[0,1,0] op_sel_hi:[1,1,1]
    v_pk_fma_f32 v[162:163], v[114:115], v[226:227], v[122:123] op_sel:[0,1,0] op_sel_hi:[1,1,1]
    v_pk_fma_f32 v[166:167], v[118:119], v[226:227], v[126:127] op_sel:[0,1,0] op_sel_hi:[1,1,1]
    v_pk_fma_f32 v[64:65], v[64:65], v[226:227], v[160:161] op_sel_hi:[1,0,1]
    v_pk_fma_f32 v[88:89], v[88:89], v[226:227], v[164:165] op_sel_hi:[1,0,1]
    v_pk_fma_f32 v[66:67], v[66:67], v[226:227], v[162:163] op_sel_hi:[1,0,1]
    v_pk_fma_f32 v[90:91], v[90:91], v[226:227], v[166:167] op_sel_hi:[1,0,1]
    v_pk_mul_f32 v[160:161], v[64:65], v[64:65]
    v_pk_mul_f32 v[162:163], v[66:67], v[66:67]
    v_pk_mul_f32 v[88:89], v[88:89], v[64:65]
    v_pk_mul_f32 v[90:91], v[90:91], v[66:67]
    v_pk_fma_f32 v[160:161], v[160:161], s[64:65], v[230:231]
    v_pk_fma_f32 v[162:163], v[162:163], s[64:65], v[230:231]
    v_pk_mul_f32 v[160:161], v[160:161], v[64:65]
    v_pk_mul_f32 v[162:163], v[162:163], v[66:67]
    v_pk_add_f32 v[144:145], v[144:145], 1.0 op_sel_hi:[1,0]
    v_pk_add_f32 v[146:147], v[146:147], 1.0 op_sel_hi:[1,0]
    v_rcp_f32 v144, v144
    v_rcp_f32 v145, v145
    v_rcp_f32 v146, v146
    v_rcp_f32 v147, v147
    v_exp_f32 v160, v160
    v_exp_f32 v161, v161
    v_exp_f32 v162, v162
    v_exp_f32 v163, v163
    v_pk_mul_f32 v[40:41], v[40:41], v[144:145]
    v_pk_mul_f32 v[42:43], v[42:43], v[146:147]
    v_cvt_pk_bf16_f32 v16, v40, v41
    v_cvt_pk_bf16_f32 v17, v42, v43
    v_pk_add_f32 v[160:161], v[160:161], 1.0 op_sel_hi:[1,0]
    v_pk_add_f32 v[162:163], v[162:163], 1.0 op_sel_hi:[1,0]
    v_rcp_f32 v160, v160
    v_rcp_f32 v161, v161
    v_rcp_f32 v162, v162
    v_rcp_f32 v163, v163
    v_pk_mul_f32 v[88:89], v[88:89], v[160:161]
    v_pk_mul_f32 v[90:91], v[90:91], v[162:163]
    v_cvt_pk_bf16_f32 v64, v88, v89
    v_cvt_pk_bf16_f32 v65, v90, v91
    s_waitcnt lgkmcnt(0)
    ds_read_b128 v[112:115], v228 offset:128
    ds_read_b128 v[116:119], v228 offset:512
    ds_read_b128 v[120:123], v228 offset:896
    ds_read_b128 v[124:127], v228 offset:1280
    v_pk_fma_f32 v[144:145], v[128:129], v[224:225], v[136:137] op_sel:[0,1,0] op_sel_hi:[1,1,1]
    v_pk_fma_f32 v[148:149], v[132:133], v[224:225], v[140:141] op_sel:[0,1,0] op_sel_hi:[1,1,1]
    v_pk_fma_f32 v[146:147], v[130:131], v[224:225], v[138:139] op_sel:[0,1,0] op_sel_hi:[1,1,1]
    v_pk_fma_f32 v[150:151], v[134:135], v[224:225], v[142:143] op_sel:[0,1,0] op_sel_hi:[1,1,1]
    v_pk_fma_f32 v[20:21], v[20:21], v[224:225], v[144:145] op_sel_hi:[1,0,1]
    v_pk_fma_f32 v[44:45], v[44:45], v[224:225], v[148:149] op_sel_hi:[1,0,1]
    v_pk_fma_f32 v[22:23], v[22:23], v[224:225], v[146:147] op_sel_hi:[1,0,1]
    v_pk_fma_f32 v[46:47], v[46:47], v[224:225], v[150:151] op_sel_hi:[1,0,1]
    v_pk_mul_f32 v[144:145], v[20:21], v[20:21]
    v_pk_mul_f32 v[146:147], v[22:23], v[22:23]
    v_pk_mul_f32 v[44:45], v[44:45], v[20:21]
    v_pk_mul_f32 v[46:47], v[46:47], v[22:23]
    v_pk_fma_f32 v[144:145], v[144:145], s[64:65], v[230:231]
    v_pk_fma_f32 v[146:147], v[146:147], s[64:65], v[230:231]
    v_pk_mul_f32 v[144:145], v[144:145], v[20:21]
    v_pk_mul_f32 v[146:147], v[146:147], v[22:23]
    v_exp_f32 v144, v144
    v_exp_f32 v145, v145
    v_exp_f32 v146, v146
    v_exp_f32 v147, v147
    v_pk_fma_f32 v[160:161], v[128:129], v[226:227], v[136:137] op_sel:[0,1,0] op_sel_hi:[1,1,1]
    v_pk_fma_f32 v[164:165], v[132:133], v[226:227], v[140:141] op_sel:[0,1,0] op_sel_hi:[1,1,1]
    v_pk_fma_f32 v[162:163], v[130:131], v[226:227], v[138:139] op_sel:[0,1,0] op_sel_hi:[1,1,1]
    v_pk_fma_f32 v[166:167], v[134:135], v[226:227], v[142:143] op_sel:[0,1,0] op_sel_hi:[1,1,1]
    v_pk_fma_f32 v[68:69], v[68:69], v[226:227], v[160:161] op_sel_hi:[1,0,1]
    v_pk_fma_f32 v[92:93], v[92:93], v[226:227], v[164:165] op_sel_hi:[1,0,1]
    v_pk_fma_f32 v[70:71], v[70:71], v[226:227], v[162:163] op_sel_hi:[1,0,1]
    v_pk_fma_f32 v[94:95], v[94:95], v[226:227], v[166:167] op_sel_hi:[1,0,1]
    v_pk_mul_f32 v[160:161], v[68:69], v[68:69]
    v_pk_mul_f32 v[162:163], v[70:71], v[70:71]
    v_pk_mul_f32 v[92:93], v[92:93], v[68:69]
    v_pk_mul_f32 v[94:95], v[94:95], v[70:71]
    v_pk_fma_f32 v[160:161], v[160:161], s[64:65], v[230:231]
    v_pk_fma_f32 v[162:163], v[162:163], s[64:65], v[230:231]
    v_pk_mul_f32 v[160:161], v[160:161], v[68:69]
    v_pk_mul_f32 v[162:163], v[162:163], v[70:71]
    v_pk_add_f32 v[144:145], v[144:145], 1.0 op_sel_hi:[1,0]
    v_pk_add_f32 v[146:147], v[146:147], 1.0 op_sel_hi:[1,0]
    v_rcp_f32 v144, v144
    v_rcp_f32 v145, v145
    v_rcp_f32 v146, v146
    v_rcp_f32 v147, v147
    v_exp_f32 v160, v160
    v_exp_f32 v161, v161
    v_exp_f32 v162, v162
    v_exp_f32 v163, v163
    v_pk_mul_f32 v[44:45], v[44:45], v[144:145]
    v_pk_mul_f32 v[46:47], v[46:47], v[146:147]
    v_cvt_pk_bf16_f32 v18, v44, v45
    v_cvt_pk_bf16_f32 v19, v46, v47
    buffer_store_dwordx4 v[16:19], v2, s[8:11], s60 offen offset:0 sc1
    v_pk_add_f32 v[160:161], v[160:161], 1.0 op_sel_hi:[1,0]
    v_pk_add_f32 v[162:163], v[162:163], 1.0 op_sel_hi:[1,0]
    v_rcp_f32 v160, v160
    v_rcp_f32 v161, v161
    v_rcp_f32 v162, v162
    v_rcp_f32 v163, v163
    v_pk_mul_f32 v[92:93], v[92:93], v[160:161]
    v_pk_mul_f32 v[94:95], v[94:95], v[162:163]
    v_cvt_pk_bf16_f32 v66, v92, v93
    v_cvt_pk_bf16_f32 v67, v94, v95
    buffer_store_dwordx4 v[64:67], v2, s[8:11], s60 offen offset:1024 sc1
    s_waitcnt lgkmcnt(0)
    ds_read_b128 v[128:131], v228 offset:192
    ds_read_b128 v[132:135], v228 offset:576
    ds_read_b128 v[136:139], v228 offset:960
    ds_read_b128 v[140:143], v228 offset:1344
    v_pk_fma_f32 v[144:145], v[112:113], v[224:225], v[120:121] op_sel:[0,1,0] op_sel_hi:[1,1,1]
    v_pk_fma_f32 v[148:149], v[116:117], v[224:225], v[124:125] op_sel:[0,1,0] op_sel_hi:[1,1,1]
    v_pk_fma_f32 v[146:147], v[114:115], v[224:225], v[122:123] op_sel:[0,1,0] op_sel_hi:[1,1,1]
    v_pk_fma_f32 v[150:151], v[118:119], v[224:225], v[126:127] op_sel:[0,1,0] op_sel_hi:[1,1,1]
    v_pk_fma_f32 v[24:25], v[24:25], v[224:225], v[144:145] op_sel_hi:[1,0,1]
    v_pk_fma_f32 v[48:49], v[48:49], v[224:225], v[148:149] op_sel_hi:[1,0,1]
    v_pk_fma_f32 v[26:27], v[26:27], v[224:225], v[146:147] op_sel_hi:[1,0,1]
    v_pk_fma_f32 v[50:51], v[50:51], v[224:225], v[150:151] op_sel_hi:[1,0,1]
    v_pk_mul_f32 v[144:145], v[24:25], v[24:25]
    v_pk_mul_f32 v[146:147], v[26:27], v[26:27]
    v_pk_mul_f32 v[48:49], v[48:49], v[24:25]
    v_pk_mul_f32 v[50:51], v[50:51], v[26:27]
    v_pk_fma_f32 v[144:145], v[144:145], s[64:65], v[230:231]
    v_pk_fma_f32 v[146:147], v[146:147], s[64:65], v[230:231]
    v_pk_mul_f32 v[144:145], v[144:145], v[24:25]
    v_pk_mul_f32 v[146:147], v[146:147], v[26:27]
    v_exp_f32 v144, v144
    v_exp_f32 v145, v145
    v_exp_f32 v146, v146
    v_exp_f32 v147, v147
    v_pk_fma_f32 v[160:161], v[112:113], v[226:227], v[120:121] op_sel:[0,1,0] op_sel_hi:[1,1,1]
    v_pk_fma_f32 v[164:165], v[116:117], v[226:227], v[124:125] op_sel:[0,1,0] op_sel_hi:[1,1,1]
    v_pk_fma_f32 v[162:163], v[114:115], v[226:227], v[122:123] op_sel:[0,1,0] op_sel_hi:[1,1,1]
    v_pk_fma_f32 v[166:167], v[118:119], v[226:227], v[126:127] op_sel:[0,1,0] op_sel_hi:[1,1,1]
    v_pk_fma_f32 v[72:73], v[72:73], v[226:227], v[160:161] op_sel_hi:[1,0,1]
    v_pk_fma_f32 v[96:97], v[96:97], v[226:227], v[164:165] op_sel_hi:[1,0,1]
    v_pk_fma_f32 v[74:75], v[74:75], v[226:227], v[162:163] op_sel_hi:[1,0,1]
    v_pk_fma_f32 v[98:99], v[98:99], v[226:227], v[166:167] op_sel_hi:[1,0,1]
    v_pk_mul_f32 v[160:161], v[72:73], v[72:73]
    v_pk_mul_f32 v[162:163], v[74:75], v[74:75]
    v_pk_mul_f32 v[96:97], v[96:97], v[72:73]
    v_pk_mul_f32 v[98:99], v[98:99], v[74:75]
    v_pk_fma_f32 v[160:161], v[160:161], s[64:65], v[230:231]
    v_pk_fma_f32 v[162:163], v[162:163], s[64:65], v[230:231]
    v_pk_mul_f32 v[160:161], v[160:161], v[72:73]
    v_pk_mul_f32 v[162:163], v[162:163], v[74:75]
    v_pk_add_f32 v[144:145], v[144:145], 1.0 op_sel_hi:[1,0]
    v_pk_add_f32 v[146:147], v[146:147], 1.0 op_sel_hi:[1,0]
    v_rcp_f32 v144, v144
    v_rcp_f32 v145, v145
    v_rcp_f32 v146, v146
    v_rcp_f32 v147, v147
    v_exp_f32 v160, v160
    v_exp_f32 v161, v161
    v_exp_f32 v162, v162
    v_exp_f32 v163, v163
    v_pk_mul_f32 v[48:49], v[48:49], v[144:145]
    v_pk_mul_f32 v[50:51], v[50:51], v[146:147]
    v_cvt_pk_bf16_f32 v24, v48, v49
    v_cvt_pk_bf16_f32 v25, v50, v51
    v_pk_add_f32 v[160:161], v[160:161], 1.0 op_sel_hi:[1,0]
    v_pk_add_f32 v[162:163], v[162:163], 1.0 op_sel_hi:[1,0]
    v_rcp_f32 v160, v160
    v_rcp_f32 v161, v161
    v_rcp_f32 v162, v162
    v_rcp_f32 v163, v163
    v_pk_mul_f32 v[96:97], v[96:97], v[160:161]
    v_pk_mul_f32 v[98:99], v[98:99], v[162:163]
    v_cvt_pk_bf16_f32 v72, v96, v97
    v_cvt_pk_bf16_f32 v73, v98, v99
    s_waitcnt lgkmcnt(0)
    ds_read_b128 v[112:115], v228 offset:256
    ds_read_b128 v[116:119], v228 offset:640
    ds_read_b128 v[120:123], v228 offset:1024
    ds_read_b128 v[124:127], v228 offset:1408
    v_pk_fma_f32 v[144:145], v[128:129], v[224:225], v[136:137] op_sel:[0,1,0] op_sel_hi:[1,1,1]
    v_pk_fma_f32 v[148:149], v[132:133], v[224:225], v[140:141] op_sel:[0,1,0] op_sel_hi:[1,1,1]
    v_pk_fma_f32 v[146:147], v[130:131], v[224:225], v[138:139] op_sel:[0,1,0] op_sel_hi:[1,1,1]
    v_pk_fma_f32 v[150:151], v[134:135], v[224:225], v[142:143] op_sel:[0,1,0] op_sel_hi:[1,1,1]
    v_pk_fma_f32 v[28:29], v[28:29], v[224:225], v[144:145] op_sel_hi:[1,0,1]
    v_pk_fma_f32 v[52:53], v[52:53], v[224:225], v[148:149] op_sel_hi:[1,0,1]
    v_pk_fma_f32 v[30:31], v[30:31], v[224:225], v[146:147] op_sel_hi:[1,0,1]
    v_pk_fma_f32 v[54:55], v[54:55], v[224:225], v[150:151] op_sel_hi:[1,0,1]
    v_pk_mul_f32 v[144:145], v[28:29], v[28:29]
    v_pk_mul_f32 v[146:147], v[30:31], v[30:31]
    v_pk_mul_f32 v[52:53], v[52:53], v[28:29]
    v_pk_mul_f32 v[54:55], v[54:55], v[30:31]
    v_pk_fma_f32 v[144:145], v[144:145], s[64:65], v[230:231]
    v_pk_fma_f32 v[146:147], v[146:147], s[64:65], v[230:231]
    v_pk_mul_f32 v[144:145], v[144:145], v[28:29]
    v_pk_mul_f32 v[146:147], v[146:147], v[30:31]
    v_exp_f32 v144, v144
    v_exp_f32 v145, v145
    v_exp_f32 v146, v146
    v_exp_f32 v147, v147
    v_pk_fma_f32 v[160:161], v[128:129], v[226:227], v[136:137] op_sel:[0,1,0] op_sel_hi:[1,1,1]
    v_pk_fma_f32 v[164:165], v[132:133], v[226:227], v[140:141] op_sel:[0,1,0] op_sel_hi:[1,1,1]
    v_pk_fma_f32 v[162:163], v[130:131], v[226:227], v[138:139] op_sel:[0,1,0] op_sel_hi:[1,1,1]
    v_pk_fma_f32 v[166:167], v[134:135], v[226:227], v[142:143] op_sel:[0,1,0] op_sel_hi:[1,1,1]
    v_pk_fma_f32 v[76:77], v[76:77], v[226:227], v[160:161] op_sel_hi:[1,0,1]
    v_pk_fma_f32 v[100:101], v[100:101], v[226:227], v[164:165] op_sel_hi:[1,0,1]
    v_pk_fma_f32 v[78:79], v[78:79], v[226:227], v[162:163] op_sel_hi:[1,0,1]
    v_pk_fma_f32 v[102:103], v[102:103], v[226:227], v[166:167] op_sel_hi:[1,0,1]
    v_pk_mul_f32 v[160:161], v[76:77], v[76:77]
    v_pk_mul_f32 v[162:163], v[78:79], v[78:79]
    v_pk_mul_f32 v[100:101], v[100:101], v[76:77]
    v_pk_mul_f32 v[102:103], v[102:103], v[78:79]
    v_pk_fma_f32 v[160:161], v[160:161], s[64:65], v[230:231]
    v_pk_fma_f32 v[162:163], v[162:163], s[64:65], v[230:231]
    v_pk_mul_f32 v[160:161], v[160:161], v[76:77]
    v_pk_mul_f32 v[162:163], v[162:163], v[78:79]
    v_pk_add_f32 v[144:145], v[144:145], 1.0 op_sel_hi:[1,0]
    v_pk_add_f32 v[146:147], v[146:147], 1.0 op_sel_hi:[1,0]
    v_rcp_f32 v144, v144
    v_rcp_f32 v145, v145
    v_rcp_f32 v146, v146
    v_rcp_f32 v147, v147
    v_exp_f32 v160, v160
    v_exp_f32 v161, v161
    v_exp_f32 v162, v162
    v_exp_f32 v163, v163
    v_pk_mul_f32 v[52:53], v[52:53], v[144:145]
    v_pk_mul_f32 v[54:55], v[54:55], v[146:147]
    v_cvt_pk_bf16_f32 v26, v52, v53
    v_cvt_pk_bf16_f32 v27, v54, v55
    buffer_store_dwordx4 v[24:27], v2, s[8:11], s61 offen offset:0 sc1
    v_pk_add_f32 v[160:161], v[160:161], 1.0 op_sel_hi:[1,0]
    v_pk_add_f32 v[162:163], v[162:163], 1.0 op_sel_hi:[1,0]
    v_rcp_f32 v160, v160
    v_rcp_f32 v161, v161
    v_rcp_f32 v162, v162
    v_rcp_f32 v163, v163
    v_pk_mul_f32 v[100:101], v[100:101], v[160:161]
    v_pk_mul_f32 v[102:103], v[102:103], v[162:163]
    v_cvt_pk_bf16_f32 v74, v100, v101
    v_cvt_pk_bf16_f32 v75, v102, v103
    buffer_store_dwordx4 v[72:75], v2, s[8:11], s61 offen offset:1024 sc1
    s_waitcnt lgkmcnt(0)
    ds_read_b128 v[128:131], v228 offset:320
    ds_read_b128 v[132:135], v228 offset:704
    ds_read_b128 v[136:139], v228 offset:1088
    ds_read_b128 v[140:143], v228 offset:1472
    v_pk_fma_f32 v[144:145], v[112:113], v[224:225], v[120:121] op_sel:[0,1,0] op_sel_hi:[1,1,1]
    v_pk_fma_f32 v[148:149], v[116:117], v[224:225], v[124:125] op_sel:[0,1,0] op_sel_hi:[1,1,1]
    v_pk_fma_f32 v[146:147], v[114:115], v[224:225], v[122:123] op_sel:[0,1,0] op_sel_hi:[1,1,1]
    v_pk_fma_f32 v[150:151], v[118:119], v[224:225], v[126:127] op_sel:[0,1,0] op_sel_hi:[1,1,1]
    v_pk_fma_f32 v[32:33], v[32:33], v[224:225], v[144:145] op_sel_hi:[1,0,1]
    v_pk_fma_f32 v[56:57], v[56:57], v[224:225], v[148:149] op_sel_hi:[1,0,1]
    v_pk_fma_f32 v[34:35], v[34:35], v[224:225], v[146:147] op_sel_hi:[1,0,1]
    v_pk_fma_f32 v[58:59], v[58:59], v[224:225], v[150:151] op_sel_hi:[1,0,1]
    v_pk_mul_f32 v[144:145], v[32:33], v[32:33]
    v_pk_mul_f32 v[146:147], v[34:35], v[34:35]
    v_pk_mul_f32 v[56:57], v[56:57], v[32:33]
    v_pk_mul_f32 v[58:59], v[58:59], v[34:35]
    v_pk_fma_f32 v[144:145], v[144:145], s[64:65], v[230:231]
    v_pk_fma_f32 v[146:147], v[146:147], s[64:65], v[230:231]
    v_pk_mul_f32 v[144:145], v[144:145], v[32:33]
    v_pk_mul_f32 v[146:147], v[146:147], v[34:35]
    v_exp_f32 v144, v144
    v_exp_f32 v145, v145
    v_exp_f32 v146, v146
    v_exp_f32 v147, v147
    v_pk_fma_f32 v[160:161], v[112:113], v[226:227], v[120:121] op_sel:[0,1,0] op_sel_hi:[1,1,1]
    v_pk_fma_f32 v[164:165], v[116:117], v[226:227], v[124:125] op_sel:[0,1,0] op_sel_hi:[1,1,1]
    v_pk_fma_f32 v[162:163], v[114:115], v[226:227], v[122:123] op_sel:[0,1,0] op_sel_hi:[1,1,1]
    v_pk_fma_f32 v[166:167], v[118:119], v[226:227], v[126:127] op_sel:[0,1,0] op_sel_hi:[1,1,1]
    v_pk_fma_f32 v[80:81], v[80:81], v[226:227], v[160:161] op_sel_hi:[1,0,1]
    v_pk_fma_f32 v[104:105], v[104:105], v[226:227], v[164:165] op_sel_hi:[1,0,1]
    v_pk_fma_f32 v[82:83], v[82:83], v[226:227], v[162:163] op_sel_hi:[1,0,1]
    v_pk_fma_f32 v[106:107], v[106:107], v[226:227], v[166:167] op_sel_hi:[1,0,1]
    v_pk_mul_f32 v[160:161], v[80:81], v[80:81]
    v_pk_mul_f32 v[162:163], v[82:83], v[82:83]
    v_pk_mul_f32 v[104:105], v[104:105], v[80:81]
    v_pk_mul_f32 v[106:107], v[106:107], v[82:83]
    v_pk_fma_f32 v[160:161], v[160:161], s[64:65], v[230:231]
    v_pk_fma_f32 v[162:163], v[162:163], s[64:65], v[230:231]
    v_pk_mul_f32 v[160:161], v[160:161], v[80:81]
    v_pk_mul_f32 v[162:163], v[162:163], v[82:83]
    v_pk_add_f32 v[144:145], v[144:145], 1.0 op_sel_hi:[1,0]
    v_pk_add_f32 v[146:147], v[146:147], 1.0 op_sel_hi:[1,0]
    v_rcp_f32 v144, v144
    v_rcp_f32 v145, v145
    v_rcp_f32 v146, v146
    v_rcp_f32 v147, v147
    v_exp_f32 v160, v160
    v_exp_f32 v161, v161
    v_exp_f32 v162, v162
    v_exp_f32 v163, v163
    v_pk_mul_f32 v[56:57], v[56:57], v[144:145]
    v_pk_mul_f32 v[58:59], v[58:59], v[146:147]
    v_cvt_pk_bf16_f32 v32, v56, v57
    v_cvt_pk_bf16_f32 v33, v58, v59
    v_pk_add_f32 v[160:161], v[160:161], 1.0 op_sel_hi:[1,0]
    v_pk_add_f32 v[162:163], v[162:163], 1.0 op_sel_hi:[1,0]
    v_rcp_f32 v160, v160
    v_rcp_f32 v161, v161
    v_rcp_f32 v162, v162
    v_rcp_f32 v163, v163
    v_pk_mul_f32 v[104:105], v[104:105], v[160:161]
    v_pk_mul_f32 v[106:107], v[106:107], v[162:163]
    v_cvt_pk_bf16_f32 v80, v104, v105
    v_cvt_pk_bf16_f32 v81, v106, v107
    s_waitcnt lgkmcnt(0)
    v_pk_fma_f32 v[144:145], v[128:129], v[224:225], v[136:137] op_sel:[0,1,0] op_sel_hi:[1,1,1]
    v_pk_fma_f32 v[148:149], v[132:133], v[224:225], v[140:141] op_sel:[0,1,0] op_sel_hi:[1,1,1]
    v_pk_fma_f32 v[146:147], v[130:131], v[224:225], v[138:139] op_sel:[0,1,0] op_sel_hi:[1,1,1]
    v_pk_fma_f32 v[150:151], v[134:135], v[224:225], v[142:143] op_sel:[0,1,0] op_sel_hi:[1,1,1]
    v_pk_fma_f32 v[36:37], v[36:37], v[224:225], v[144:145] op_sel_hi:[1,0,1]
    v_pk_fma_f32 v[60:61], v[60:61], v[224:225], v[148:149] op_sel_hi:[1,0,1]
    v_pk_fma_f32 v[38:39], v[38:39], v[224:225], v[146:147] op_sel_hi:[1,0,1]
    v_pk_fma_f32 v[62:63], v[62:63], v[224:225], v[150:151] op_sel_hi:[1,0,1]
    v_pk_mul_f32 v[144:145], v[36:37], v[36:37]
    v_pk_mul_f32 v[146:147], v[38:39], v[38:39]
    v_pk_mul_f32 v[60:61], v[60:61], v[36:37]
    v_pk_mul_f32 v[62:63], v[62:63], v[38:39]
    v_pk_fma_f32 v[144:145], v[144:145], s[64:65], v[230:231]
    v_pk_fma_f32 v[146:147], v[146:147], s[64:65], v[230:231]
    v_pk_mul_f32 v[144:145], v[144:145], v[36:37]
    v_pk_mul_f32 v[146:147], v[146:147], v[38:39]
    v_exp_f32 v144, v144
    v_exp_f32 v145, v145
    v_exp_f32 v146, v146
    v_exp_f32 v147, v147
    v_pk_fma_f32 v[160:161], v[128:129], v[226:227], v[136:137] op_sel:[0,1,0] op_sel_hi:[1,1,1]
    v_pk_fma_f32 v[164:165], v[132:133], v[226:227], v[140:141] op_sel:[0,1,0] op_sel_hi:[1,1,1]
    v_pk_fma_f32 v[162:163], v[130:131], v[226:227], v[138:139] op_sel:[0,1,0] op_sel_hi:[1,1,1]
    v_pk_fma_f32 v[166:167], v[134:135], v[226:227], v[142:143] op_sel:[0,1,0] op_sel_hi:[1,1,1]
    v_pk_fma_f32 v[84:85], v[84:85], v[226:227], v[160:161] op_sel_hi:[1,0,1]
    v_pk_fma_f32 v[108:109], v[108:109], v[226:227], v[164:165] op_sel_hi:[1,0,1]
    v_pk_fma_f32 v[86:87], v[86:87], v[226:227], v[162:163] op_sel_hi:[1,0,1]
    v_pk_fma_f32 v[110:111], v[110:111], v[226:227], v[166:167] op_sel_hi:[1,0,1]
    v_pk_mul_f32 v[160:161], v[84:85], v[84:85]
    v_pk_mul_f32 v[162:163], v[86:87], v[86:87]
    v_pk_mul_f32 v[108:109], v[108:109], v[84:85]
    v_pk_mul_f32 v[110:111], v[110:111], v[86:87]
    v_pk_fma_f32 v[160:161], v[160:161], s[64:65], v[230:231]
    v_pk_fma_f32 v[162:163], v[162:163], s[64:65], v[230:231]
    v_pk_mul_f32 v[160:161], v[160:161], v[84:85]
    v_pk_mul_f32 v[162:163], v[162:163], v[86:87]
    v_pk_add_f32 v[144:145], v[144:145], 1.0 op_sel_hi:[1,0]
    v_pk_add_f32 v[146:147], v[146:147], 1.0 op_sel_hi:[1,0]
    v_rcp_f32 v144, v144
    v_rcp_f32 v145, v145
    v_rcp_f32 v146, v146
    v_rcp_f32 v147, v147
    v_exp_f32 v160, v160
    v_exp_f32 v161, v161
    v_exp_f32 v162, v162
    v_exp_f32 v163, v163
    v_pk_mul_f32 v[60:61], v[60:61], v[144:145]
    v_pk_mul_f32 v[62:63], v[62:63], v[146:147]
    v_cvt_pk_bf16_f32 v34, v60, v61
    v_cvt_pk_bf16_f32 v35, v62, v63
    buffer_store_dwordx4 v[32:35], v2, s[8:11], s62 offen offset:0 sc1
    v_pk_add_f32 v[160:161], v[160:161], 1.0 op_sel_hi:[1,0]
    v_pk_add_f32 v[162:163], v[162:163], 1.0 op_sel_hi:[1,0]
    v_rcp_f32 v160, v160
    v_rcp_f32 v161, v161
    v_rcp_f32 v162, v162
    v_rcp_f32 v163, v163
    v_pk_mul_f32 v[108:109], v[108:109], v[160:161]
    v_pk_mul_f32 v[110:111], v[110:111], v[162:163]
    v_cvt_pk_bf16_f32 v82, v108, v109
    v_cvt_pk_bf16_f32 v83, v110, v111
    buffer_store_dwordx4 v[80:83], v2, s[8:11], s62 offen offset:1024 sc1
    s_lshl_b32 s40, s33, 8
    s_lshl_b32 s41, s34, 4
    s_add_u32 s40, s40, s41
    s_lshl_b32 s41, s32, 2
    s_add_u32 s40, s40, s41
    s_add_u32 s40, s40, 26492928
    v_mov_b32 v5, s96
    s_waitcnt vmcnt(0)
    s_mov_b64 exec, 1
    s_cmp_eq_u32 s37, 0
    s_cbranch_scc1 kp_s20
    buffer_store_dword v5, v4, s[8:11], s40 offen
    s_branch kp_d21
kp_s20:
    buffer_store_dword v5, v4, s[8:11], s40 offen sc1
kp_d21:
    s_mov_b64 exec, -1
    v_add_u32 v9, 32768, v2
    v_add_u32 v10, 0x10000, v9
    s_lshl_b32 s40, s32, 10
    s_add_u32 s40, s40, 0
    v_add_u32 v11, s40, v2
    v_add_u32 v12, 0x10000, v11
    v_add_u32 v208, 145920, v3
    v_and_b32 v209, 15, v1
    v_mul_u32_u24 v209, 1280, v209
    v_lshrrev_b32 v5, 1, v3
    v_add_u32 v209, v209, v5
    s_lshl_b32 s60, s35, 2
    s_add_u32 s60, s60, s32
    s_mul_i32 s60, s60, 20480
    s_mul_i32 s43, s36, 160
    s_add_u32 s60, s60, s43
    s_mov_b32 s28, s24
    s_mov_b32 s29, s25
    s_mov_b32 s30, 2621440
    s_mov_b32 s31, 0x20000
    v_lshlrev_b32 v188, 16, v240
    v_and_b32 v189, 0xffff0000, v240
    v_lshlrev_b32 v190, 16, v241
    v_and_b32 v191, 0xffff0000, v241
    v_lshlrev_b32 v192, 16, v242
    v_and_b32 v193, 0xffff0000, v242
    v_lshlrev_b32 v194, 16, v243
    v_and_b32 v195, 0xffff0000, v243
    v_lshlrev_b32 v196, 16, v244
    v_and_b32 v197, 0xffff0000, v244
    v_lshlrev_b32 v198, 16, v245
    v_and_b32 v199, 0xffff0000, v245
    v_lshlrev_b32 v200, 16, v246
    v_and_b32 v201, 0xffff0000, v246
    v_lshlrev_b32 v202, 16, v247
    v_and_b32 v203, 0xffff0000, v247
    v_lshlrev_b32 v204, 16, v248
    v_and_b32 v205, 0xffff0000, v248
    v_lshlrev_b32 v206, 16, v249
    v_and_b32 v207, 0xffff0000, v249
    s_barrier
    ds_read_b128 v[80:83], v11 offset:0
    ds_read_b128 v[40:43], v9 offset:0
    ds_read_b128 v[44:47], v9 offset:1024
    ds_read_b128 v[48:51], v9 offset:2048
    ds_read_b128 v[52:55], v9 offset:3072
    ds_read_b128 v[56:59], v9 offset:4096
    ds_read_b128 v[84:87], v11 offset:4096
    ds_read_b128 v[60:63], v9 offset:5120
    ds_read_b128 v[64:67], v9 offset:6144
    ds_read_b128 v[68:71], v9 offset:7168
    ds_read_b128 v[72:75], v9 offset:8192
    ds_read_b128 v[76:79], v9 offset:9216
    s_waitcnt lgkmcnt(0)
    s_barrier
    v_mfma_f32_16x16x32_bf16 v[16:19], v[40:43], v[80:83], 0
    ds_read_b128 v[128:131], v11 offset:8192
    v_mfma_f32_16x16x32_bf16 v[20:23], v[44:47], v[80:83], 0
    ds_read_b128 v[88:91], v9 offset:10240
    v_mfma_f32_16x16x32_bf16 v[24:27], v[48:51], v[80:83], 0
    ds_read_b128 v[92:95], v9 offset:11264
    v_mfma_f32_16x16x32_bf16 v[28:31], v[52:55], v[80:83], 0
    ds_read_b128 v[96:99], v9 offset:12288
    v_mfma_f32_16x16x32_bf16 v[32:35], v[56:59], v[80:83], 0
    ds_read_b128 v[100:103], v9 offset:13312
    v_mfma_f32_16x16x32_bf16 v[16:19], v[60:63], v[84:87], v[16:19]
    ds_read_b128 v[104:107], v9 offset:14336
    v_mfma_f32_16x16x32_bf16 v[20:23], v[64:67], v[84:87], v[20:23]
    ds_read_b128 v[132:135], v11 offset:12288
    v_mfma_f32_16x16x32_bf16 v[24:27], v[68:71], v[84:87], v[24:27]
    ds_read_b128 v[108:111], v9 offset:15360
    v_mfma_f32_16x16x32_bf16 v[28:31], v[72:75], v[84:87], v[28:31]
    ds_read_b128 v[112:115], v9 offset:16384
    v_mfma_f32_16x16x32_bf16 v[32:35], v[76:79], v[84:87], v[32:35]
    ds_read_b128 v[116:119], v9 offset:17408
    ds_read_b128 v[120:123], v9 offset:18432
    ds_read_b128 v[124:127], v9 offset:19456
    s_waitcnt lgkmcnt(0)
    s_barrier
    v_mfma_f32_16x16x32_bf16 v[16:19], v[88:91], v[128:131], v[16:19]
    ds_read_b128 v[80:83], v11 offset:16384
    v_mfma_f32_16x16x32_bf16 v[20:23], v[92:95], v[128:131], v[20:23]
    ds_read_b128 v[40:43], v9 offset:20480
    v_mfma_f32_16x16x32_bf16 v[24:27], v[96:99], v[128:131], v[24:27]
    ds_read_b128 v[44:47], v9 offset:21504
    v_mfma_f32_16x16x32_bf16 v[28:31], v[100:103], v[128:131], v[28:31]
    ds_read_b128 v[48:51], v9 offset:22528
    v_mfma_f32_16x16x32_bf16 v[32:35], v[104:107], v[128:131], v[32:35]
    ds_read_b128 v[52:55], v9 offset:23552
    v_mfma_f32_16x16x32_bf16 v[16:19], v[108:111], v[132:135], v[16:19]
    ds_read_b128 v[56:59], v9 offset:24576
    v_mfma_f32_16x16x32_bf16 v[20:23], v[112:115], v[132:135], v[20:23]
    ds_read_b128 v[84:87], v11 offset:20480
    v_mfma_f32_16x16x32_bf16 v[24:27], v[116:119], v[132:135], v[24:27]
    ds_read_b128 v[60:63], v9 offset:25600
    v_mfma_f32_16x16x32_bf16 v[28:31], v[120:123], v[132:135], v[28:31]
    ds_read_b128 v[64:67], v9 offset:26624
    v_mfma_f32_16x16x32_bf16 v[32:35], v[124:127], v[132:135], v[32:35]
    ds_read_b128 v[68:71], v9 offset:27648
    ds_read_b128 v[72:75], v9 offset:28672
    ds_read_b128 v[76:79], v9 offset:29696
    s_waitcnt lgkmcnt(0)
    s_barrier
    v_mfma_f32_16x16x32_bf16 v[16:19], v[40:43], v[80:83], v[16:19]
    ds_read_b128 v[128:131], v11 offset:24576
    v_mfma_f32_16x16x32_bf16 v[20:23], v[44:47], v[80:83], v[20:23]
    ds_read_b128 v[88:91], v9 offset:30720
    v_mfma_f32_16x16x32_bf16 v[24:27], v[48:51], v[80:83], v[24:27]
    ds_read_b128 v[92:95], v9 offset:31744
    v_mfma_f32_16x16x32_bf16 v[28:31], v[52:55], v[80:83], v[28:31]
    ds_read_b128 v[96:99], v9 offset:32768
    v_mfma_f32_16x16x32_bf16 v[32:35], v[56:59], v[80:83], v[32:35]
    ds_read_b128 v[100:103], v9 offset:33792
    v_mfma_f32_16x16x32_bf16 v[16:19], v[60:63], v[84:87], v[16:19]
    ds_read_b128 v[104:107], v9 offset:34816
    v_mfma_f32_16x16x32_bf16 v[20:23], v[64:67], v[84:87], v[20:23]
    ds_read_b128 v[132:135], v11 offset:28672
    v_mfma_f32_16x16x32_bf16 v[24:27], v[68:71], v[84:87], v[24:27]
    ds_read_b128 v[108:111], v9 offset:35840
    v_mfma_f32_16x16x32_bf16 v[28:31], v[72:75], v[84:87], v[28:31]
    ds_read_b128 v[112:115], v9 offset:36864
    v_mfma_f32_16x16x32_bf16 v[32:35], v[76:79], v[84:87], v[32:35]
    ds_read_b128 v[116:119], v9 offset:37888
    ds_read_b128 v[120:123], v9 offset:38912
    ds_read_b128 v[124:127], v9 offset:39936
    s_waitcnt lgkmcnt(0)
    s_barrier
    v_mfma_f32_16x16x32_bf16 v[16:19], v[88:91], v[128:131], v[16:19]
    ds_read_b128 v[80:83], v11 offset:0
    v_mfma_f32_16x16x32_bf16 v[20:23], v[92:95], v[128:131], v[20:23]
    ds_read_b128 v[40:43], v9 offset:40960
    v_mfma_f32_16x16x32_bf16 v[24:27], v[96:99], v[128:131], v[24:27]
    ds_read_b128 v[44:47], v9 offset:41984
    v_mfma_f32_16x16x32_bf16 v[28:31], v[100:103], v[128:131], v[28:31]
    ds_read_b128 v[48:51], v9 offset:43008
    v_mfma_f32_16x16x32_bf16 v[32:35], v[104:107], v[128:131], v[32:35]
    ds_read_b128 v[52:55], v9 offset:44032
    v_mfma_f32_16x16x32_bf16 v[16:19], v[108:111], v[132:135], v[16:19]
    ds_read_b128 v[56:59], v9 offset:45056
    v_mfma_f32_16x16x32_bf16 v[20:23], v[112:115], v[132:135], v[20:23]
    ds_read_b128 v[84:87], v11 offset:4096
    v_mfma_f32_16x16x32_bf16 v[24:27], v[116:119], v[132:135], v[24:27]
    ds_read_b128 v[60:63], v9 offset:46080
    v_mfma_f32_16x16x32_bf16 v[28:31], v[120:123], v[132:135], v[28:31]
    ds_read_b128 v[64:67], v9 offset:47104
    v_mfma_f32_16x16x32_bf16 v[32:35], v[124:127], v[132:135], v[32:35]
    ds_read_b128 v[68:71], v9 offset:48128
    ds_read_b128 v[72:75], v9 offset:49152
    ds_read_b128 v[76:79], v9 offset:50176
    s_waitcnt lgkmcnt(0)
    s_barrier
    v_mfma_f32_16x16x32_bf16 v[16:19], v[40:43], v[80:83], v[16:19]
    ds_read_b128 v[128:131], v11 offset:8192
    v_mfma_f32_16x16x32_bf16 v[20:23], v[44:47], v[80:83], v[20:23]
    ds_read_b128 v[88:91], v9 offset:51200
    v_mfma_f32_16x16x32_bf16 v[24:27], v[48:51], v[80:83], v[24:27]
    ds_read_b128 v[92:95], v9 offset:52224
    v_mfma_f32_16x16x32_bf16 v[28:31], v[52:55], v[80:83], v[28:31]
    ds_read_b128 v[96:99], v9 offset:53248
    v_mfma_f32_16x16x32_bf16 v[32:35], v[56:59], v[80:83], v[32:35]
    ds_read_b128 v[100:103], v9 offset:54272
    v_mfma_f32_16x16x32_bf16 v[16:19], v[60:63], v[84:87], v[16:19]
    ds_read_b128 v[104:107], v9 offset:55296
    v_mfma_f32_16x16x32_bf16 v[20:23], v[64:67], v[84:87], v[20:23]
    ds_read_b128 v[132:135], v11 offset:12288
    v_mfma_f32_16x16x32_bf16 v[24:27], v[68:71], v[84:87], v[24:27]
    ds_read_b128 v[108:111], v9 offset:56320
    v_mfma_f32_16x16x32_bf16 v[28:31], v[72:75], v[84:87], v[28:31]
    ds_read_b128 v[112:115], v9 offset:57344
    v_mfma_f32_16x16x32_bf16 v[32:35], v[76:79], v[84:87], v[32:35]
    ds_read_b128 v[116:119], v9 offset:58368
    ds_read_b128 v[120:123], v9 offset:59392
    ds_read_b128 v[124:127], v9 offset:60416
    s_waitcnt lgkmcnt(0)
    s_barrier
    v_mfma_f32_16x16x32_bf16 v[16:19], v[88:91], v[128:131], v[16:19]
    ds_read_b128 v[80:83], v11 offset:16384
    v_mfma_f32_16x16x32_bf16 v[20:23], v[92:95], v[128:131], v[20:23]
    ds_read_b128 v[40:43], v9 offset:0
    v_mfma_f32_16x16x32_bf16 v[24:27], v[96:99], v[128:131], v[24:27]
    ds_read_b128 v[44:47], v9 offset:1024
    v_mfma_f32_16x16x32_bf16 v[28:31], v[100:103], v[128:131], v[28:31]
    ds_read_b128 v[48:51], v9 offset:2048
    v_mfma_f32_16x16x32_bf16 v[32:35], v[104:107], v[128:131], v[32:35]
    ds_read_b128 v[52:55], v9 offset:3072
    v_mfma_f32_16x16x32_bf16 v[16:19], v[108:111], v[132:135], v[16:19]
    ds_read_b128 v[56:59], v9 offset:4096
    v_mfma_f32_16x16x32_bf16 v[20:23], v[112:115], v[132:135], v[20:23]
    ds_read_b128 v[84:87], v11 offset:20480
    v_mfma_f32_16x16x32_bf16 v[24:27], v[116:119], v[132:135], v[24:27]
    ds_read_b128 v[60:63], v9 offset:5120
    v_mfma_f32_16x16x32_bf16 v[28:31], v[120:123], v[132:135], v[28:31]
    ds_read_b128 v[64:67], v9 offset:6144
    v_mfma_f32_16x16x32_bf16 v[32:35], v[124:127], v[132:135], v[32:35]
    ds_read_b128 v[68:71], v9 offset:7168
    ds_read_b128 v[72:75], v9 offset:8192
    ds_read_b128 v[76:79], v9 offset:9216
    s_waitcnt lgkmcnt(0)
    s_barrier
    v_mfma_f32_16x16x32_bf16 v[16:19], v[40:43], v[80:83], v[16:19]
    ds_read_b128 v[128:131], v11 offset:24576
    v_mfma_f32_16x16x32_bf16 v[20:23], v[44:47], v[80:83], v[20:23]
    ds_read_b128 v[88:91], v9 offset:10240
    v_mfma_f32_16x16x32_bf16 v[24:27], v[48:51], v[80:83], v[24:27]
    ds_read_b128 v[92:95], v9 offset:11264
    v_mfma_f32_16x16x32_bf16 v[28:31], v[52:55], v[80:83], v[28:31]
    ds_read_b128 v[96:99], v9 offset:12288
    v_mfma_f32_16x16x32_bf16 v[32:35], v[56:59], v[80:83], v[32:35]
    ds_read_b128 v[100:103], v9 offset:13312
    v_mfma_f32_16x16x32_bf16 v[16:19], v[60:63], v[84:87], v[16:19]
    ds_read_b128 v[104:107], v9 offset:14336
    v_mfma_f32_16x16x32_bf16 v[20:23], v[64:67], v[84:87], v[20:23]
    ds_read_b128 v[132:135], v11 offset:28672
    v_mfma_f32_16x16x32_bf16 v[24:27], v[68:71], v[84:87], v[24:27]
    ds_read_b128 v[108:111], v9 offset:15360
    v_mfma_f32_16x16x32_bf16 v[28:31], v[72:75], v[84:87], v[28:31]
    ds_read_b128 v[112:115], v9 offset:16384
    v_mfma_f32_16x16x32_bf16 v[32:35], v[76:79], v[84:87], v[32:35]
    ds_read_b128 v[116:119], v9 offset:17408
    ds_read_b128 v[120:123], v9 offset:18432
    ds_read_b128 v[124:127], v9 offset:19456
    s_waitcnt lgkmcnt(0)
    s_barrier
    v_mfma_f32_16x16x32_bf16 v[16:19], v[88:91], v[128:131], v[16:19]
    ds_read_b128 v[80:83], v11 offset:0
    v_mfma_f32_16x16x32_bf16 v[20:23], v[92:95], v[128:131], v[20:23]
    ds_read_b128 v[40:43], v9 offset:20480
    v_mfma_f32_16x16x32_bf16 v[24:27], v[96:99], v[128:131], v[24:27]
    ds_read_b128 v[44:47], v9 offset:21504
    v_mfma_f32_16x16x32_bf16 v[28:31], v[100:103], v[128:131], v[28:31]
    ds_read_b128 v[48:51], v9 offset:22528
    v_mfma_f32_16x16x32_bf16 v[32:35], v[104:107], v[128:131], v[32:35]
    ds_read_b128 v[52:55], v9 offset:23552
    v_mfma_f32_16x16x32_bf16 v[16:19], v[108:111], v[132:135], v[16:19]
    ds_read_b128 v[56:59], v9 offset:24576
    v_mfma_f32_16x16x32_bf16 v[20:23], v[112:115], v[132:135], v[20:23]
    ds_read_b128 v[84:87], v11 offset:4096
    v_mfma_f32_16x16x32_bf16 v[24:27], v[116:119], v[132:135], v[24:27]
    ds_read_b128 v[60:63], v9 offset:25600
    v_mfma_f32_16x16x32_bf16 v[28:31], v[120:123], v[132:135], v[28:31]
    ds_read_b128 v[64:67], v9 offset:26624
    v_mfma_f32_16x16x32_bf16 v[32:35], v[124:127], v[132:135], v[32:35]
    ds_read_b128 v[68:71], v9 offset:27648
    ds_read_b128 v[72:75], v9 offset:28672
    ds_read_b128 v[76:79], v9 offset:29696
    s_waitcnt lgkmcnt(0)
    s_barrier
    v_mfma_f32_16x16x32_bf16 v[16:19], v[40:43], v[80:83], v[16:19]
    ds_read_b128 v[128:131], v11 offset:8192
    v_mfma_f32_16x16x32_bf16 v[20:23], v[44:47], v[80:83], v[20:23]
    ds_read_b128 v[88:91], v9 offset:30720
    v_mfma_f32_16x16x32_bf16 v[24:27], v[48:51], v[80:83], v[24:27]
    ds_read_b128 v[92:95], v9 offset:31744
    v_mfma_f32_16x16x32_bf16 v[28:31], v[52:55], v[80:83], v[28:31]
    ds_read_b128 v[96:99], v9 offset:32768
    v_mfma_f32_16x16x32_bf16 v[32:35], v[56:59], v[80:83], v[32:35]
    ds_read_b128 v[100:103], v9 offset:33792
    v_mfma_f32_16x16x32_bf16 v[16:19], v[60:63], v[84:87], v[16:19]
    ds_read_b128 v[104:107], v9 offset:34816
    v_mfma_f32_16x16x32_bf16 v[20:23], v[64:67], v[84:87], v[20:23]
    ds_read_b128 v[132:135], v11 offset:12288
    v_mfma_f32_16x16x32_bf16 v[24:27], v[68:71], v[84:87], v[24:27]
    ds_read_b128 v[108:111], v9 offset:35840
    v_mfma_f32_16x16x32_bf16 v[28:31], v[72:75], v[84:87], v[28:31]
    ds_read_b128 v[112:115], v9 offset:36864
    v_mfma_f32_16x16x32_bf16 v[32:35], v[76:79], v[84:87], v[32:35]
    ds_read_b128 v[116:119], v9 offset:37888
    ds_read_b128 v[120:123], v9 offset:38912
    ds_read_b128 v[124:127], v9 offset:39936
    s_waitcnt lgkmcnt(0)
    s_barrier
    v_mfma_f32_16x16x32_bf16 v[16:19], v[88:91], v[128:131], v[16:19]
    ds_read_b128 v[80:83], v11 offset:16384
    v_mfma_f32_16x16x32_bf16 v[20:23], v[92:95], v[128:131], v[20:23]
    ds_read_b128 v[40:43], v9 offset:40960
    v_mfma_f32_16x16x32_bf16 v[24:27], v[96:99], v[128:131], v[24:27]
    ds_read_b128 v[44:47], v9 offset:41984
    v_mfma_f32_16x16x32_bf16 v[28:31], v[100:103], v[128:131], v[28:31]
    ds_read_b128 v[48:51], v9 offset:43008
    v_mfma_f32_16x16x32_bf16 v[32:35], v[104:107], v[128:131], v[32:35]
    ds_read_b128 v[52:55], v9 offset:44032
    v_mfma_f32_16x16x32_bf16 v[16:19], v[108:111], v[132:135], v[16:19]
    ds_read_b128 v[56:59], v9 offset:45056
    v_mfma_f32_16x16x32_bf16 v[20:23], v[112:115], v[132:135], v[20:23]
    ds_read_b128 v[84:87], v11 offset:20480
    v_mfma_f32_16x16x32_bf16 v[24:27], v[116:119], v[132:135], v[24:27]
    ds_read_b128 v[60:63], v9 offset:46080
    v_mfma_f32_16x16x32_bf16 v[28:31], v[120:123], v[132:135], v[28:31]
    ds_read_b128 v[64:67], v9 offset:47104
    v_mfma_f32_16x16x32_bf16 v[32:35], v[124:127], v[132:135], v[32:35]
    ds_read_b128 v[68:71], v9 offset:48128
    ds_read_b128 v[72:75], v9 offset:49152
    ds_read_b128 v[76:79], v9 offset:50176
    s_waitcnt lgkmcnt(0)
    s_barrier
    v_mfma_f32_16x16x32_bf16 v[16:19], v[40:43], v[80:83], v[16:19]
    ds_read_b128 v[128:131], v11 offset:24576
    v_mfma_f32_16x16x32_bf16 v[20:23], v[44:47], v[80:83], v[20:23]
    ds_read_b128 v[88:91], v9 offset:51200
    v_mfma_f32_16x16x32_bf16 v[24:27], v[48:51], v[80:83], v[24:27]
    ds_read_b128 v[92:95], v9 offset:52224
    v_mfma_f32_16x16x32_bf16 v[28:31], v[52:55], v[80:83], v[28:31]
    ds_read_b128 v[96:99], v9 offset:53248
    v_mfma_f32_16x16x32_bf16 v[32:35], v[56:59], v[80:83], v[32:35]
    ds_read_b128 v[100:103], v9 offset:54272
    v_mfma_f32_16x16x32_bf16 v[16:19], v[60:63], v[84:87], v[16:19]
    ds_read_b128 v[104:107], v9 offset:55296
    v_mfma_f32_16x16x32_bf16 v[20:23], v[64:67], v[84:87], v[20:23]
    ds_read_b128 v[132:135], v11 offset:28672
    v_mfma_f32_16x16x32_bf16 v[24:27], v[68:71], v[84:87], v[24:27]
    ds_read_b128 v[108:111], v9 offset:56320
    v_mfma_f32_16x16x32_bf16 v[28:31], v[72:75], v[84:87], v[28:31]
    ds_read_b128 v[112:115], v9 offset:57344
    v_mfma_f32_16x16x32_bf16 v[32:35], v[76:79], v[84:87], v[32:35]
    ds_read_b128 v[116:119], v9 offset:58368
    ds_read_b128 v[120:123], v9 offset:59392
    ds_read_b128 v[124:127], v9 offset:60416
    s_waitcnt lgkmcnt(0)
    s_barrier
    v_mfma_f32_16x16x32_bf16 v[16:19], v[88:91], v[128:131], v[16:19]
    ds_read_b128 v[80:83], v11 offset:0
    v_mfma_f32_16x16x32_bf16 v[20:23], v[92:95], v[128:131], v[20:23]
    ds_read_b128 v[40:43], v9 offset:0
    v_mfma_f32_16x16x32_bf16 v[24:27], v[96:99], v[128:131], v[24:27]
    ds_read_b128 v[44:47], v9 offset:1024
    v_mfma_f32_16x16x32_bf16 v[28:31], v[100:103], v[128:131], v[28:31]
    ds_read_b128 v[48:51], v9 offset:2048
    v_mfma_f32_16x16x32_bf16 v[32:35], v[104:107], v[128:131], v[32:35]
    ds_read_b128 v[52:55], v9 offset:3072
    v_mfma_f32_16x16x32_bf16 v[16:19], v[108:111], v[132:135], v[16:19]
    ds_read_b128 v[56:59], v9 offset:4096
    v_mfma_f32_16x16x32_bf16 v[20:23], v[112:115], v[132:135], v[20:23]
    ds_read_b128 v[84:87], v11 offset:4096
    v_mfma_f32_16x16x32_bf16 v[24:27], v[116:119], v[132:135], v[24:27]
    ds_read_b128 v[60:63], v9 offset:5120
    v_mfma_f32_16x16x32_bf16 v[28:31], v[120:123], v[132:135], v[28:31]
    ds_read_b128 v[64:67], v9 offset:6144
    v_mfma_f32_16x16x32_bf16 v[32:35], v[124:127], v[132:135], v[32:35]
    ds_read_b128 v[68:71], v9 offset:7168
    ds_read_b128 v[72:75], v9 offset:8192
    ds_read_b128 v[76:79], v9 offset:9216
    s_waitcnt lgkmcnt(0)
    s_barrier
    v_mfma_f32_16x16x32_bf16 v[16:19], v[40:43], v[80:83], v[16:19]
    ds_read_b128 v[128:131], v11 offset:8192
    v_mfma_f32_16x16x32_bf16 v[20:23], v[44:47], v[80:83], v[20:23]
    ds_read_b128 v[88:91], v9 offset:10240
    v_mfma_f32_16x16x32_bf16 v[24:27], v[48:51], v[80:83], v[24:27]
    ds_read_b128 v[92:95], v9 offset:11264
    v_mfma_f32_16x16x32_bf16 v[28:31], v[52:55], v[80:83], v[28:31]
    ds_read_b128 v[96:99], v9 offset:12288
    v_mfma_f32_16x16x32_bf16 v[32:35], v[56:59], v[80:83], v[32:35]
    ds_read_b128 v[100:103], v9 offset:13312
    v_mfma_f32_16x16x32_bf16 v[16:19], v[60:63], v[84:87], v[16:19]
    ds_read_b128 v[104:107], v9 offset:14336
    v_mfma_f32_16x16x32_bf16 v[20:23], v[64:67], v[84:87], v[20:23]
    ds_read_b128 v[132:135], v11 offset:12288
    v_mfma_f32_16x16x32_bf16 v[24:27], v[68:71], v[84:87], v[24:27]
    ds_read_b128 v[108:111], v9 offset:15360
    v_mfma_f32_16x16x32_bf16 v[28:31], v[72:75], v[84:87], v[28:31]
    ds_read_b128 v[112:115], v9 offset:16384
    v_mfma_f32_16x16x32_bf16 v[32:35], v[76:79], v[84:87], v[32:35]
    ds_read_b128 v[116:119], v9 offset:17408
    ds_read_b128 v[120:123], v9 offset:18432
    ds_read_b128 v[124:127], v9 offset:19456
    s_waitcnt lgkmcnt(0)
    s_barrier
    v_mfma_f32_16x16x32_bf16 v[16:19], v[88:91], v[128:131], v[16:19]
    ds_read_b128 v[80:83], v11 offset:16384
    v_mfma_f32_16x16x32_bf16 v[20:23], v[92:95], v[128:131], v[20:23]
    ds_read_b128 v[40:43], v9 offset:20480
    v_mfma_f32_16x16x32_bf16 v[24:27], v[96:99], v[128:131], v[24:27]
    ds_read_b128 v[44:47], v9 offset:21504
    v_mfma_f32_16x16x32_bf16 v[28:31], v[100:103], v[128:131], v[28:31]
    ds_read_b128 v[48:51], v9 offset:22528
    v_mfma_f32_16x16x32_bf16 v[32:35], v[104:107], v[128:131], v[32:35]
    ds_read_b128 v[52:55], v9 offset:23552
    v_mfma_f32_16x16x32_bf16 v[16:19], v[108:111], v[132:135], v[16:19]
    ds_read_b128 v[56:59], v9 offset:24576
    v_mfma_f32_16x16x32_bf16 v[20:23], v[112:115], v[132:135], v[20:23]
    ds_read_b128 v[84:87], v11 offset:20480
    v_mfma_f32_16x16x32_bf16 v[24:27], v[116:119], v[132:135], v[24:27]
    ds_read_b128 v[60:63], v9 offset:25600
    v_mfma_f32_16x16x32_bf16 v[28:31], v[120:123], v[132:135], v[28:31]
    ds_read_b128 v[64:67], v9 offset:26624
    v_mfma_f32_16x16x32_bf16 v[32:35], v[124:127], v[132:135], v[32:35]
    ds_read_b128 v[68:71], v9 offset:27648
    ds_read_b128 v[72:75], v9 offset:28672
    ds_read_b128 v[76:79], v9 offset:29696
    s_waitcnt lgkmcnt(0)
    s_barrier
    v_mfma_f32_16x16x32_bf16 v[16:19], v[40:43], v[80:83], v[16:19]
    ds_read_b128 v[128:131], v11 offset:24576
    v_mfma_f32_16x16x32_bf16 v[20:23], v[44:47], v[80:83], v[20:23]
    ds_read_b128 v[88:91], v9 offset:30720
    v_mfma_f32_16x16x32_bf16 v[24:27], v[48:51], v[80:83], v[24:27]
    ds_read_b128 v[92:95], v9 offset:31744
    v_mfma_f32_16x16x32_bf16 v[28:31], v[52:55], v[80:83], v[28:31]
    ds_read_b128 v[96:99], v9 offset:32768
    v_mfma_f32_16x16x32_bf16 v[32:35], v[56:59], v[80:83], v[32:35]
    ds_read_b128 v[100:103], v9 offset:33792
    v_mfma_f32_16x16x32_bf16 v[16:19], v[60:63], v[84:87], v[16:19]
    ds_read_b128 v[104:107], v9 offset:34816
    v_mfma_f32_16x16x32_bf16 v[20:23], v[64:67], v[84:87], v[20:23]
    ds_read_b128 v[132:135], v11 offset:28672
    v_mfma_f32_16x16x32_bf16 v[24:27], v[68:71], v[84:87], v[24:27]
    ds_read_b128 v[108:111], v9 offset:35840
    v_mfma_f32_16x16x32_bf16 v[28:31], v[72:75], v[84:87], v[28:31]
    ds_read_b128 v[112:115], v9 offset:36864
    v_mfma_f32_16x16x32_bf16 v[32:35], v[76:79], v[84:87], v[32:35]
    ds_read_b128 v[116:119], v9 offset:37888
    ds_read_b128 v[120:123], v9 offset:38912
    ds_read_b128 v[124:127], v9 offset:39936
    s_waitcnt lgkmcnt(0)
    s_barrier
    v_mfma_f32_16x16x32_bf16 v[16:19], v[88:91], v[128:131], v[16:19]
    ds_read_b128 v[80:83], v11 offset:0
    v_mfma_f32_16x16x32_bf16 v[20:23], v[92:95], v[128:131], v[20:23]
    ds_read_b128 v[40:43], v9 offset:40960
    v_mfma_f32_16x16x32_bf16 v[24:27], v[96:99], v[128:131], v[24:27]
    ds_read_b128 v[44:47], v9 offset:41984
    v_mfma_f32_16x16x32_bf16 v[28:31], v[100:103], v[128:131], v[28:31]
    ds_read_b128 v[48:51], v9 offset:43008
    v_mfma_f32_16x16x32_bf16 v[32:35], v[104:107], v[128:131], v[32:35]
    ds_read_b128 v[52:55], v9 offset:44032
    v_mfma_f32_16x16x32_bf16 v[16:19], v[108:111], v[132:135], v[16:19]
    ds_read_b128 v[56:59], v9 offset:45056
    v_mfma_f32_16x16x32_bf16 v[20:23], v[112:115], v[132:135], v[20:23]
    ds_read_b128 v[84:87], v11 offset:4096
    v_mfma_f32_16x16x32_bf16 v[24:27], v[116:119], v[132:135], v[24:27]
    ds_read_b128 v[60:63], v9 offset:46080
    v_mfma_f32_16x16x32_bf16 v[28:31], v[120:123], v[132:135], v[28:31]
    ds_read_b128 v[64:67], v9 offset:47104
    v_mfma_f32_16x16x32_bf16 v[32:35], v[124:127], v[132:135], v[32:35]
    ds_read_b128 v[68:71], v9 offset:48128
    ds_read_b128 v[72:75], v9 offset:49152
    ds_read_b128 v[76:79], v9 offset:50176
    s_waitcnt lgkmcnt(0)
    s_barrier
    v_mfma_f32_16x16x32_bf16 v[16:19], v[40:43], v[80:83], v[16:19]
    ds_read_b128 v[128:131], v11 offset:8192
    v_mfma_f32_16x16x32_bf16 v[20:23], v[44:47], v[80:83], v[20:23]
    ds_read_b128 v[88:91], v9 offset:51200
    v_mfma_f32_16x16x32_bf16 v[24:27], v[48:51], v[80:83], v[24:27]
    ds_read_b128 v[92:95], v9 offset:52224
    v_mfma_f32_16x16x32_bf16 v[28:31], v[52:55], v[80:83], v[28:31]
    ds_read_b128 v[96:99], v9 offset:53248
    v_mfma_f32_16x16x32_bf16 v[32:35], v[56:59], v[80:83], v[32:35]
    ds_read_b128 v[100:103], v9 offset:54272
    v_mfma_f32_16x16x32_bf16 v[16:19], v[60:63], v[84:87], v[16:19]
    ds_read_b128 v[104:107], v9 offset:55296
    v_mfma_f32_16x16x32_bf16 v[20:23], v[64:67], v[84:87], v[20:23]
    ds_read_b128 v[132:135], v11 offset:12288
    v_mfma_f32_16x16x32_bf16 v[24:27], v[68:71], v[84:87], v[24:27]
    ds_read_b128 v[108:111], v9 offset:56320
    v_mfma_f32_16x16x32_bf16 v[28:31], v[72:75], v[84:87], v[28:31]
    ds_read_b128 v[112:115], v9 offset:57344
    v_mfma_f32_16x16x32_bf16 v[32:35], v[76:79], v[84:87], v[32:35]
    ds_read_b128 v[116:119], v9 offset:58368
    ds_read_b128 v[120:123], v9 offset:59392
    ds_read_b128 v[124:127], v9 offset:60416
    s_waitcnt lgkmcnt(0)
    s_barrier
    v_mfma_f32_16x16x32_bf16 v[16:19], v[88:91], v[128:131], v[16:19]
    ds_read_b128 v[80:83], v11 offset:16384
    v_mfma_f32_16x16x32_bf16 v[20:23], v[92:95], v[128:131], v[20:23]
    ds_read_b128 v[40:43], v9 offset:0
    v_mfma_f32_16x16x32_bf16 v[24:27], v[96:99], v[128:131], v[24:27]
    ds_read_b128 v[44:47], v9 offset:1024
    v_mfma_f32_16x16x32_bf16 v[28:31], v[100:103], v[128:131], v[28:31]
    ds_read_b128 v[48:51], v9 offset:2048
    v_mfma_f32_16x16x32_bf16 v[32:35], v[104:107], v[128:131], v[32:35]
    ds_read_b128 v[52:55], v9 offset:3072
    v_mfma_f32_16x16x32_bf16 v[16:19], v[108:111], v[132:135], v[16:19]
    ds_read_b128 v[56:59], v9 offset:4096
    v_mfma_f32_16x16x32_bf16 v[20:23], v[112:115], v[132:135], v[20:23]
    ds_read_b128 v[84:87], v11 offset:20480
    v_mfma_f32_16x16x32_bf16 v[24:27], v[116:119], v[132:135], v[24:27]
    ds_read_b128 v[60:63], v9 offset:5120
    v_mfma_f32_16x16x32_bf16 v[28:31], v[120:123], v[132:135], v[28:31]
    ds_read_b128 v[64:67], v9 offset:6144
    v_mfma_f32_16x16x32_bf16 v[32:35], v[124:127], v[132:135], v[32:35]
    ds_read_b128 v[68:71], v9 offset:7168
    ds_read_b128 v[72:75], v9 offset:8192
    ds_read_b128 v[76:79], v9 offset:9216
    s_waitcnt lgkmcnt(0)
    s_barrier
    v_mfma_f32_16x16x32_bf16 v[16:19], v[40:43], v[80:83], v[16:19]
    ds_read_b128 v[128:131], v11 offset:24576
    v_mfma_f32_16x16x32_bf16 v[20:23], v[44:47], v[80:83], v[20:23]
    ds_read_b128 v[88:91], v9 offset:10240
    v_mfma_f32_16x16x32_bf16 v[24:27], v[48:51], v[80:83], v[24:27]
    ds_read_b128 v[92:95], v9 offset:11264
    v_mfma_f32_16x16x32_bf16 v[28:31], v[52:55], v[80:83], v[28:31]
    ds_read_b128 v[96:99], v9 offset:12288
    v_mfma_f32_16x16x32_bf16 v[32:35], v[56:59], v[80:83], v[32:35]
    ds_read_b128 v[100:103], v9 offset:13312
    v_mfma_f32_16x16x32_bf16 v[16:19], v[60:63], v[84:87], v[16:19]
    ds_read_b128 v[104:107], v9 offset:14336
    v_mfma_f32_16x16x32_bf16 v[20:23], v[64:67], v[84:87], v[20:23]
    ds_read_b128 v[132:135], v11 offset:28672
    v_mfma_f32_16x16x32_bf16 v[24:27], v[68:71], v[84:87], v[24:27]
    ds_read_b128 v[108:111], v9 offset:15360
    v_mfma_f32_16x16x32_bf16 v[28:31], v[72:75], v[84:87], v[28:31]
    ds_read_b128 v[112:115], v9 offset:16384
    v_mfma_f32_16x16x32_bf16 v[32:35], v[76:79], v[84:87], v[32:35]
    ds_read_b128 v[116:119], v9 offset:17408
    ds_read_b128 v[120:123], v9 offset:18432
    ds_read_b128 v[124:127], v9 offset:19456
    s_waitcnt lgkmcnt(0)
    s_barrier
    v_mfma_f32_16x16x32_bf16 v[16:19], v[88:91], v[128:131], v[16:19]
    ds_read_b128 v[80:83], v11 offset:0
    v_mfma_f32_16x16x32_bf16 v[20:23], v[92:95], v[128:131], v[20:23]
    ds_read_b128 v[40:43], v9 offset:20480
    v_mfma_f32_16x16x32_bf16 v[24:27], v[96:99], v[128:131], v[24:27]
    ds_read_b128 v[44:47], v9 offset:21504
    v_mfma_f32_16x16x32_bf16 v[28:31], v[100:103], v[128:131], v[28:31]
    ds_read_b128 v[48:51], v9 offset:22528
    v_mfma_f32_16x16x32_bf16 v[32:35], v[104:107], v[128:131], v[32:35]
    ds_read_b128 v[52:55], v9 offset:23552
    v_mfma_f32_16x16x32_bf16 v[16:19], v[108:111], v[132:135], v[16:19]
    ds_read_b128 v[56:59], v9 offset:24576
    v_mfma_f32_16x16x32_bf16 v[20:23], v[112:115], v[132:135], v[20:23]
    ds_read_b128 v[84:87], v11 offset:4096
    v_mfma_f32_16x16x32_bf16 v[24:27], v[116:119], v[132:135], v[24:27]
    ds_read_b128 v[60:63], v9 offset:25600
    v_mfma_f32_16x16x32_bf16 v[28:31], v[120:123], v[132:135], v[28:31]
    ds_read_b128 v[64:67], v9 offset:26624
    v_mfma_f32_16x16x32_bf16 v[32:35], v[124:127], v[132:135], v[32:35]
    ds_read_b128 v[68:71], v9 offset:27648
    ds_read_b128 v[72:75], v9 offset:28672
    ds_read_b128 v[76:79], v9 offset:29696
    s_waitcnt lgkmcnt(0)
    s_barrier
    v_mfma_f32_16x16x32_bf16 v[16:19], v[40:43], v[80:83], v[16:19]
    ds_read_b128 v[128:131], v11 offset:8192
    v_mfma_f32_16x16x32_bf16 v[20:23], v[44:47], v[80:83], v[20:23]
    ds_read_b128 v[88:91], v9 offset:30720
    v_mfma_f32_16x16x32_bf16 v[24:27], v[48:51], v[80:83], v[24:27]
    ds_read_b128 v[92:95], v9 offset:31744
    v_mfma_f32_16x16x32_bf16 v[28:31], v[52:55], v[80:83], v[28:31]
    ds_read_b128 v[96:99], v9 offset:32768
    v_mfma_f32_16x16x32_bf16 v[32:35], v[56:59], v[80:83], v[32:35]
    ds_read_b128 v[100:103], v9 offset:33792
    v_mfma_f32_16x16x32_bf16 v[16:19], v[60:63], v[84:87], v[16:19]
    ds_read_b128 v[104:107], v9 offset:34816
    v_mfma_f32_16x16x32_bf16 v[20:23], v[64:67], v[84:87], v[20:23]
    ds_read_b128 v[132:135], v11 offset:12288
    v_mfma_f32_16x16x32_bf16 v[24:27], v[68:71], v[84:87], v[24:27]
    ds_read_b128 v[108:111], v9 offset:35840
    v_mfma_f32_16x16x32_bf16 v[28:31], v[72:75], v[84:87], v[28:31]
    ds_read_b128 v[112:115], v9 offset:36864
    v_mfma_f32_16x16x32_bf16 v[32:35], v[76:79], v[84:87], v[32:35]
    ds_read_b128 v[116:119], v9 offset:37888
    ds_read_b128 v[120:123], v9 offset:38912
    ds_read_b128 v[124:127], v9 offset:39936
    s_waitcnt lgkmcnt(0)
    s_barrier
    v_mfma_f32_16x16x32_bf16 v[16:19], v[88:91], v[128:131], v[16:19]
    ds_read_b128 v[80:83], v11 offset:16384
    v_mfma_f32_16x16x32_bf16 v[20:23], v[92:95], v[128:131], v[20:23]
    ds_read_b128 v[40:43], v9 offset:40960
    v_mfma_f32_16x16x32_bf16 v[24:27], v[96:99], v[128:131], v[24:27]
    ds_read_b128 v[44:47], v9 offset:41984
    v_mfma_f32_16x16x32_bf16 v[28:31], v[100:103], v[128:131], v[28:31]
    ds_read_b128 v[48:51], v9 offset:43008
    v_mfma_f32_16x16x32_bf16 v[32:35], v[104:107], v[128:131], v[32:35]
    ds_read_b128 v[52:55], v9 offset:44032
    v_mfma_f32_16x16x32_bf16 v[16:19], v[108:111], v[132:135], v[16:19]
    ds_read_b128 v[56:59], v9 offset:45056
    v_mfma_f32_16x16x32_bf16 v[20:23], v[112:115], v[132:135], v[20:23]
    ds_read_b128 v[84:87], v11 offset:20480
    v_mfma_f32_16x16x32_bf16 v[24:27], v[116:119], v[132:135], v[24:27]
    ds_read_b128 v[60:63], v9 offset:46080
    v_mfma_f32_16x16x32_bf16 v[28:31], v[120:123], v[132:135], v[28:31]
    ds_read_b128 v[64:67], v9 offset:47104
    v_mfma_f32_16x16x32_bf16 v[32:35], v[124:127], v[132:135], v[32:35]
    ds_read_b128 v[68:71], v9 offset:48128
    ds_read_b128 v[72:75], v9 offset:49152
    ds_read_b128 v[76:79], v9 offset:50176
    s_waitcnt lgkmcnt(0)
    s_barrier
    v_mfma_f32_16x16x32_bf16 v[16:19], v[40:43], v[80:83], v[16:19]
    ds_read_b128 v[128:131], v11 offset:24576
    v_mfma_f32_16x16x32_bf16 v[20:23], v[44:47], v[80:83], v[20:23]
    ds_read_b128 v[88:91], v9 offset:51200
    v_mfma_f32_16x16x32_bf16 v[24:27], v[48:51], v[80:83], v[24:27]
    ds_read_b128 v[92:95], v9 offset:52224
    v_mfma_f32_16x16x32_bf16 v[28:31], v[52:55], v[80:83], v[28:31]
    ds_read_b128 v[96:99], v9 offset:53248
    v_mfma_f32_16x16x32_bf16 v[32:35], v[56:59], v[80:83], v[32:35]
    ds_read_b128 v[100:103], v9 offset:54272
    v_mfma_f32_16x16x32_bf16 v[16:19], v[60:63], v[84:87], v[16:19]
    ds_read_b128 v[104:107], v9 offset:55296
    v_mfma_f32_16x16x32_bf16 v[20:23], v[64:67], v[84:87], v[20:23]
    ds_read_b128 v[132:135], v11 offset:28672
    v_mfma_f32_16x16x32_bf16 v[24:27], v[68:71], v[84:87], v[24:27]
    ds_read_b128 v[108:111], v9 offset:56320
    v_mfma_f32_16x16x32_bf16 v[28:31], v[72:75], v[84:87], v[28:31]
    ds_read_b128 v[112:115], v9 offset:57344
    v_mfma_f32_16x16x32_bf16 v[32:35], v[76:79], v[84:87], v[32:35]
    ds_read_b128 v[116:119], v9 offset:58368
    ds_read_b128 v[120:123], v9 offset:59392
    ds_read_b128 v[124:127], v9 offset:60416
    s_waitcnt lgkmcnt(0)
    v_mfma_f32_16x16x32_bf16 v[16:19], v[88:91], v[128:131], v[16:19]
    ds_read_b128 v[148:151], v208 offset:0
    v_mfma_f32_16x16x32_bf16 v[20:23], v[92:95], v[128:131], v[20:23]
    ds_read_b128 v[152:155], v208 offset:64
    v_mfma_f32_16x16x32_bf16 v[24:27], v[96:99], v[128:131], v[24:27]
    ds_read_b128 v[156:159], v208 offset:128
    v_mfma_f32_16x16x32_bf16 v[28:31], v[100:103], v[128:131], v[28:31]
    ds_read_b128 v[160:163], v208 offset:192
    v_mfma_f32_16x16x32_bf16 v[32:35], v[104:107], v[128:131], v[32:35]
    ds_read_b128 v[164:167], v208 offset:256
    v_mfma_f32_16x16x32_bf16 v[16:19], v[108:111], v[132:135], v[16:19]
    v_mfma_f32_16x16x32_bf16 v[20:23], v[112:115], v[132:135], v[20:23]
    v_mfma_f32_16x16x32_bf16 v[24:27], v[116:119], v[132:135], v[24:27]
    v_mfma_f32_16x16x32_bf16 v[28:31], v[120:123], v[132:135], v[28:31]
    v_mfma_f32_16x16x32_bf16 v[32:35], v[124:127], v[132:135], v[32:35]
    s_waitcnt lgkmcnt(0)
    s_nop 2
    v_pk_fma_f32 v[188:189], v[148:149], v[16:17], v[188:189]
    v_pk_fma_f32 v[190:191], v[150:151], v[18:19], v[190:191]
    v_cvt_pk_bf16_f32 v136, v188, v189
    v_cvt_pk_bf16_f32 v137, v190, v191
    buffer_store_dwordx2 v[136:137], v209, s[28:31], s60 offen offset:0
    v_pk_fma_f32 v[192:193], v[152:153], v[20:21], v[192:193]
    v_pk_fma_f32 v[194:195], v[154:155], v[22:23], v[194:195]
    v_cvt_pk_bf16_f32 v138, v192, v193
    v_cvt_pk_bf16_f32 v139, v194, v195
    buffer_store_dwordx2 v[138:139], v209, s[28:31], s60 offen offset:32
    v_pk_fma_f32 v[196:197], v[156:157], v[24:25], v[196:197]
    v_pk_fma_f32 v[198:199], v[158:159], v[26:27], v[198:199]
    v_cvt_pk_bf16_f32 v140, v196, v197
    v_cvt_pk_bf16_f32 v141, v198, v199
    buffer_store_dwordx2 v[140:141], v209, s[28:31], s60 offen offset:64
    v_pk_fma_f32 v[200:201], v[160:161], v[28:29], v[200:201]
    v_pk_fma_f32 v[202:203], v[162:163], v[30:31], v[202:203]
    v_cvt_pk_bf16_f32 v142, v200, v201
    v_cvt_pk_bf16_f32 v143, v202, v203
    buffer_store_dwordx2 v[142:143], v209, s[28:31], s60 offen offset:96
    v_pk_fma_f32 v[204:205], v[164:165], v[32:33], v[204:205]
    v_pk_fma_f32 v[206:207], v[166:167], v[34:35], v[206:207]
    v_cvt_pk_bf16_f32 v144, v204, v205
    v_cvt_pk_bf16_f32 v145, v206, v207
    buffer_store_dwordx2 v[144:145], v209, s[28:31], s60 offen offset:128
    s_endpgm
kp_L0:
    s_mul_i32 s45, s34, 163840
    s_add_u32 s45, s45, 2641920
    s_lshl_b32 s46, s33, 13
    v_min_u32 v18, 57, v1
    v_add_u32 v16, 160, v18
    s_lshl_b32 s40, s33, 4
    s_sub_u32 s40, s40, 42
    v_add_u32 v19, s40, v18
    v_max_i32 v19, 0, v19
    v_cmp_gt_u32 vcc, 40, v18
    s_nop 1
    v_cndmask_b32 v16, v19, v16, vcc
    v_lshlrev_b32 v16, 7, v16
    v_min_u32 v18, 9, v1
    s_lshl_b32 s40, s34, 3
    v_add_u32 v17, s40, v18
    s_and_b32 s40, s34, 3
    s_lshl_b32 s40, s40, 3
    s_lshr_b32 s41, s34, 2
    s_add_u32 s40, s40, s41
    s_add_u32 s40, s40, 96
    v_lshlrev_b32 v19, 2, v18
    v_add_u32 v19, s40, v19
    v_cmp_gt_u32 vcc, 8, v18
    s_nop 1
    v_cndmask_b32 v17, v19, v17, vcc
    v_lshlrev_b32 v17, 7, v17
    s_mov_b32 s47, 26599424
    s_mov_b32 s39, 32768
kp_pm22:
    buffer_load_dword v20, v16, s[8:11], s47 offen sc1
    buffer_load_dword v21, v17, s[8:11], s47 offen sc1
    s_waitcnt vmcnt(0)
    v_cmp_eq_u32 vcc, s96, v20
    v_cmp_eq_u32 s[42:43], s96, v21
    s_nop 3
    s_and_b64 vcc, vcc, s[42:43]
    s_cmp_eq_u64 vcc, -1
    s_cbranch_scc1 kp_pn23
    s_sub_u32 s39, s39, 1
    s_cmp_lg_u32 s39, 0
    s_cbranch_scc1 kp_pm22
kp_pn23:
    s_barrier
    s_mov_b32 m0, 0
    s_nop 0
    buffer_load_dwordx4 v2, s[8:11], s46 offen lds
    buffer_load_dwordx4 v2, s[8:11], s46 offen offset:1024 lds
    buffer_load_dwordx4 v2, s[8:11], s46 offen offset:2048 lds
    buffer_load_dwordx4 v2, s[8:11], s46 offen offset:3072 lds
    s_mov_b32 m0, 4096
    s_add_u32 s40, s46, 4096
    buffer_load_dwordx4 v2, s[8:11], s40 offen lds
    buffer_load_dwordx4 v2, s[8:11], s40 offen offset:1024 lds
    s_mov_b32 m0, 17408
    s_add_u32 s40, s46, 132096
    buffer_load_dwordx4 v2, s[8:11], s40 offen lds
    buffer_load_dwordx4 v2, s[8:11], s40 offen offset:1024 lds
    buffer_load_dwordx4 v2, s[8:11], s40 offen offset:2048 lds
    buffer_load_dwordx4 v2, s[8:11], s40 offen offset:3072 lds
    s_mov_b32 m0, 21504
    s_add_u32 s40, s46, 136192
    buffer_load_dwordx4 v2, s[8:11], s40 offen lds
    s_mov_b32 m0, 34816
    s_add_u32 s40, s46, 264192
    buffer_load_dwordx4 v2, s[8:11], s40 offen lds
    buffer_load_dwordx4 v2, s[8:11], s40 offen offset:1024 lds
    buffer_load_dwordx4 v2, s[8:11], s40 offen offset:2048 lds
    buffer_load_dwordx4 v2, s[8:11], s40 offen offset:3072 lds
    s_mov_b32 m0, 38912
    s_add_u32 s40, s46, 268288
    buffer_load_dwordx4 v2, s[8:11], s40 offen lds
    buffer_load_dwordx4 v2, s[8:11], s40 offen offset:1024 lds
    s_waitcnt vmcnt(11) lgkmcnt(0)
    s_barrier
    s_mov_b32 m0, 52224
    s_add_u32 s40, s46, 396288
    buffer_load_dwordx4 v2, s[8:11], s40 offen lds
    buffer_load_dwordx4 v2, s[8:11], s40 offen offset:1024 lds
    buffer_load_dwordx4 v2, s[8:11], s40 offen offset:2048 lds
    buffer_load_dwordx4 v2, s[8:11], s40 offen offset:3072 lds
    s_waitcnt vmcnt(10) lgkmcnt(0)
    s_barrier
    s_mov_b32 m0, 0
    s_add_u32 s40, s46, 528384
    buffer_load_dwordx4 v2, s[8:11], s40 offen lds
    buffer_load_dwordx4 v2, s[8:11], s40 offen offset:1024 lds
    buffer_load_dwordx4 v2, s[8:11], s40 offen offset:2048 lds
    buffer_load_dwordx4 v2, s[8:11], s40 offen offset:3072 lds
    s_mov_b32 m0, 4096
    s_add_u32 s40, s46, 532480
    buffer_load_dwordx4 v2, s[8:11], s40 offen lds
    s_waitcnt vmcnt(9) lgkmcnt(0)
    s_barrier
    s_mov_b32 m0, 17408
    s_add_u32 s40, s46, 660480
    buffer_load_dwordx4 v2, s[8:11], s40 offen lds
    buffer_load_dwordx4 v2, s[8:11], s40 offen offset:1024 lds
    buffer_load_dwordx4 v2, s[8:11], s40 offen offset:2048 lds
    buffer_load_dwordx4 v2, s[8:11], s40 offen offset:3072 lds
    s_waitcnt vmcnt(9) lgkmcnt(0)
    s_barrier
    s_mov_b32 m0, 34816
    s_add_u32 s40, s46, 792576
    buffer_load_dwordx4 v2, s[8:11], s40 offen lds
    buffer_load_dwordx4 v2, s[8:11], s40 offen offset:1024 lds
    buffer_load_dwordx4 v2, s[8:11], s40 offen offset:2048 lds
    buffer_load_dwordx4 v2, s[8:11], s40 offen offset:3072 lds
    s_waitcnt vmcnt(8) lgkmcnt(0)
    s_barrier
    s_mov_b32 m0, 52224
    s_add_u32 s40, s46, 924672
    buffer_load_dwordx4 v2, s[8:11], s40 offen lds
    buffer_load_dwordx4 v2, s[8:11], s40 offen offset:1024 lds
    buffer_load_dwordx4 v2, s[8:11], s40 offen offset:2048 lds
    buffer_load_dwordx4 v2, s[8:11], s40 offen offset:3072 lds
    s_waitcnt vmcnt(8) lgkmcnt(0)
    s_barrier
    s_mov_b32 m0, 0
    s_add_u32 s40, s46, 1056768
    buffer_load_dwordx4 v2, s[8:11], s40 offen lds
    buffer_load_dwordx4 v2, s[8:11], s40 offen offset:1024 lds
    buffer_load_dwordx4 v2, s[8:11], s40 offen offset:2048 lds
    buffer_load_dwordx4 v2, s[8:11], s40 offen offset:3072 lds
    s_mov_b32 m0, 4096
    s_add_u32 s40, s46, 1060864
    buffer_load_dwordx4 v2, s[8:11], s40 offen lds
    s_waitcnt vmcnt(9) lgkmcnt(0)
    s_barrier
    s_mov_b32 m0, 17408
    s_add_u32 s40, s46, 1188864
    buffer_load_dwordx4 v2, s[8:11], s40 offen lds
    buffer_load_dwordx4 v2, s[8:11], s40 offen offset:1024 lds
    buffer_load_dwordx4 v2, s[8:11], s40 offen offset:2048 lds
    buffer_load_dwordx4 v2, s[8:11], s40 offen offset:3072 lds
    s_waitcnt vmcnt(9) lgkmcnt(0)
    s_barrier
    s_mov_b32 m0, 34816
    s_add_u32 s40, s46, 1320960
    buffer_load_dwordx4 v2, s[8:11], s40 offen lds
    buffer_load_dwordx4 v2, s[8:11], s40 offen offset:1024 lds
    buffer_load_dwordx4 v2, s[8:11], s40 offen offset:2048 lds
    buffer_load_dwordx4 v2, s[8:11], s40 offen offset:3072 lds
    s_waitcnt vmcnt(8) lgkmcnt(0)
    s_barrier
    s_mov_b32 m0, 52224
    s_add_u32 s40, s46, 1453056
    buffer_load_dwordx4 v2, s[8:11], s40 offen lds
    buffer_load_dwordx4 v2, s[8:11], s40 offen offset:1024 lds
    buffer_load_dwordx4 v2, s[8:11], s40 offen offset:2048 lds
    buffer_load_dwordx4 v2, s[8:11], s40 offen offset:3072 lds
    s_waitcnt vmcnt(8) lgkmcnt(0)
    s_barrier
    s_mov_b32 m0, 0
    s_add_u32 s40, s46, 1585152
    buffer_load_dwordx4 v2, s[8:11], s40 offen lds
    buffer_load_dwordx4 v2, s[8:11], s40 offen offset:1024 lds
    buffer_load_dwordx4 v2, s[8:11], s40 offen offset:2048 lds
    buffer_load_dwordx4 v2, s[8:11], s40 offen offset:3072 lds
    s_mov_b32 m0, 4096
    s_add_u32 s40, s46, 1589248
    buffer_load_dwordx4 v2, s[8:11], s40 offen lds
    s_waitcnt vmcnt(9) lgkmcnt(0)
    s_barrier
    s_mov_b32 m0, 17408
    s_add_u32 s40, s46, 1717248
    buffer_load_dwordx4 v2, s[8:11], s40 offen lds
    buffer_load_dwordx4 v2, s[8:11], s40 offen offset:1024 lds
    buffer_load_dwordx4 v2, s[8:11], s40 offen offset:2048 lds
    buffer_load_dwordx4 v2, s[8:11], s40 offen offset:3072 lds
    s_waitcnt vmcnt(9) lgkmcnt(0)
    s_barrier
    s_mov_b32 m0, 34816
    s_add_u32 s40, s46, 1849344
    buffer_load_dwordx4 v2, s[8:11], s40 offen lds
    buffer_load_dwordx4 v2, s[8:11], s40 offen offset:1024 lds
    buffer_load_dwordx4 v2, s[8:11], s40 offen offset:2048 lds
    buffer_load_dwordx4 v2, s[8:11], s40 offen offset:3072 lds
    s_waitcnt vmcnt(8) lgkmcnt(0)
    s_barrier
    s_mov_b32 m0, 52224
    s_add_u32 s40, s46, 1981440
    buffer_load_dwordx4 v2, s[8:11], s40 offen lds
    buffer_load_dwordx4 v2, s[8:11], s40 offen offset:1024 lds
    buffer_load_dwordx4 v2, s[8:11], s40 offen offset:2048 lds
    buffer_load_dwordx4 v2, s[8:11], s40 offen offset:3072 lds
    s_waitcnt vmcnt(8) lgkmcnt(0)
    s_barrier
    s_mov_b32 m0, 0
    s_add_u32 s40, s46, 2113536
    buffer_load_dwordx4 v2, s[8:11], s40 offen lds
    buffer_load_dwordx4 v2, s[8:11], s40 offen offset:1024 lds
    buffer_load_dwordx4 v2, s[8:11], s40 offen offset:2048 lds
    buffer_load_dwordx4 v2, s[8:11], s40 offen offset:3072 lds
    s_mov_b32 m0, 4096
    s_add_u32 s40, s46, 2117632
    buffer_load_dwordx4 v2, s[8:11], s40 offen lds
    s_waitcnt vmcnt(9) lgkmcnt(0)
    s_barrier
    s_mov_b32 m0, 17408
    s_add_u32 s40, s46, 2245632
    buffer_load_dwordx4 v2, s[8:11], s40 offen lds
    buffer_load_dwordx4 v2, s[8:11], s40 offen offset:1024 lds
    buffer_load_dwordx4 v2, s[8:11], s40 offen offset:2048 lds
    buffer_load_dwordx4 v2, s[8:11], s40 offen offset:3072 lds
    s_waitcnt vmcnt(9) lgkmcnt(0)
    s_barrier
    s_mov_b32 m0, 34816
    s_add_u32 s40, s46, 2377728
    buffer_load_dwordx4 v2, s[8:11], s40 offen lds
    buffer_load_dwordx4 v2, s[8:11], s40 offen offset:1024 lds
    buffer_load_dwordx4 v2, s[8:11], s40 offen offset:2048 lds
    buffer_load_dwordx4 v2, s[8:11], s40 offen offset:3072 lds
    s_waitcnt vmcnt(8) lgkmcnt(0)
    s_barrier
    s_mov_b32 m0, 52224
    s_add_u32 s40, s46, 2509824
    buffer_load_dwordx4 v2, s[8:11], s40 offen lds
    buffer_load_dwordx4 v2, s[8:11], s40 offen offset:1024 lds
    buffer_load_dwordx4 v2, s[8:11], s40 offen offset:2048 lds
    buffer_load_dwordx4 v2, s[8:11], s40 offen offset:3072 lds
    s_waitcnt vmcnt(8) lgkmcnt(0)
    s_barrier
    s_waitcnt vmcnt(4) lgkmcnt(0)
    s_barrier
    s_waitcnt vmcnt(0) lgkmcnt(0)
    s_barrier
    s_barrier
    s_mul_i32 s45, s36, 102400
    s_add_u32 s45, s45, 5357568
    s_mul_i32 s46, s35, 81920
    s_add_u32 s46, s46, 12197888
    s_mov_b32 m0, 0
    s_nop 0
    buffer_load_dwordx4 v2, s[8:11], s45 offen sc1 lds
    buffer_load_dwordx4 v2, s[8:11], s45 offen offset:1024 sc1 lds
    buffer_load_dwordx4 v2, s[8:11], s45 offen offset:2048 sc1 lds
    s_mov_b32 m0, 10240
    s_add_u32 s40, s45, 10240
    buffer_load_dwordx4 v2, s[8:11], s40 offen sc1 lds
    buffer_load_dwordx4 v2, s[8:11], s40 offen offset:1024 sc1 lds
    s_mov_b32 m0, 20480
    s_add_u32 s40, s45, 20480
    buffer_load_dwordx4 v2, s[8:11], s40 offen sc1 lds
    buffer_load_dwordx4 v2, s[8:11], s40 offen offset:1024 sc1 lds
    s_mov_b32 m0, 30720
    s_add_u32 s40, s45, 30720
    buffer_load_dwordx4 v2, s[8:11], s40 offen sc1 lds
    buffer_load_dwordx4 v2, s[8:11], s40 offen offset:1024 sc1 lds
    buffer_load_dwordx4 v2, s[8:11], s40 offen offset:2048 sc1 lds
    s_mov_b32 m0, 40960
    s_add_u32 s40, s45, 40960
    buffer_load_dwordx4 v2, s[8:11], s40 offen sc1 lds
    buffer_load_dwordx4 v2, s[8:11], s40 offen offset:1024 sc1 lds
    buffer_load_dwordx4 v2, s[8:11], s40 offen offset:2048 sc1 lds
    s_mov_b32 m0, 51200
    s_add_u32 s40, s45, 51200
    buffer_load_dwordx4 v2, s[8:11], s40 offen sc1 lds
    buffer_load_dwordx4 v2, s[8:11], s40 offen offset:1024 sc1 lds
    s_mov_b32 s28, s22
    s_mov_b32 s29, s23
    s_mov_b32 s30, 2621440
    s_mov_b32 s31, 0x20000
    s_mul_i32 s41, s35, 81920
    s_mul_i32 s42, s36, 160
    s_add_u32 s41, s41, s42
    v_add_u32 v5, 0, v1
    v_mul_u32_u24 v6, 6554, v5
    v_lshrrev_b32 v6, 16, v6
    v_mul_u32_u24 v7, 10, v6
    v_sub_u32 v5, v5, v7
    v_lshlrev_b32 v5, 4, v5
    v_mul_u32_u24 v6, 1280, v6
    v_add_u32 v20, v5, v6
    s_mov_b32 m0, 131072
    s_nop 0
    buffer_load_dwordx4 v20, s[28:31], s41 offen lds
    v_add_u32 v5, 256, v1
    v_mul_u32_u24 v6, 6554, v5
    v_lshrrev_b32 v6, 16, v6
    v_mul_u32_u24 v7, 10, v6
    v_sub_u32 v5, v5, v7
    v_lshlrev_b32 v5, 4, v5
    v_mul_u32_u24 v6, 1280, v6
    v_add_u32 v24, v5, v6
    s_mov_b32 m0, 135168
    s_nop 0
    buffer_load_dwordx4 v24, s[28:31], s41 offen lds
    v_add_u32 v5, 512, v1
    v_mul_u32_u24 v6, 6554, v5
    v_lshrrev_b32 v6, 16, v6
    v_mul_u32_u24 v7, 10, v6
    v_sub_u32 v5, v5, v7
    v_lshlrev_b32 v5, 4, v5
    v_mul_u32_u24 v6, 1280, v6
    v_add_u32 v28, v5, v6
    s_mov_b32 m0, 139264
    s_nop 0
    buffer_load_dwordx4 v28, s[28:31], s41 offen lds
    s_lshl_b32 s47, s33, 8
    s_add_u32 s47, s47, 26484736
    s_mov_b32 s39, 32768
kp_p24:
    buffer_load_dword v16, v4, s[8:11], s47 offen sc1
    s_waitcnt vmcnt(0)
    v_cmp_eq_u32 vcc, s96, v16
    s_nop 3
    s_cmp_eq_u64 vcc, -1
    s_cbranch_scc1 kp_q25
    s_sub_u32 s39, s39, 1
    s_cmp_lg_u32 s39, 0
    s_cbranch_scc1 kp_p24
kp_q25:
    s_mov_b32 m0, 61440
    s_nop 0
    buffer_load_dwordx4 v2, s[8:11], s46 offen sc1 lds
    buffer_load_dwordx4 v2, s[8:11], s46 offen offset:1024 sc1 lds
    buffer_load_dwordx4 v2, s[8:11], s46 offen offset:2048 sc1 lds
    buffer_load_dwordx4 v2, s[8:11], s46 offen offset:3072 sc1 lds
    s_mov_b32 m0, 65536
    s_add_u32 s40, s46, 4096
    buffer_load_dwordx4 v2, s[8:11], s40 offen sc1 lds
    buffer_load_dwordx4 v2, s[8:11], s40 offen offset:1024 sc1 lds
    buffer_load_dwordx4 v2, s[8:11], s40 offen offset:2048 sc1 lds
    buffer_load_dwordx4 v2, s[8:11], s40 offen offset:3072 sc1 lds
    s_mov_b32 m0, 69632
    s_add_u32 s40, s46, 8192
    buffer_load_dwordx4 v2, s[8:11], s40 offen sc1 lds
    buffer_load_dwordx4 v2, s[8:11], s40 offen offset:1024 sc1 lds
    buffer_load_dwordx4 v2, s[8:11], s40 offen offset:2048 sc1 lds
    buffer_load_dwordx4 v2, s[8:11], s40 offen offset:3072 sc1 lds
    s_mov_b32 m0, 73728
    s_add_u32 s40, s46, 12288
    buffer_load_dwordx4 v2, s[8:11], s40 offen sc1 lds
    buffer_load_dwordx4 v2, s[8:11], s40 offen offset:1024 sc1 lds
    buffer_load_dwordx4 v2, s[8:11], s40 offen offset:2048 sc1 lds
    buffer_load_dwordx4 v2, s[8:11], s40 offen offset:3072 sc1 lds
    s_mov_b32 m0, 77824
    s_add_u32 s40, s46, 16384
    buffer_load_dwordx4 v2, s[8:11], s40 offen sc1 lds
    buffer_load_dwordx4 v2, s[8:11], s40 offen offset:1024 sc1 lds
    buffer_load_dwordx4 v2, s[8:11], s40 offen offset:2048 sc1 lds
    buffer_load_dwordx4 v2, s[8:11], s40 offen offset:3072 sc1 lds
    s_mov_b32 m0, 81920
    s_add_u32 s40, s46, 20480
    buffer_load_dwordx4 v2, s[8:11], s40 offen sc1 lds
    buffer_load_dwordx4 v2, s[8:11], s40 offen offset:1024 sc1 lds
    buffer_load_dwordx4 v2, s[8:11], s40 offen offset:2048 sc1 lds
    buffer_load_dwordx4 v2, s[8:11], s40 offen offset:3072 sc1 lds
    s_waitcnt vmcnt(16) lgkmcnt(0)
    s_barrier
    s_mov_b32 m0, 86016
    s_add_u32 s40, s46, 24576
    buffer_load_dwordx4 v2, s[8:11], s40 offen sc1 lds
    buffer_load_dwordx4 v2, s[8:11], s40 offen offset:1024 sc1 lds
    s_waitcnt vmcnt(10) lgkmcnt(0)
    s_barrier
    s_mov_b32 m0, 61440
    s_add_u32 s40, s46, 32768
    buffer_load_dwordx4 v2, s[8:11], s40 offen sc1 lds
    buffer_load_dwordx4 v2, s[8:11], s40 offen offset:1024 sc1 lds
    s_mov_b32 m0, 0
    s_add_u32 s40, s45, 61440
    buffer_load_dwordx4 v2, s[8:11], s40 offen sc1 lds
    buffer_load_dwordx4 v2, s[8:11], s40 offen offset:1024 sc1 lds
    s_waitcnt vmcnt(6) lgkmcnt(0)
    s_barrier
    s_mov_b32 m0, 69632
    s_add_u32 s40, s46, 40960
    buffer_load_dwordx4 v2, s[8:11], s40 offen sc1 lds
    buffer_load_dwordx4 v2, s[8:11], s40 offen offset:1024 sc1 lds
    s_mov_b32 m0, 10240
    s_add_u32 s40, s45, 71680
    buffer_load_dwordx4 v2, s[8:11], s40 offen sc1 lds
    buffer_load_dwordx4 v2, s[8:11], s40 offen offset:1024 sc1 lds
    buffer_load_dwordx4 v2, s[8:11], s40 offen offset:2048 sc1 lds
    s_waitcnt vmcnt(9) lgkmcnt(0)
    s_barrier
    s_mov_b32 m0, 77824
    s_add_u32 s40, s46, 49152
    buffer_load_dwordx4 v2, s[8:11], s40 offen sc1 lds
    buffer_load_dwordx4 v2, s[8:11], s40 offen offset:1024 sc1 lds
    s_mov_b32 m0, 20480
    s_add_u32 s40, s45, 81920
    buffer_load_dwordx4 v2, s[8:11], s40 offen sc1 lds
    buffer_load_dwordx4 v2, s[8:11], s40 offen offset:1024 sc1 lds
    buffer_load_dwordx4 v2, s[8:11], s40 offen offset:2048 sc1 lds
    s_waitcnt vmcnt(12) lgkmcnt(0)
    s_barrier
    s_mov_b32 m0, 86016
    s_add_u32 s40, s46, 57344
    buffer_load_dwordx4 v2, s[8:11], s40 offen sc1 lds
    buffer_load_dwordx4 v2, s[8:11], s40 offen offset:1024 sc1 lds
    s_mov_b32 m0, 30720
    s_add_u32 s40, s45, 92160
    buffer_load_dwordx4 v2, s[8:11], s40 offen sc1 lds
    buffer_load_dwordx4 v2, s[8:11], s40 offen offset:1024 sc1 lds
    v_min_u32 v58, 29, v1
    v_mul_u32_u24 v59, 35, v58
    v_lshrrev_b32 v59, 9, v59
    v_mul_u32_u24 v57, 120, v59
    v_mul_u32_u24 v59, 15, v59
    v_sub_u32 v58, v58, v59
    v_mul_u32_u24 v59, 86, v58
    v_lshrrev_b32 v59, 8, v59
    v_mad_u32_u24 v57, v59, 24, v57
    v_mul_u32_u24 v59, 3, v59
    v_sub_u32 v58, v58, v59
    s_mul_i32 s40, s34, 6
    s_add_u32 s41, s40, 5
    s_lshr_b32 s40, s40, 2
    s_lshr_b32 s41, s41, 2
    v_add_u32 v58, s40, v58
    v_min_u32 v58, s41, v58
    v_add_u32 v57, v57, v58
    v_lshlrev_b32 v57, 7, v57
    s_mov_b32 s47, 26501120
    buffer_load_dword v56, v57, s[8:11], s47 offen sc1
    s_waitcnt vmcnt(13) lgkmcnt(0)
    s_barrier
    s_mov_b32 m0, 61440
    s_add_u32 s40, s46, 65536
    buffer_load_dwordx4 v2, s[8:11], s40 offen sc1 lds
    buffer_load_dwordx4 v2, s[8:11], s40 offen offset:1024 sc1 lds
    s_waitcnt vmcnt(10) lgkmcnt(0)
    s_barrier
    s_mov_b32 m0, 69632
    s_add_u32 s40, s46, 73728
    buffer_load_dwordx4 v2, s[8:11], s40 offen sc1 lds
    buffer_load_dwordx4 v2, s[8:11], s40 offen offset:1024 sc1 lds
    s_waitcnt vmcnt(7) lgkmcnt(0)
    s_barrier
    s_waitcnt vmcnt(4)
    v_cmp_eq_u32 vcc, s96, v56
    s_nop 3
    s_cmp_eq_u64 vcc, -1
    s_cbranch_scc1 kp_sfok26
    s_mov_b32 s39, 32768
kp_p27:
    buffer_load_dword v56, v57, s[8:11], s47 offen sc1
    s_waitcnt vmcnt(0)
    v_cmp_eq_u32 vcc, s96, v56
    s_nop 3
    s_cmp_eq_u64 vcc, -1
    s_cbranch_scc1 kp_q28
    s_sub_u32 s39, s39, 1
    s_cmp_lg_u32 s39, 0
    s_cbranch_scc1 kp_p27
kp_q28:
kp_sfok26:
    s_mul_i32 s45, s34, 245760
    s_add_u32 s45, s45, 6176768
    s_mul_i32 s46, s33, 163840
    s_add_u32 s46, s46, 17440768
    s_mov_b32 m0, 94208
    s_nop 0
    buffer_load_dwordx4 v2, s[8:11], s45 offen sc1 lds
    buffer_load_dwordx4 v2, s[8:11], s45 offen offset:1024 sc1 lds
    buffer_load_dwordx4 v2, s[8:11], s45 offen offset:2048 sc1 lds
    s_waitcnt vmcnt(5) lgkmcnt(0)
    s_barrier
    s_mov_b32 m0, 106496
    s_add_u32 s40, s45, 12288
    buffer_load_dwordx4 v2, s[8:11], s40 offen sc1 lds
    buffer_load_dwordx4 v2, s[8:11], s40 offen offset:1024 sc1 lds
    buffer_load_dwordx4 v2, s[8:11], s40 offen offset:2048 sc1 lds
    s_waitcnt vmcnt(6) lgkmcnt(0)
    s_barrier
    s_mov_b32 m0, 118784
    s_add_u32 s40, s45, 24576
    buffer_load_dwordx4 v2, s[8:11], s40 offen sc1 lds
    buffer_load_dwordx4 v2, s[8:11], s40 offen offset:1024 sc1 lds
    buffer_load_dwordx4 v2, s[8:11], s40 offen offset:2048 sc1 lds
    s_lshl_b32 s47, s33, 8
    s_add_u32 s47, s47, 26488832
    s_mov_b32 s39, 32768
kp_p29:
    buffer_load_dword v16, v4, s[8:11], s47 offen sc1
    s_waitcnt vmcnt(0)
    v_cmp_eq_u32 vcc, s96, v16
    s_nop 3
    s_cmp_eq_u64 vcc, -1
    s_cbranch_scc1 kp_q30
    s_sub_u32 s39, s39, 1
    s_cmp_lg_u32 s39, 0
    s_cbranch_scc1 kp_p29
kp_q30:
    s_mov_b32 m0, 0
    s_nop 0
    buffer_load_dwordx4 v2, s[8:11], s46 offen sc1 lds
    buffer_load_dwordx4 v2, s[8:11], s46 offen offset:1024 sc1 lds
    buffer_load_dwordx4 v2, s[8:11], s46 offen offset:2048 sc1 lds
    buffer_load_dwordx4 v2, s[8:11], s46 offen offset:3072 sc1 lds
    s_mov_b32 m0, 4096
    s_add_u32 s40, s46, 4096
    buffer_load_dwordx4 v2, s[8:11], s40 offen sc1 lds
    buffer_load_dwordx4 v2, s[8:11], s40 offen offset:1024 sc1 lds
    buffer_load_dwordx4 v2, s[8:11], s40 offen offset:2048 sc1 lds
    buffer_load_dwordx4 v2, s[8:11], s40 offen offset:3072 sc1 lds
    s_mov_b32 m0, 8192
    s_add_u32 s40, s46, 8192
    buffer_load_dwordx4 v2, s[8:11], s40 offen sc1 lds
    buffer_load_dwordx4 v2, s[8:11], s40 offen offset:1024 sc1 lds
    buffer_load_dwordx4 v2, s[8:11], s40 offen offset:2048 sc1 lds
    buffer_load_dwordx4 v2, s[8:11], s40 offen offset:3072 sc1 lds
    s_mov_b32 m0, 12288
    s_add_u32 s40, s46, 12288
    buffer_load_dwordx4 v2, s[8:11], s40 offen sc1 lds
    buffer_load_dwordx4 v2, s[8:11], s40 offen offset:1024 sc1 lds
    buffer_load_dwordx4 v2, s[8:11], s40 offen offset:2048 sc1 lds
    buffer_load_dwordx4 v2, s[8:11], s40 offen offset:3072 sc1 lds
    s_mov_b32 m0, 16384
    s_add_u32 s40, s46, 16384
    buffer_load_dwordx4 v2, s[8:11], s40 offen sc1 lds
    buffer_load_dwordx4 v2, s[8:11], s40 offen offset:1024 sc1 lds
    buffer_load_dwordx4 v2, s[8:11], s40 offen offset:2048 sc1 lds
    buffer_load_dwordx4 v2, s[8:11], s40 offen offset:3072 sc1 lds
    s_mov_b32 m0, 20480
    s_add_u32 s40, s46, 20480
    buffer_load_dwordx4 v2, s[8:11], s40 offen sc1 lds
    buffer_load_dwordx4 v2, s[8:11], s40 offen offset:1024 sc1 lds
    buffer_load_dwordx4 v2, s[8:11], s40 offen offset:2048 sc1 lds
    buffer_load_dwordx4 v2, s[8:11], s40 offen offset:3072 sc1 lds
    s_waitcnt vmcnt(16) lgkmcnt(0)
    s_barrier
    s_mov_b32 m0, 131072
    s_add_u32 s40, s45, 36864
    buffer_load_dwordx4 v2, s[8:11], s40 offen sc1 lds
    buffer_load_dwordx4 v2, s[8:11], s40 offen offset:1024 sc1 lds
    buffer_load_dwordx4 v2, s[8:11], s40 offen offset:2048 sc1 lds
    buffer_load_dwordx4 v2, s[8:11], s40 offen offset:3072 sc1 lds
    s_mov_b32 m0, 135168
    s_add_u32 s40, s45, 40960
    buffer_load_dwordx4 v2, s[8:11], s40 offen sc1 lds
    s_waitcnt vmcnt(13) lgkmcnt(0)
    s_barrier
    s_mov_b32 m0, 94208
    s_add_u32 s40, s45, 49152
    buffer_load_dwordx4 v2, s[8:11], s40 offen sc1 lds
    buffer_load_dwordx4 v2, s[8:11], s40 offen offset:1024 sc1 lds
    buffer_load_dwordx4 v2, s[8:11], s40 offen offset:2048 sc1 lds
    buffer_load_dwordx4 v2, s[8:11], s40 offen offset:3072 sc1 lds
    s_mov_b32 m0, 98304
    s_add_u32 s40, s45, 53248
    buffer_load_dwordx4 v2, s[8:11], s40 offen sc1 lds
    s_waitcnt vmcnt(10) lgkmcnt(0)
    s_barrier
    s_mov_b32 m0, 106496
    s_add_u32 s40, s45, 61440
    buffer_load_dwordx4 v2, s[8:11], s40 offen sc1 lds
    buffer_load_dwordx4 v2, s[8:11], s40 offen offset:1024 sc1 lds
    buffer_load_dwordx4 v2, s[8:11], s40 offen offset:2048 sc1 lds
    buffer_load_dwordx4 v2, s[8:11], s40 offen offset:3072 sc1 lds
    s_mov_b32 m0, 110592
    s_add_u32 s40, s45, 65536
    buffer_load_dwordx4 v2, s[8:11], s40 offen sc1 lds
    s_lshl_b32 s42, s33, 3
    s_add_u32 s42, s42, 0
    s_lshl_b32 s42, s42, 10
    s_add_u32 s42, s42, 20062208
    v_and_b32 v5, 15, v1
    v_lshl_add_u32 v5, v5, 6, v3
    buffer_load_dwordx4 v[16:19], v5, s[8:11], s42 offen offset:0 sc1
    buffer_load_dwordx4 v[20:23], v5, s[8:11], s42 offen offset:1024 sc1
    v_add_u32 v44, 0, v1
    v_mul_u32_u24 v6, 43, v44
    v_lshrrev_b32 v6, 10, v6
    v_mul_u32_u24 v7, 24, v6
    v_sub_u32 v7, v44, v7
    v_mul_u32_u24 v6, 6144, v6
    v_lshl_add_u32 v6, v7, 4, v6
    v_mov_b32 v7, 0x40000000
    v_cmp_gt_u32 vcc, 96, v44
    s_nop 1
    v_cndmask_b32 v6, v7, v6, vcc
    s_mul_i32 s43, s34, 384
    s_add_u32 s43, s43, 12075008
    buffer_load_dwordx4 v[24:27], v6, s[8:11], s43 offen sc1
    s_add_u32 s43, s43, 24576
    buffer_load_dwordx4 v[28:31], v6, s[8:11], s43 offen sc1
    s_add_u32 s43, s43, 24576
    buffer_load_dwordx4 v[32:35], v6, s[8:11], s43 offen sc1
    s_add_u32 s43, s43, 24576
    buffer_load_dwordx4 v[36:39], v6, s[8:11], s43 offen sc1
    s_add_u32 s43, s43, 24576
    buffer_load_dwordx4 v[40:43], v6, s[8:11], s43 offen sc1
    s_waitcnt vmcnt(17) lgkmcnt(0)
    s_barrier
    s_mov_b32 m0, 118784
    s_add_u32 s40, s45, 73728
    buffer_load_dwordx4 v2, s[8:11], s40 offen sc1 lds
    buffer_load_dwordx4 v2, s[8:11], s40 offen offset:1024 sc1 lds
    buffer_load_dwordx4 v2, s[8:11], s40 offen offset:2048 sc1 lds
    buffer_load_dwordx4 v2, s[8:11], s40 offen offset:3072 sc1 lds
    s_mov_b32 m0, 122880
    s_add_u32 s40, s45, 77824
    buffer_load_dwordx4 v2, s[8:11], s40 offen sc1 lds
    s_waitcnt vmcnt(17) lgkmcnt(0)
    s_barrier
    s_mov_b32 m0, 131072
    s_add_u32 s40, s45, 86016
    buffer_load_dwordx4 v2, s[8:11], s40 offen sc1 lds
    buffer_load_dwordx4 v2, s[8:11], s40 offen offset:1024 sc1 lds
    buffer_load_dwordx4 v2, s[8:11], s40 offen offset:2048 sc1 lds
    buffer_load_dwordx4 v2, s[8:11], s40 offen offset:3072 sc1 lds
    s_mov_b32 m0, 135168
    s_add_u32 s40, s45, 90112
    buffer_load_dwordx4 v2, s[8:11], s40 offen sc1 lds
    s_waitcnt vmcnt(17) lgkmcnt(0)
    s_barrier
    s_mov_b32 m0, 94208
    s_add_u32 s40, s45, 98304
    buffer_load_dwordx4 v2, s[8:11], s40 offen sc1 lds
    buffer_load_dwordx4 v2, s[8:11], s40 offen offset:1024 sc1 lds
    buffer_load_dwordx4 v2, s[8:11], s40 offen offset:2048 sc1 lds
    buffer_load_dwordx4 v2, s[8:11], s40 offen offset:3072 sc1 lds
    s_mov_b32 m0, 98304
    s_add_u32 s40, s45, 102400
    buffer_load_dwordx4 v2, s[8:11], s40 offen sc1 lds
    s_waitcnt vmcnt(10) lgkmcnt(0)
    s_barrier
    s_mov_b32 m0, 106496
    s_add_u32 s40, s45, 110592
    buffer_load_dwordx4 v2, s[8:11], s40 offen sc1 lds
    buffer_load_dwordx4 v2, s[8:11], s40 offen offset:1024 sc1 lds
    buffer_load_dwordx4 v2, s[8:11], s40 offen offset:2048 sc1 lds
    buffer_load_dwordx4 v2, s[8:11], s40 offen offset:3072 sc1 lds
    s_mov_b32 m0, 110592
    s_add_u32 s40, s45, 114688
    buffer_load_dwordx4 v2, s[8:11], s40 offen sc1 lds
    s_waitcnt vmcnt(10) lgkmcnt(0)
    s_barrier
    s_mov_b32 m0, 118784
    s_add_u32 s40, s45, 122880
    buffer_load_dwordx4 v2, s[8:11], s40 offen sc1 lds
    buffer_load_dwordx4 v2, s[8:11], s40 offen offset:1024 sc1 lds
    buffer_load_dwordx4 v2, s[8:11], s40 offen offset:2048 sc1 lds
    buffer_load_dwordx4 v2, s[8:11], s40 offen offset:3072 sc1 lds
    s_mov_b32 m0, 122880
    s_add_u32 s40, s45, 126976
    buffer_load_dwordx4 v2, s[8:11], s40 offen sc1 lds
    s_waitcnt vmcnt(10) lgkmcnt(0)
    s_barrier
    s_mov_b32 m0, 131072
    s_add_u32 s40, s45, 135168
    buffer_load_dwordx4 v2, s[8:11], s40 offen sc1 lds
    buffer_load_dwordx4 v2, s[8:11], s40 offen offset:1024 sc1 lds
    buffer_load_dwordx4 v2, s[8:11], s40 offen offset:2048 sc1 lds
    buffer_load_dwordx4 v2, s[8:11], s40 offen offset:3072 sc1 lds
    s_mov_b32 m0, 135168
    s_add_u32 s40, s45, 139264
    buffer_load_dwordx4 v2, s[8:11], s40 offen sc1 lds
    s_waitcnt vmcnt(10) lgkmcnt(0)
    s_barrier
    s_mov_b32 m0, 94208
    s_add_u32 s40, s45, 147456
    buffer_load_dwordx4 v2, s[8:11], s40 offen sc1 lds
    buffer_load_dwordx4 v2, s[8:11], s40 offen offset:1024 sc1 lds
    buffer_load_dwordx4 v2, s[8:11], s40 offen offset:2048 sc1 lds
    buffer_load_dwordx4 v2, s[8:11], s40 offen offset:3072 sc1 lds
    s_mov_b32 m0, 98304
    s_add_u32 s40, s45, 151552
    buffer_load_dwordx4 v2, s[8:11], s40 offen sc1 lds
    s_waitcnt vmcnt(10) lgkmcnt(0)
    s_barrier
    s_mov_b32 m0, 106496
    s_add_u32 s40, s45, 159744
    buffer_load_dwordx4 v2, s[8:11], s40 offen sc1 lds
    buffer_load_dwordx4 v2, s[8:11], s40 offen offset:1024 sc1 lds
    buffer_load_dwordx4 v2, s[8:11], s40 offen offset:2048 sc1 lds
    buffer_load_dwordx4 v2, s[8:11], s40 offen offset:3072 sc1 lds
    s_mov_b32 m0, 110592
    s_add_u32 s40, s45, 163840
    buffer_load_dwordx4 v2, s[8:11], s40 offen sc1 lds
    v_min_u32 v58, 23, v1
    v_lshrrev_b32 v59, 1, v58
    v_mul_u32_u24 v57, 10, v59
    v_and_b32 v58, 1, v58
    s_mul_i32 s40, s36, 5
    s_add_u32 s41, s40, 4
    s_lshr_b32 s40, s40, 2
    s_lshr_b32 s41, s41, 2
    v_add_u32 v58, s40, v58
    v_min_u32 v58, s41, v58
    v_add_u32 v57, v57, v58
    v_lshlrev_b32 v57, 7, v57
    s_mov_b32 s47, 26533888
    buffer_load_dword v56, v57, s[8:11], s47 offen sc1
    s_waitcnt vmcnt(11) lgkmcnt(0)
    s_barrier
    s_mov_b32 m0, 118784
    s_add_u32 s40, s45, 172032
    buffer_load_dwordx4 v2, s[8:11], s40 offen sc1 lds
    buffer_load_dwordx4 v2, s[8:11], s40 offen offset:1024 sc1 lds
    buffer_load_dwordx4 v2, s[8:11], s40 offen offset:2048 sc1 lds
    buffer_load_dwordx4 v2, s[8:11], s40 offen offset:3072 sc1 lds
    s_mov_b32 m0, 122880
    s_add_u32 s40, s45, 176128
    buffer_load_dwordx4 v2, s[8:11], s40 offen sc1 lds
    s_waitcnt vmcnt(11) lgkmcnt(0)
    s_barrier
    s_mov_b32 m0, 131072
    s_add_u32 s40, s45, 184320
    buffer_load_dwordx4 v2, s[8:11], s40 offen sc1 lds
    buffer_load_dwordx4 v2, s[8:11], s40 offen offset:1024 sc1 lds
    buffer_load_dwordx4 v2, s[8:11], s40 offen offset:2048 sc1 lds
    buffer_load_dwordx4 v2, s[8:11], s40 offen offset:3072 sc1 lds
    s_mov_b32 m0, 135168
    s_add_u32 s40, s45, 188416
    buffer_load_dwordx4 v2, s[8:11], s40 offen sc1 lds
    s_waitcnt vmcnt(11) lgkmcnt(0)
    s_barrier
    s_mov_b32 m0, 94208
    s_add_u32 s40, s45, 196608
    buffer_load_dwordx4 v2, s[8:11], s40 offen sc1 lds
    buffer_load_dwordx4 v2, s[8:11], s40 offen offset:1024 sc1 lds
    buffer_load_dwordx4 v2, s[8:11], s40 offen offset:2048 sc1 lds
    buffer_load_dwordx4 v2, s[8:11], s40 offen offset:3072 sc1 lds
    s_mov_b32 m0, 98304
    s_add_u32 s40, s45, 200704
    buffer_load_dwordx4 v2, s[8:11], s40 offen sc1 lds
    s_waitcnt vmcnt(10) lgkmcnt(0)
    s_barrier
    s_mov_b32 m0, 106496
    s_add_u32 s40, s45, 208896
    buffer_load_dwordx4 v2, s[8:11], s40 offen sc1 lds
    buffer_load_dwordx4 v2, s[8:11], s40 offen offset:1024 sc1 lds
    buffer_load_dwordx4 v2, s[8:11], s40 offen offset:2048 sc1 lds
    buffer_load_dwordx4 v2, s[8:11], s40 offen offset:3072 sc1 lds
    s_mov_b32 m0, 110592
    s_add_u32 s40, s45, 212992
    buffer_load_dwordx4 v2, s[8:11], s40 offen sc1 lds
    s_waitcnt vmcnt(10) lgkmcnt(0)
    s_barrier
    s_mov_b32 m0, 118784
    s_add_u32 s40, s45, 221184
    buffer_load_dwordx4 v2, s[8:11], s40 offen sc1 lds
    buffer_load_dwordx4 v2, s[8:11], s40 offen offset:1024 sc1 lds
    buffer_load_dwordx4 v2, s[8:11], s40 offen offset:2048 sc1 lds
    buffer_load_dwordx4 v2, s[8:11], s40 offen offset:3072 sc1 lds
    s_mov_b32 m0, 122880
    s_add_u32 s40, s45, 225280
    buffer_load_dwordx4 v2, s[8:11], s40 offen sc1 lds
    s_waitcnt vmcnt(10) lgkmcnt(0)
    s_barrier
    s_mov_b32 m0, 131072
    s_add_u32 s40, s45, 233472
    buffer_load_dwordx4 v2, s[8:11], s40 offen sc1 lds
    buffer_load_dwordx4 v2, s[8:11], s40 offen offset:1024 sc1 lds
    buffer_load_dwordx4 v2, s[8:11], s40 offen offset:2048 sc1 lds
    buffer_load_dwordx4 v2, s[8:11], s40 offen offset:3072 sc1 lds
    s_mov_b32 m0, 135168
    s_add_u32 s40, s45, 237568
    buffer_load_dwordx4 v2, s[8:11], s40 offen sc1 lds
    s_waitcnt vmcnt(10) lgkmcnt(0)
    s_barrier
    v_add_f32 v46, v16, v18
    v_mov_b32 v47, v46
    s_nop 1
    v_permlane32_swap_b32 v46, v47
    v_add_f32 v46, v46, v47
    v_mov_b32 v47, v46
    s_nop 1
    v_permlane16_swap_b32 v46, v47
    v_add_f32 v46, v46, v47
    v_mul_f32 v46, 0x3e000000, v46
    v_sub_f32 v47, v16, v46
    v_sub_f32 v48, v18, v46
    v_mul_f32 v47, v47, v47
    v_fmac_f32 v47, v48, v48
    v_add_f32 v48, v17, v19
    v_fmac_f32 v48, 0x42a00000, v47
    v_mov_b32 v47, v48
    s_nop 1
    v_permlane32_swap_b32 v48, v47
    v_add_f32 v48, v48, v47
    v_mov_b32 v47, v48
    s_nop 1
    v_permlane16_swap_b32 v48, v47
    v_add_f32 v48, v48, v47
    v_mov_b32 v47, 0x3727c5ac
    v_fmac_f32 v47, 0x3acccccd, v48
    v_rsq_f32 v50, v47
    s_nop 0
    v_mul_f32 v51, v46, v50
    v_sub_f32 v51, 0, v51
    v_and_b32 v47, 15, v1
    v_lshlrev_b32 v47, 3, v47
    v_add_u32 v47, 144896, v47
    s_mov_b64 exec, 0xffff
    ds_write_b64 v47, v[50:51]
    s_mov_b64 exec, -1
    v_cmp_eq_u32 vcc, s96, v56
    s_nop 3
    s_cmp_eq_u64 vcc, -1
    s_cbranch_scc1 kp_sfok31
    s_mov_b32 s39, 32768
kp_p32:
    buffer_load_dword v56, v57, s[8:11], s47 offen sc1
    s_waitcnt vmcnt(0)
    v_cmp_eq_u32 vcc, s96, v56
    s_nop 3
    s_cmp_eq_u64 vcc, -1
    s_cbranch_scc1 kp_q33
    s_sub_u32 s39, s39, 1
    s_cmp_lg_u32 s39, 0
    s_cbranch_scc1 kp_p32
kp_q33:
kp_sfok31:
    s_mul_i32 s45, s36, 245760
    s_add_u32 s45, s45, 10108928
    s_mul_i32 s46, s35, 196608
    s_add_u32 s46, s46, 20193280
    s_mov_b32 m0, 32768
    s_nop 0
    buffer_load_dwordx4 v2, s[8:11], s45 offen sc1 lds
    buffer_load_dwordx4 v2, s[8:11], s45 offen offset:1024 sc1 lds
    buffer_load_dwordx4 v2, s[8:11], s45 offen offset:2048 sc1 lds
    s_waitcnt vmcnt(8) lgkmcnt(0)
    s_barrier
    v_add_f32 v46, v20, v22
    v_mov_b32 v47, v46
    s_nop 1
    v_permlane32_swap_b32 v46, v47
    v_add_f32 v46, v46, v47
    v_mov_b32 v47, v46
    s_nop 1
    v_permlane16_swap_b32 v46, v47
    v_add_f32 v46, v46, v47
    v_mul_f32 v46, 0x3e000000, v46
    v_sub_f32 v47, v20, v46
    v_sub_f32 v48, v22, v46
    v_mul_f32 v47, v47, v47
    v_fmac_f32 v47, v48, v48
    v_add_f32 v48, v21, v23
    v_fmac_f32 v48, 0x42a00000, v47
    v_mov_b32 v47, v48
    s_nop 1
    v_permlane32_swap_b32 v48, v47
    v_add_f32 v48, v48, v47
    v_mov_b32 v47, v48
    s_nop 1
    v_permlane16_swap_b32 v48, v47
    v_add_f32 v48, v48, v47
    v_mov_b32 v47, 0x3727c5ac
    v_fmac_f32 v47, 0x3acccccd, v48
    v_rsq_f32 v50, v47
    s_nop 0
    v_mul_f32 v51, v46, v50
    v_sub_f32 v51, 0, v51
    v_and_b32 v47, 15, v1
    v_lshlrev_b32 v47, 3, v47
    v_add_u32 v47, 145024, v47
    s_mov_b64 exec, 0xffff
    ds_write_b64 v47, v[50:51]
    s_mov_b64 exec, -1
    v_pk_add_f32 v[24:25], v[24:25], v[28:29]
    v_pk_add_f32 v[26:27], v[26:27], v[30:31]
    v_pk_add_f32 v[24:25], v[24:25], v[32:33]
    v_pk_add_f32 v[26:27], v[26:27], v[34:35]
    v_pk_add_f32 v[24:25], v[24:25], v[36:37]
    v_pk_add_f32 v[26:27], v[26:27], v[38:39]
    v_pk_add_f32 v[24:25], v[24:25], v[40:41]
    v_pk_add_f32 v[26:27], v[26:27], v[42:43]
    v_lshlrev_b32 v7, 4, v44
    v_add_u32 v7, 143360, v7
    ds_write_b128 v7, v[24:27]
    s_mov_b32 m0, 43008
    s_add_u32 s40, s45, 10240
    buffer_load_dwordx4 v2, s[8:11], s40 offen sc1 lds
    buffer_load_dwordx4 v2, s[8:11], s40 offen offset:1024 sc1 lds
    s_waitcnt vmcnt(5) lgkmcnt(0)
    s_barrier
    s_mov_b32 m0, 53248
    s_add_u32 s40, s45, 20480
    buffer_load_dwordx4 v2, s[8:11], s40 offen sc1 lds
    buffer_load_dwordx4 v2, s[8:11], s40 offen offset:1024 sc1 lds
    s_mov_b32 m0, 63488
    s_add_u32 s40, s45, 30720
    buffer_load_dwordx4 v2, s[8:11], s40 offen sc1 lds
    buffer_load_dwordx4 v2, s[8:11], s40 offen offset:1024 sc1 lds
    buffer_load_dwordx4 v2, s[8:11], s40 offen offset:2048 sc1 lds
    s_mov_b32 m0, 73728
    s_add_u32 s40, s45, 40960
    buffer_load_dwordx4 v2, s[8:11], s40 offen sc1 lds
    buffer_load_dwordx4 v2, s[8:11], s40 offen offset:1024 sc1 lds
    buffer_load_dwordx4 v2, s[8:11], s40 offen offset:2048 sc1 lds
    s_mov_b32 m0, 83968
    s_add_u32 s40, s45, 51200
    buffer_load_dwordx4 v2, s[8:11], s40 offen sc1 lds
    buffer_load_dwordx4 v2, s[8:11], s40 offen offset:1024 sc1 lds
    s_lshl_b32 s47, s33, 8
    s_add_u32 s47, s47, 26492928
    s_mov_b32 s39, 32768
kp_p34:
    buffer_load_dword v16, v4, s[8:11], s47 offen sc1
    s_waitcnt vmcnt(0)
    v_cmp_eq_u32 vcc, s96, v16
    s_nop 3
    s_cmp_eq_u64 vcc, -1
    s_cbranch_scc1 kp_q35
    s_sub_u32 s39, s39, 1
    s_cmp_lg_u32 s39, 0
    s_cbranch_scc1 kp_p34
kp_q35:
    s_mov_b32 m0, 0
    s_nop 0
    buffer_load_dwordx4 v2, s[8:11], s46 offen sc1 lds
    buffer_load_dwordx4 v2, s[8:11], s46 offen offset:1024 sc1 lds
    buffer_load_dwordx4 v2, s[8:11], s46 offen offset:2048 sc1 lds
    buffer_load_dwordx4 v2, s[8:11], s46 offen offset:3072 sc1 lds
    s_mov_b32 m0, 4096
    s_add_u32 s40, s46, 4096
    buffer_load_dwordx4 v2, s[8:11], s40 offen sc1 lds
    buffer_load_dwordx4 v2, s[8:11], s40 offen offset:1024 sc1 lds
    buffer_load_dwordx4 v2, s[8:11], s40 offen offset:2048 sc1 lds
    buffer_load_dwordx4 v2, s[8:11], s40 offen offset:3072 sc1 lds
    s_mov_b32 m0, 8192
    s_add_u32 s40, s46, 8192
    buffer_load_dwordx4 v2, s[8:11], s40 offen sc1 lds
    buffer_load_dwordx4 v2, s[8:11], s40 offen offset:1024 sc1 lds
    buffer_load_dwordx4 v2, s[8:11], s40 offen offset:2048 sc1 lds
    buffer_load_dwordx4 v2, s[8:11], s40 offen offset:3072 sc1 lds
    s_mov_b32 m0, 12288
    s_add_u32 s40, s46, 12288
    buffer_load_dwordx4 v2, s[8:11], s40 offen sc1 lds
    buffer_load_dwordx4 v2, s[8:11], s40 offen offset:1024 sc1 lds
    buffer_load_dwordx4 v2, s[8:11], s40 offen offset:2048 sc1 lds
    buffer_load_dwordx4 v2, s[8:11], s40 offen offset:3072 sc1 lds
    s_mov_b32 m0, 16384
    s_add_u32 s40, s46, 16384
    buffer_load_dwordx4 v2, s[8:11], s40 offen sc1 lds
    buffer_load_dwordx4 v2, s[8:11], s40 offen offset:1024 sc1 lds
    buffer_load_dwordx4 v2, s[8:11], s40 offen offset:2048 sc1 lds
    buffer_load_dwordx4 v2, s[8:11], s40 offen offset:3072 sc1 lds
    s_mov_b32 m0, 20480
    s_add_u32 s40, s46, 20480
    buffer_load_dwordx4 v2, s[8:11], s40 offen sc1 lds
    buffer_load_dwordx4 v2, s[8:11], s40 offen offset:1024 sc1 lds
    buffer_load_dwordx4 v2, s[8:11], s40 offen offset:2048 sc1 lds
    buffer_load_dwordx4 v2, s[8:11], s40 offen offset:3072 sc1 lds
    s_waitcnt vmcnt(16) lgkmcnt(0)
    s_barrier
    s_mov_b32 m0, 24576
    s_add_u32 s40, s46, 24576
    buffer_load_dwordx4 v2, s[8:11], s40 offen sc1 lds
    buffer_load_dwordx4 v2, s[8:11], s40 offen offset:1024 sc1 lds
    s_waitcnt vmcnt(10) lgkmcnt(0)
    s_barrier
    s_mov_b32 m0, 0
    s_add_u32 s40, s46, 32768
    buffer_load_dwordx4 v2, s[8:11], s40 offen sc1 lds
    buffer_load_dwordx4 v2, s[8:11], s40 offen offset:1024 sc1 lds
    s_mov_b32 m0, 32768
    s_add_u32 s40, s45, 61440
    buffer_load_dwordx4 v2, s[8:11], s40 offen sc1 lds
    buffer_load_dwordx4 v2, s[8:11], s40 offen offset:1024 sc1 lds
    s_waitcnt vmcnt(6) lgkmcnt(0)
    s_barrier
    s_mov_b32 m0, 8192
    s_add_u32 s40, s46, 40960
    buffer_load_dwordx4 v2, s[8:11], s40 offen sc1 lds
    buffer_load_dwordx4 v2, s[8:11], s40 offen offset:1024 sc1 lds
    s_mov_b32 m0, 43008
    s_add_u32 s40, s45, 71680
    buffer_load_dwordx4 v2, s[8:11], s40 offen sc1 lds
    buffer_load_dwordx4 v2, s[8:11], s40 offen offset:1024 sc1 lds
    buffer_load_dwordx4 v2, s[8:11], s40 offen offset:2048 sc1 lds
    s_waitcnt vmcnt(9) lgkmcnt(0)
    s_barrier
    s_mov_b32 m0, 16384
    s_add_u32 s40, s46, 49152
    buffer_load_dwordx4 v2, s[8:11], s40 offen sc1 lds
    buffer_load_dwordx4 v2, s[8:11], s40 offen offset:1024 sc1 lds
    s_mov_b32 m0, 53248
    s_add_u32 s40, s45, 81920
    buffer_load_dwordx4 v2, s[8:11], s40 offen sc1 lds
    buffer_load_dwordx4 v2, s[8:11], s40 offen offset:1024 sc1 lds
    buffer_load_dwordx4 v2, s[8:11], s40 offen offset:2048 sc1 lds
    s_waitcnt vmcnt(12) lgkmcnt(0)
    s_barrier
    s_mov_b32 m0, 24576
    s_add_u32 s40, s46, 57344
    buffer_load_dwordx4 v2, s[8:11], s40 offen sc1 lds
    buffer_load_dwordx4 v2, s[8:11], s40 offen offset:1024 sc1 lds
    s_mov_b32 m0, 63488
    s_add_u32 s40, s45, 92160
    buffer_load_dwordx4 v2, s[8:11], s40 offen sc1 lds
    buffer_load_dwordx4 v2, s[8:11], s40 offen offset:1024 sc1 lds
    s_waitcnt vmcnt(12) lgkmcnt(0)
    s_barrier
    s_mov_b32 m0, 0
    s_add_u32 s40, s46, 65536
    buffer_load_dwordx4 v2, s[8:11], s40 offen sc1 lds
    buffer_load_dwordx4 v2, s[8:11], s40 offen offset:1024 sc1 lds
    s_mov_b32 m0, 73728
    s_add_u32 s40, s45, 102400
    buffer_load_dwordx4 v2, s[8:11], s40 offen sc1 lds
    buffer_load_dwordx4 v2, s[8:11], s40 offen offset:1024 sc1 lds
    s_waitcnt vmcnt(11) lgkmcnt(0)
    s_barrier
    s_mov_b32 m0, 8192
    s_add_u32 s40, s46, 73728
    buffer_load_dwordx4 v2, s[8:11], s40 offen sc1 lds
    buffer_load_dwordx4 v2, s[8:11], s40 offen offset:1024 sc1 lds
    s_mov_b32 m0, 83968
    s_add_u32 s40, s45, 112640
    buffer_load_dwordx4 v2, s[8:11], s40 offen sc1 lds
    buffer_load_dwordx4 v2, s[8:11], s40 offen offset:1024 sc1 lds
    buffer_load_dwordx4 v2, s[8:11], s40 offen offset:2048 sc1 lds
    s_waitcnt vmcnt(11) lgkmcnt(0)
    s_barrier
    s_mov_b32 m0, 16384
    s_add_u32 s40, s46, 81920
    buffer_load_dwordx4 v2, s[8:11], s40 offen sc1 lds
    buffer_load_dwordx4 v2, s[8:11], s40 offen offset:1024 sc1 lds
    s_mov_b32 m0, 32768
    s_add_u32 s40, s45, 122880
    buffer_load_dwordx4 v2, s[8:11], s40 offen sc1 lds
    buffer_load_dwordx4 v2, s[8:11], s40 offen offset:1024 sc1 lds
    buffer_load_dwordx4 v2, s[8:11], s40 offen offset:2048 sc1 lds
    s_waitcnt vmcnt(12) lgkmcnt(0)
    s_barrier
    s_mov_b32 m0, 24576
    s_add_u32 s40, s46, 90112
    buffer_load_dwordx4 v2, s[8:11], s40 offen sc1 lds
    buffer_load_dwordx4 v2, s[8:11], s40 offen offset:1024 sc1 lds
    s_mov_b32 m0, 43008
    s_add_u32 s40, s45, 133120
    buffer_load_dwordx4 v2, s[8:11], s40 offen sc1 lds
    buffer_load_dwordx4 v2, s[8:11], s40 offen offset:1024 sc1 lds
    s_waitcnt vmcnt(12) lgkmcnt(0)
    s_barrier
    s_mov_b32 m0, 0
    s_add_u32 s40, s46, 98304
    buffer_load_dwordx4 v2, s[8:11], s40 offen sc1 lds
    buffer_load_dwordx4 v2, s[8:11], s40 offen offset:1024 sc1 lds
    s_mov_b32 m0, 53248
    s_add_u32 s40, s45, 143360
    buffer_load_dwordx4 v2, s[8:11], s40 offen sc1 lds
    buffer_load_dwordx4 v2, s[8:11], s40 offen offset:1024 sc1 lds
    s_waitcnt vmcnt(11) lgkmcnt(0)
    s_barrier
    s_mov_b32 m0, 8192
    s_add_u32 s40, s46, 106496
    buffer_load_dwordx4 v2, s[8:11], s40 offen sc1 lds
    buffer_load_dwordx4 v2, s[8:11], s40 offen offset:1024 sc1 lds
    s_mov_b32 m0, 63488
    s_add_u32 s40, s45, 153600
    buffer_load_dwordx4 v2, s[8:11], s40 offen sc1 lds
    buffer_load_dwordx4 v2, s[8:11], s40 offen offset:1024 sc1 lds
    buffer_load_dwordx4 v2, s[8:11], s40 offen offset:2048 sc1 lds
    s_waitcnt vmcnt(11) lgkmcnt(0)
    s_barrier
    s_mov_b32 m0, 16384
    s_add_u32 s40, s46, 114688
    buffer_load_dwordx4 v2, s[8:11], s40 offen sc1 lds
    buffer_load_dwordx4 v2, s[8:11], s40 offen offset:1024 sc1 lds
    s_mov_b32 m0, 73728
    s_add_u32 s40, s45, 163840
    buffer_load_dwordx4 v2, s[8:11], s40 offen sc1 lds
    buffer_load_dwordx4 v2, s[8:11], s40 offen offset:1024 sc1 lds
    buffer_load_dwordx4 v2, s[8:11], s40 offen offset:2048 sc1 lds
    s_waitcnt vmcnt(12) lgkmcnt(0)
    s_barrier
    s_mov_b32 m0, 24576
    s_add_u32 s40, s46, 122880
    buffer_load_dwordx4 v2, s[8:11], s40 offen sc1 lds
    buffer_load_dwordx4 v2, s[8:11], s40 offen offset:1024 sc1 lds
    s_mov_b32 m0, 83968
    s_add_u32 s40, s45, 174080
    buffer_load_dwordx4 v2, s[8:11], s40 offen sc1 lds
    buffer_load_dwordx4 v2, s[8:11], s40 offen offset:1024 sc1 lds
    s_waitcnt vmcnt(12) lgkmcnt(0)
    s_barrier
    s_mov_b32 m0, 0
    s_add_u32 s40, s46, 131072
    buffer_load_dwordx4 v2, s[8:11], s40 offen sc1 lds
    buffer_load_dwordx4 v2, s[8:11], s40 offen offset:1024 sc1 lds
    s_mov_b32 m0, 32768
    s_add_u32 s40, s45, 184320
    buffer_load_dwordx4 v2, s[8:11], s40 offen sc1 lds
    buffer_load_dwordx4 v2, s[8:11], s40 offen offset:1024 sc1 lds
    s_waitcnt vmcnt(11) lgkmcnt(0)
    s_barrier
    s_mov_b32 m0, 8192
    s_add_u32 s40, s46, 139264
    buffer_load_dwordx4 v2, s[8:11], s40 offen sc1 lds
    buffer_load_dwordx4 v2, s[8:11], s40 offen offset:1024 sc1 lds
    s_mov_b32 m0, 43008
    s_add_u32 s40, s45, 194560
    buffer_load_dwordx4 v2, s[8:11], s40 offen sc1 lds
    buffer_load_dwordx4 v2, s[8:11], s40 offen offset:1024 sc1 lds
    buffer_load_dwordx4 v2, s[8:11], s40 offen offset:2048 sc1 lds
    s_waitcnt vmcnt(11) lgkmcnt(0)
    s_barrier
    s_mov_b32 m0, 16384
    s_add_u32 s40, s46, 147456
    buffer_load_dwordx4 v2, s[8:11], s40 offen sc1 lds
    buffer_load_dwordx4 v2, s[8:11], s40 offen offset:1024 sc1 lds
    s_mov_b32 m0, 53248
    s_add_u32 s40, s45, 204800
    buffer_load_dwordx4 v2, s[8:11], s40 offen sc1 lds
    buffer_load_dwordx4 v2, s[8:11], s40 offen offset:1024 sc1 lds
    buffer_load_dwordx4 v2, s[8:11], s40 offen offset:2048 sc1 lds
    s_waitcnt vmcnt(12) lgkmcnt(0)
    s_barrier
    s_mov_b32 m0, 24576
    s_add_u32 s40, s46, 155648
    buffer_load_dwordx4 v2, s[8:11], s40 offen sc1 lds
    buffer_load_dwordx4 v2, s[8:11], s40 offen offset:1024 sc1 lds
    s_mov_b32 m0, 63488
    s_add_u32 s40, s45, 215040
    buffer_load_dwordx4 v2, s[8:11], s40 offen sc1 lds
    buffer_load_dwordx4 v2, s[8:11], s40 offen offset:1024 sc1 lds
    s_waitcnt vmcnt(12) lgkmcnt(0)
    s_barrier
    s_mov_b32 m0, 0
    s_add_u32 s40, s46, 163840
    buffer_load_dwordx4 v2, s[8:11], s40 offen sc1 lds
    buffer_load_dwordx4 v2, s[8:11], s40 offen offset:1024 sc1 lds
    s_mov_b32 m0, 73728
    s_add_u32 s40, s45, 225280
    buffer_load_dwordx4 v2, s[8:11], s40 offen sc1 lds
    buffer_load_dwordx4 v2, s[8:11], s40 offen offset:1024 sc1 lds
    s_waitcnt vmcnt(11) lgkmcnt(0)
    s_barrier
    s_mov_b32 m0, 8192
    s_add_u32 s40, s46, 172032
    buffer_load_dwordx4 v2, s[8:11], s40 offen sc1 lds
    buffer_load_dwordx4 v2, s[8:11], s40 offen offset:1024 sc1 lds
    s_mov_b32 m0, 83968
    s_add_u32 s40, s45, 235520
    buffer_load_dwordx4 v2, s[8:11], s40 offen sc1 lds
    buffer_load_dwordx4 v2, s[8:11], s40 offen offset:1024 sc1 lds
    buffer_load_dwordx4 v2, s[8:11], s40 offen offset:2048 sc1 lds
    s_waitcnt vmcnt(11) lgkmcnt(0)
    s_barrier
    s_mov_b32 m0, 16384
    s_add_u32 s40, s46, 180224
    buffer_load_dwordx4 v2, s[8:11], s40 offen sc1 lds
    buffer_load_dwordx4 v2, s[8:11], s40 offen offset:1024 sc1 lds
    s_waitcnt vmcnt(9) lgkmcnt(0)
    s_barrier
    s_mov_b32 m0, 24576
    s_add_u32 s40, s46, 188416
    buffer_load_dwordx4 v2, s[8:11], s40 offen sc1 lds
    buffer_load_dwordx4 v2, s[8:11], s40 offen offset:1024 sc1 lds
    s_waitcnt vmcnt(7) lgkmcnt(0)
    s_barrier
    s_waitcnt vmcnt(2) lgkmcnt(0)
    s_barrier
    s_waitcnt vmcnt(0) lgkmcnt(0)
    s_barrier
    s_endpgm
kp_L1:
    s_mul_i32 s45, s34, 163840
    s_add_u32 s45, s45, 2641920
    s_lshl_b32 s46, s33, 13
    s_barrier
    s_mov_b32 m0, 6144
    s_add_u32 s40, s46, 6144
    buffer_load_dwordx4 v2, s[8:11], s40 offen lds
    buffer_load_dwordx4 v2, s[8:11], s40 offen offset:1024 lds
    buffer_load_dwordx4 v2, s[8:11], s40 offen offset:2048 lds
    s_mov_b32 m0, 9216
    s_nop 0
    buffer_load_dwordx4 v2, s[8:11], s45 offen lds
    buffer_load_dwordx4 v2, s[8:11], s45 offen offset:1024 lds
    buffer_load_dwordx4 v2, s[8:11], s45 offen offset:2048 lds
    s_mov_b32 m0, 22528
    s_add_u32 s40, s46, 137216
    buffer_load_dwordx4 v2, s[8:11], s40 offen lds
    buffer_load_dwordx4 v2, s[8:11], s40 offen offset:1024 lds
    buffer_load_dwordx4 v2, s[8:11], s40 offen offset:2048 lds
    buffer_load_dwordx4 v2, s[8:11], s40 offen offset:3072 lds
    s_mov_b32 m0, 26624
    s_add_u32 s40, s45, 8192
    buffer_load_dwordx4 v2, s[8:11], s40 offen lds
    buffer_load_dwordx4 v2, s[8:11], s40 offen offset:1024 lds
    s_mov_b32 m0, 40960
    s_add_u32 s40, s46, 270336
    buffer_load_dwordx4 v2, s[8:11], s40 offen lds
    buffer_load_dwordx4 v2, s[8:11], s40 offen offset:1024 lds
    buffer_load_dwordx4 v2, s[8:11], s40 offen offset:2048 lds
    s_mov_b32 m0, 44032
    s_add_u32 s40, s45, 16384
    buffer_load_dwordx4 v2, s[8:11], s40 offen lds
    buffer_load_dwordx4 v2, s[8:11], s40 offen offset:1024 lds
    s_waitcnt vmcnt(11) lgkmcnt(0)
    s_barrier
    s_mov_b32 m0, 56320
    s_add_u32 s40, s46, 400384
    buffer_load_dwordx4 v2, s[8:11], s40 offen lds
    buffer_load_dwordx4 v2, s[8:11], s40 offen offset:1024 lds
    buffer_load_dwordx4 v2, s[8:11], s40 offen offset:2048 lds
    buffer_load_dwordx4 v2, s[8:11], s40 offen offset:3072 lds
    s_waitcnt vmcnt(9) lgkmcnt(0)
    s_barrier
    s_mov_b32 m0, 5120
    s_add_u32 s40, s46, 533504
    buffer_load_dwordx4 v2, s[8:11], s40 offen lds
    buffer_load_dwordx4 v2, s[8:11], s40 offen offset:1024 lds
    buffer_load_dwordx4 v2, s[8:11], s40 offen offset:2048 lds
    buffer_load_dwordx4 v2, s[8:11], s40 offen offset:3072 lds
    s_waitcnt vmcnt(8) lgkmcnt(0)
    s_barrier
    s_mov_b32 m0, 21504
    s_add_u32 s40, s46, 664576
    buffer_load_dwordx4 v2, s[8:11], s40 offen lds
    buffer_load_dwordx4 v2, s[8:11], s40 offen offset:1024 lds
    buffer_load_dwordx4 v2, s[8:11], s40 offen offset:2048 lds
    buffer_load_dwordx4 v2, s[8:11], s40 offen offset:3072 lds
    s_mov_b32 m0, 25600
    s_add_u32 s40, s46, 668672
    buffer_load_dwordx4 v2, s[8:11], s40 offen lds
    s_waitcnt vmcnt(9) lgkmcnt(0)
    s_barrier
    s_mov_b32 m0, 38912
    s_add_u32 s40, s46, 796672
    buffer_load_dwordx4 v2, s[8:11], s40 offen lds
    buffer_load_dwordx4 v2, s[8:11], s40 offen offset:1024 lds
    buffer_load_dwordx4 v2, s[8:11], s40 offen offset:2048 lds
    buffer_load_dwordx4 v2, s[8:11], s40 offen offset:3072 lds
    s_waitcnt vmcnt(9) lgkmcnt(0)
    s_barrier
    s_mov_b32 m0, 56320
    s_add_u32 s40, s46, 928768
    buffer_load_dwordx4 v2, s[8:11], s40 offen lds
    buffer_load_dwordx4 v2, s[8:11], s40 offen offset:1024 lds
    buffer_load_dwordx4 v2, s[8:11], s40 offen offset:2048 lds
    buffer_load_dwordx4 v2, s[8:11], s40 offen offset:3072 lds
    s_waitcnt vmcnt(8) lgkmcnt(0)
    s_barrier
    s_mov_b32 m0, 5120
    s_add_u32 s40, s46, 1061888
    buffer_load_dwordx4 v2, s[8:11], s40 offen lds
    buffer_load_dwordx4 v2, s[8:11], s40 offen offset:1024 lds
    buffer_load_dwordx4 v2, s[8:11], s40 offen offset:2048 lds
    buffer_load_dwordx4 v2, s[8:11], s40 offen offset:3072 lds
    v_lshlrev_b32 v40, 7, v1
    v_lshlrev_b32 v41, 7, v1
    v_add_u32 v41, 8192, v41
    v_lshlrev_b32 v42, 7, v1
    v_add_u32 v42, 16384, v42
    v_lshlrev_b32 v43, 7, v1
    v_add_u32 v43, 24576, v43
    s_mov_b32 s47, 26599424
    buffer_load_dword v44, v40, s[8:11], s47 offen sc1
    buffer_load_dword v45, v41, s[8:11], s47 offen sc1
    buffer_load_dword v46, v42, s[8:11], s47 offen sc1
    buffer_load_dword v47, v43, s[8:11], s47 offen sc1
    s_waitcnt vmcnt(12) lgkmcnt(0)
    s_barrier
    s_mov_b32 m0, 21504
    s_add_u32 s40, s46, 1192960
    buffer_load_dwordx4 v2, s[8:11], s40 offen lds
    buffer_load_dwordx4 v2, s[8:11], s40 offen offset:1024 lds
    buffer_load_dwordx4 v2, s[8:11], s40 offen offset:2048 lds
    buffer_load_dwordx4 v2, s[8:11], s40 offen offset:3072 lds
    s_mov_b32 m0, 25600
    s_add_u32 s40, s46, 1197056
    buffer_load_dwordx4 v2, s[8:11], s40 offen lds
    s_waitcnt vmcnt(13) lgkmcnt(0)
    s_barrier
    s_mov_b32 m0, 38912
    s_add_u32 s40, s46, 1325056
    buffer_load_dwordx4 v2, s[8:11], s40 offen lds
    buffer_load_dwordx4 v2, s[8:11], s40 offen offset:1024 lds
    buffer_load_dwordx4 v2, s[8:11], s40 offen offset:2048 lds
    buffer_load_dwordx4 v2, s[8:11], s40 offen offset:3072 lds
    s_waitcnt vmcnt(13) lgkmcnt(0)
    s_barrier
    s_mov_b32 m0, 56320
    s_add_u32 s40, s46, 1457152
    buffer_load_dwordx4 v2, s[8:11], s40 offen lds
    buffer_load_dwordx4 v2, s[8:11], s40 offen offset:1024 lds
    buffer_load_dwordx4 v2, s[8:11], s40 offen offset:2048 lds
    buffer_load_dwordx4 v2, s[8:11], s40 offen offset:3072 lds
    s_waitcnt vmcnt(8) lgkmcnt(0)
    s_barrier
    s_mov_b32 m0, 5120
    s_add_u32 s40, s46, 1590272
    buffer_load_dwordx4 v2, s[8:11], s40 offen lds
    buffer_load_dwordx4 v2, s[8:11], s40 offen offset:1024 lds
    buffer_load_dwordx4 v2, s[8:11], s40 offen offset:2048 lds
    buffer_load_dwordx4 v2, s[8:11], s40 offen offset:3072 lds
    s_waitcnt vmcnt(8) lgkmcnt(0)
    s_barrier
    s_mov_b32 m0, 21504
    s_add_u32 s40, s46, 1721344
    buffer_load_dwordx4 v2, s[8:11], s40 offen lds
    buffer_load_dwordx4 v2, s[8:11], s40 offen offset:1024 lds
    buffer_load_dwordx4 v2, s[8:11], s40 offen offset:2048 lds
    buffer_load_dwordx4 v2, s[8:11], s40 offen offset:3072 lds
    s_mov_b32 m0, 25600
    s_add_u32 s40, s46, 1725440
    buffer_load_dwordx4 v2, s[8:11], s40 offen lds
    s_waitcnt vmcnt(9) lgkmcnt(0)
    s_barrier
    s_mov_b32 m0, 38912
    s_add_u32 s40, s46, 1853440
    buffer_load_dwordx4 v2, s[8:11], s40 offen lds
    buffer_load_dwordx4 v2, s[8:11], s40 offen offset:1024 lds
    buffer_load_dwordx4 v2, s[8:11], s40 offen offset:2048 lds
    buffer_load_dwordx4 v2, s[8:11], s40 offen offset:3072 lds
    s_waitcnt vmcnt(9) lgkmcnt(0)
    s_barrier
    s_mov_b32 m0, 56320
    s_add_u32 s40, s46, 1985536
    buffer_load_dwordx4 v2, s[8:11], s40 offen lds
    buffer_load_dwordx4 v2, s[8:11], s40 offen offset:1024 lds
    buffer_load_dwordx4 v2, s[8:11], s40 offen offset:2048 lds
    buffer_load_dwordx4 v2, s[8:11], s40 offen offset:3072 lds
    s_waitcnt vmcnt(8) lgkmcnt(0)
    s_barrier
    s_mov_b32 m0, 5120
    s_add_u32 s40, s46, 2118656
    buffer_load_dwordx4 v2, s[8:11], s40 offen lds
    buffer_load_dwordx4 v2, s[8:11], s40 offen offset:1024 lds
    buffer_load_dwordx4 v2, s[8:11], s40 offen offset:2048 lds
    buffer_load_dwordx4 v2, s[8:11], s40 offen offset:3072 lds
    s_waitcnt vmcnt(8) lgkmcnt(0)
    s_barrier
    s_mov_b32 m0, 21504
    s_add_u32 s40, s46, 2249728
    buffer_load_dwordx4 v2, s[8:11], s40 offen lds
    buffer_load_dwordx4 v2, s[8:11], s40 offen offset:1024 lds
    buffer_load_dwordx4 v2, s[8:11], s40 offen offset:2048 lds
    buffer_load_dwordx4 v2, s[8:11], s40 offen offset:3072 lds
    s_mov_b32 m0, 25600
    s_add_u32 s40, s46, 2253824
    buffer_load_dwordx4 v2, s[8:11], s40 offen lds
    v_cmp_eq_u32 vcc, s96, v44
    v_cmp_eq_u32 s[42:43], s96, v45
    s_nop 3
    s_and_b64 vcc, vcc, s[42:43]
    v_cmp_eq_u32 s[42:43], s96, v46
    s_nop 3
    s_and_b64 vcc, vcc, s[42:43]
    v_cmp_eq_u32 s[42:43], s96, v47
    s_nop 3
    s_and_b64 vcc, vcc, s[42:43]
    s_cmp_eq_u64 vcc, -1
    s_cbranch_scc1 kp_paok36
    s_mov_b32 s47, 26599424
    s_mov_b32 s39, 32768
kp_pm37:
    buffer_load_dword v44, v40, s[8:11], s47 offen sc1
    buffer_load_dword v45, v41, s[8:11], s47 offen sc1
    buffer_load_dword v46, v42, s[8:11], s47 offen sc1
    buffer_load_dword v47, v43, s[8:11], s47 offen sc1
    s_waitcnt vmcnt(0)
    v_cmp_eq_u32 vcc, s96, v44
    v_cmp_eq_u32 s[42:43], s96, v45
    s_nop 3
    s_and_b64 vcc, vcc, s[42:43]
    v_cmp_eq_u32 s[42:43], s96, v46
    s_nop 3
    s_and_b64 vcc, vcc, s[42:43]
    v_cmp_eq_u32 s[42:43], s96, v47
    s_nop 3
    s_and_b64 vcc, vcc, s[42:43]
    s_cmp_eq_u64 vcc, -1
    s_cbranch_scc1 kp_pn38
    s_sub_u32 s39, s39, 1
    s_cmp_lg_u32 s39, 0
    s_cbranch_scc1 kp_pm37
kp_pn38:
kp_paok36:
    s_mov_b32 s40, 26632192
    s_cmp_eq_u32 s2, 0
    s_cselect_b32 s40, s40, 0x40000000
    v_mov_b32 v48, s96
    v_mov_b32 v49, 0
    s_mov_b64 exec, 1
    buffer_store_dword v48, v49, s[8:11], s40 offen sc1
    s_mov_b64 exec, -1
    s_waitcnt vmcnt(10) lgkmcnt(0)
    s_barrier
    s_mov_b32 m0, 38912
    s_add_u32 s40, s46, 2381824
    buffer_load_dwordx4 v2, s[8:11], s40 offen lds
    buffer_load_dwordx4 v2, s[8:11], s40 offen offset:1024 lds
    buffer_load_dwordx4 v2, s[8:11], s40 offen offset:2048 lds
    buffer_load_dwordx4 v2, s[8:11], s40 offen offset:3072 lds
    s_waitcnt vmcnt(10) lgkmcnt(0)
    s_barrier
    s_mov_b32 m0, 56320
    s_add_u32 s40, s46, 2513920
    buffer_load_dwordx4 v2, s[8:11], s40 offen lds
    buffer_load_dwordx4 v2, s[8:11], s40 offen offset:1024 lds
    buffer_load_dwordx4 v2, s[8:11], s40 offen offset:2048 lds
    buffer_load_dwordx4 v2, s[8:11], s40 offen offset:3072 lds
    s_waitcnt vmcnt(9) lgkmcnt(0)
    s_barrier
    s_waitcnt vmcnt(4) lgkmcnt(0)
    s_barrier
    s_waitcnt vmcnt(0) lgkmcnt(0)
    s_barrier
    s_barrier
    s_mul_i32 s45, s36, 102400
    s_add_u32 s45, s45, 5357568
    s_mul_i32 s46, s35, 81920
    s_add_u32 s46, s46, 12197888
    s_mov_b32 m0, 3072
    s_add_u32 s40, s45, 3072
    buffer_load_dwordx4 v2, s[8:11], s40 offen sc1 lds
    buffer_load_dwordx4 v2, s[8:11], s40 offen offset:1024 sc1 lds
    buffer_load_dwordx4 v2, s[8:11], s40 offen offset:2048 sc1 lds
    s_mov_b32 m0, 12288
    s_add_u32 s40, s45, 12288
    buffer_load_dwordx4 v2, s[8:11], s40 offen sc1 lds
    buffer_load_dwordx4 v2, s[8:11], s40 offen offset:1024 sc1 lds
    buffer_load_dwordx4 v2, s[8:11], s40 offen offset:2048 sc1 lds
    s_mov_b32 m0, 22528
    s_add_u32 s40, s45, 22528
    buffer_load_dwordx4 v2, s[8:11], s40 offen sc1 lds
    buffer_load_dwordx4 v2, s[8:11], s40 offen offset:1024 sc1 lds
    s_mov_b32 m0, 33792
    s_add_u32 s40, s45, 33792
    buffer_load_dwordx4 v2, s[8:11], s40 offen sc1 lds
    buffer_load_dwordx4 v2, s[8:11], s40 offen offset:1024 sc1 lds
    s_mov_b32 m0, 44032
    s_add_u32 s40, s45, 44032
    buffer_load_dwordx4 v2, s[8:11], s40 offen sc1 lds
    buffer_load_dwordx4 v2, s[8:11], s40 offen offset:1024 sc1 lds
    buffer_load_dwordx4 v2, s[8:11], s40 offen offset:2048 sc1 lds
    s_mov_b32 m0, 53248
    s_add_u32 s40, s45, 53248
    buffer_load_dwordx4 v2, s[8:11], s40 offen sc1 lds
    buffer_load_dwordx4 v2, s[8:11], s40 offen offset:1024 sc1 lds
    buffer_load_dwordx4 v2, s[8:11], s40 offen offset:2048 sc1 lds
    s_mov_b32 s28, s22
    s_mov_b32 s29, s23
    s_mov_b32 s30, 2621440
    s_mov_b32 s31, 0x20000
    s_mul_i32 s41, s35, 81920
    s_mul_i32 s42, s36, 160
    s_add_u32 s41, s41, s42
    v_add_u32 v5, 64, v1
    v_mul_u32_u24 v6, 6554, v5
    v_lshrrev_b32 v6, 16, v6
    v_mul_u32_u24 v7, 10, v6
    v_sub_u32 v5, v5, v7
    v_lshlrev_b32 v5, 4, v5
    v_mul_u32_u24 v6, 1280, v6
    v_add_u32 v21, v5, v6
    s_mov_b32 m0, 132096
    s_nop 0
    buffer_load_dwordx4 v21, s[28:31], s41 offen lds
    v_add_u32 v5, 320, v1
    v_mul_u32_u24 v6, 6554, v5
    v_lshrrev_b32 v6, 16, v6
    v_mul_u32_u24 v7, 10, v6
    v_sub_u32 v5, v5, v7
    v_lshlrev_b32 v5, 4, v5
    v_mul_u32_u24 v6, 1280, v6
    v_add_u32 v25, v5, v6
    s_mov_b32 m0, 136192
    s_nop 0
    buffer_load_dwordx4 v25, s[28:31], s41 offen lds
    v_add_u32 v5, 576, v1
    v_mul_u32_u24 v6, 6554, v5
    v_lshrrev_b32 v6, 16, v6
    v_mul_u32_u24 v7, 10, v6
    v_sub_u32 v5, v5, v7
    v_lshlrev_b32 v5, 4, v5
    v_mul_u32_u24 v6, 1280, v6
    v_add_u32 v29, v5, v6
    s_mov_b32 m0, 140288
    s_nop 0
    buffer_load_dwordx4 v29, s[28:31], s41 offen lds
    s_waitcnt vmcnt(0) lgkmcnt(0)
    s_barrier
    s_mov_b32 m0, 88064
    s_add_u32 s40, s46, 26624
    buffer_load_dwordx4 v2, s[8:11], s40 offen sc1 lds
    buffer_load_dwordx4 v2, s[8:11], s40 offen offset:1024 sc1 lds
    s_waitcnt lgkmcnt(0)
    s_barrier
    s_mov_b32 m0, 63488
    s_add_u32 s40, s46, 34816
    buffer_load_dwordx4 v2, s[8:11], s40 offen sc1 lds
    buffer_load_dwordx4 v2, s[8:11], s40 offen offset:1024 sc1 lds
    s_mov_b32 m0, 2048
    s_add_u32 s40, s45, 63488
    buffer_load_dwordx4 v2, s[8:11], s40 offen sc1 lds
    buffer_load_dwordx4 v2, s[8:11], s40 offen offset:1024 sc1 lds
    s_waitcnt lgkmcnt(0)
    s_barrier
    s_mov_b32 m0, 71680
    s_add_u32 s40, s46, 43008
    buffer_load_dwordx4 v2, s[8:11], s40 offen sc1 lds
    buffer_load_dwordx4 v2, s[8:11], s40 offen offset:1024 sc1 lds
    s_mov_b32 m0, 13312
    s_add_u32 s40, s45, 74752
    buffer_load_dwordx4 v2, s[8:11], s40 offen sc1 lds
    buffer_load_dwordx4 v2, s[8:11], s40 offen offset:1024 sc1 lds
    s_waitcnt vmcnt(8) lgkmcnt(0)
    s_barrier
    s_mov_b32 m0, 79872
    s_add_u32 s40, s46, 51200
    buffer_load_dwordx4 v2, s[8:11], s40 offen sc1 lds
    buffer_load_dwordx4 v2, s[8:11], s40 offen offset:1024 sc1 lds
    s_mov_b32 m0, 23552
    s_add_u32 s40, s45, 84992
    buffer_load_dwordx4 v2, s[8:11], s40 offen sc1 lds
    buffer_load_dwordx4 v2, s[8:11], s40 offen offset:1024 sc1 lds
    buffer_load_dwordx4 v2, s[8:11], s40 offen offset:2048 sc1 lds
    s_waitcnt vmcnt(11) lgkmcnt(0)
    s_barrier
    s_mov_b32 m0, 88064
    s_add_u32 s40, s46, 59392
    buffer_load_dwordx4 v2, s[8:11], s40 offen sc1 lds
    buffer_load_dwordx4 v2, s[8:11], s40 offen offset:1024 sc1 lds
    s_mov_b32 m0, 32768
    s_add_u32 s40, s45, 94208
    buffer_load_dwordx4 v2, s[8:11], s40 offen sc1 lds
    buffer_load_dwordx4 v2, s[8:11], s40 offen offset:1024 sc1 lds
    buffer_load_dwordx4 v2, s[8:11], s40 offen offset:2048 sc1 lds
    v_min_u32 v58, 29, v1
    v_mul_u32_u24 v59, 35, v58
    v_lshrrev_b32 v59, 9, v59
    v_mul_u32_u24 v57, 120, v59
    v_mul_u32_u24 v59, 15, v59
    v_sub_u32 v58, v58, v59
    v_mul_u32_u24 v59, 86, v58
    v_lshrrev_b32 v59, 8, v59
    v_mad_u32_u24 v57, v59, 24, v57
    v_mul_u32_u24 v59, 3, v59
    v_sub_u32 v58, v58, v59
    s_mul_i32 s40, s34, 6
    s_add_u32 s41, s40, 5
    s_lshr_b32 s40, s40, 2
    s_lshr_b32 s41, s41, 2
    v_add_u32 v58, s40, v58
    v_min_u32 v58, s41, v58
    v_add_u32 v57, v57, v58
    v_lshlrev_b32 v57, 7, v57
    s_mov_b32 s47, 26501120
    buffer_load_dword v56, v57, s[8:11], s47 offen sc1
    s_waitcnt vmcnt(13) lgkmcnt(0)
    s_barrier
    s_mov_b32 m0, 63488
    s_add_u32 s40, s46, 67584
    buffer_load_dwordx4 v2, s[8:11], s40 offen sc1 lds
    buffer_load_dwordx4 v2, s[8:11], s40 offen offset:1024 sc1 lds
    s_waitcnt vmcnt(11) lgkmcnt(0)
    s_barrier
    s_mov_b32 m0, 71680
    s_add_u32 s40, s46, 75776
    buffer_load_dwordx4 v2, s[8:11], s40 offen sc1 lds
    buffer_load_dwordx4 v2, s[8:11], s40 offen offset:1024 sc1 lds
    s_waitcnt vmcnt(8) lgkmcnt(0)
    s_barrier
    s_waitcnt vmcnt(4)
    v_cmp_eq_u32 vcc, s96, v56
    s_nop 3
    s_cmp_eq_u64 vcc, -1
    s_cbranch_scc1 kp_sfok39
    s_mov_b32 s39, 32768
kp_p40:
    buffer_load_dword v56, v57, s[8:11], s47 offen sc1
    s_waitcnt vmcnt(0)
    v_cmp_eq_u32 vcc, s96, v56
    s_nop 3
    s_cmp_eq_u64 vcc, -1
    s_cbranch_scc1 kp_q41
    s_sub_u32 s39, s39, 1
    s_cmp_lg_u32 s39, 0
    s_cbranch_scc1 kp_p40
kp_q41:
kp_sfok39:
    s_mul_i32 s45, s34, 245760
    s_add_u32 s45, s45, 6176768
    s_mul_i32 s46, s33, 163840
    s_add_u32 s46, s46, 17440768
    s_mov_b32 m0, 97280
    s_add_u32 s40, s45, 3072
    buffer_load_dwordx4 v2, s[8:11], s40 offen sc1 lds
    buffer_load_dwordx4 v2, s[8:11], s40 offen offset:1024 sc1 lds
    buffer_load_dwordx4 v2, s[8:11], s40 offen offset:2048 sc1 lds
    s_waitcnt vmcnt(5) lgkmcnt(0)
    s_barrier
    s_mov_b32 m0, 109568
    s_add_u32 s40, s45, 15360
    buffer_load_dwordx4 v2, s[8:11], s40 offen sc1 lds
    buffer_load_dwordx4 v2, s[8:11], s40 offen offset:1024 sc1 lds
    buffer_load_dwordx4 v2, s[8:11], s40 offen offset:2048 sc1 lds
    s_waitcnt vmcnt(6) lgkmcnt(0)
    s_barrier
    s_mov_b32 m0, 121856
    s_add_u32 s40, s45, 27648
    buffer_load_dwordx4 v2, s[8:11], s40 offen sc1 lds
    buffer_load_dwordx4 v2, s[8:11], s40 offen offset:1024 sc1 lds
    buffer_load_dwordx4 v2, s[8:11], s40 offen offset:2048 sc1 lds
    s_waitcnt vmcnt(6) lgkmcnt(0)
    s_barrier
    s_mov_b32 m0, 136192
    s_add_u32 s40, s45, 41984
    buffer_load_dwordx4 v2, s[8:11], s40 offen sc1 lds
    buffer_load_dwordx4 v2, s[8:11], s40 offen offset:1024 sc1 lds
    buffer_load_dwordx4 v2, s[8:11], s40 offen offset:2048 sc1 lds
    buffer_load_dwordx4 v2, s[8:11], s40 offen offset:3072 sc1 lds
    s_mov_b32 m0, 140288
    s_add_u32 s40, s45, 46080
    buffer_load_dwordx4 v2, s[8:11], s40 offen sc1 lds
    s_waitcnt vmcnt(8) lgkmcnt(0)
    s_barrier
    s_mov_b32 m0, 99328
    s_add_u32 s40, s45, 54272
    buffer_load_dwordx4 v2, s[8:11], s40 offen sc1 lds
    buffer_load_dwordx4 v2, s[8:11], s40 offen offset:1024 sc1 lds
    buffer_load_dwordx4 v2, s[8:11], s40 offen offset:2048 sc1 lds
    buffer_load_dwordx4 v2, s[8:11], s40 offen offset:3072 sc1 lds
    s_mov_b32 m0, 103424
    s_add_u32 s40, s45, 58368
    buffer_load_dwordx4 v2, s[8:11], s40 offen sc1 lds
    s_waitcnt vmcnt(10) lgkmcnt(0)
    s_barrier
    s_mov_b32 m0, 111616
    s_add_u32 s40, s45, 66560
    buffer_load_dwordx4 v2, s[8:11], s40 offen sc1 lds
    buffer_load_dwordx4 v2, s[8:11], s40 offen offset:1024 sc1 lds
    buffer_load_dwordx4 v2, s[8:11], s40 offen offset:2048 sc1 lds
    buffer_load_dwordx4 v2, s[8:11], s40 offen offset:3072 sc1 lds
    s_mov_b32 m0, 115712
    s_add_u32 s40, s45, 70656
    buffer_load_dwordx4 v2, s[8:11], s40 offen sc1 lds
    s_waitcnt vmcnt(10) lgkmcnt(0)
    s_barrier
    s_mov_b32 m0, 123904
    s_add_u32 s40, s45, 78848
    buffer_load_dwordx4 v2, s[8:11], s40 offen sc1 lds
    buffer_load_dwordx4 v2, s[8:11], s40 offen offset:1024 sc1 lds
    buffer_load_dwordx4 v2, s[8:11], s40 offen offset:2048 sc1 lds
    buffer_load_dwordx4 v2, s[8:11], s40 offen offset:3072 sc1 lds
    s_mov_b32 m0, 128000
    s_add_u32 s40, s45, 82944
    buffer_load_dwordx4 v2, s[8:11], s40 offen sc1 lds
    s_lshl_b32 s42, s33, 3
    s_add_u32 s42, s42, 2
    s_lshl_b32 s42, s42, 10
    s_add_u32 s42, s42, 20062208
    v_and_b32 v5, 15, v1
    v_lshl_add_u32 v5, v5, 6, v3
    buffer_load_dwordx4 v[16:19], v5, s[8:11], s42 offen offset:0 sc1
    buffer_load_dwordx4 v[20:23], v5, s[8:11], s42 offen offset:1024 sc1
    v_add_u32 v44, 64, v1
    v_mul_u32_u24 v6, 43, v44
    v_lshrrev_b32 v6, 10, v6
    v_mul_u32_u24 v7, 24, v6
    v_sub_u32 v7, v44, v7
    v_mul_u32_u24 v6, 6144, v6
    v_lshl_add_u32 v6, v7, 4, v6
    v_mov_b32 v7, 0x40000000
    v_cmp_gt_u32 vcc, 96, v44
    s_nop 1
    v_cndmask_b32 v6, v7, v6, vcc
    s_mul_i32 s43, s34, 384
    s_add_u32 s43, s43, 12075008
    buffer_load_dwordx4 v[24:27], v6, s[8:11], s43 offen sc1
    s_add_u32 s43, s43, 24576
    buffer_load_dwordx4 v[28:31], v6, s[8:11], s43 offen sc1
    s_add_u32 s43, s43, 24576
    buffer_load_dwordx4 v[32:35], v6, s[8:11], s43 offen sc1
    s_add_u32 s43, s43, 24576
    buffer_load_dwordx4 v[36:39], v6, s[8:11], s43 offen sc1
    s_add_u32 s43, s43, 24576
    buffer_load_dwordx4 v[40:43], v6, s[8:11], s43 offen sc1
    s_waitcnt vmcnt(17) lgkmcnt(0)
    s_barrier
    s_mov_b32 m0, 136192
    s_add_u32 s40, s45, 91136
    buffer_load_dwordx4 v2, s[8:11], s40 offen sc1 lds
    buffer_load_dwordx4 v2, s[8:11], s40 offen offset:1024 sc1 lds
    buffer_load_dwordx4 v2, s[8:11], s40 offen offset:2048 sc1 lds
    buffer_load_dwordx4 v2, s[8:11], s40 offen offset:3072 sc1 lds
    s_mov_b32 m0, 140288
    s_add_u32 s40, s45, 95232
    buffer_load_dwordx4 v2, s[8:11], s40 offen sc1 lds
    s_waitcnt vmcnt(17) lgkmcnt(0)
    s_barrier
    s_mov_b32 m0, 99328
    s_add_u32 s40, s45, 103424
    buffer_load_dwordx4 v2, s[8:11], s40 offen sc1 lds
    buffer_load_dwordx4 v2, s[8:11], s40 offen offset:1024 sc1 lds
    buffer_load_dwordx4 v2, s[8:11], s40 offen offset:2048 sc1 lds
    buffer_load_dwordx4 v2, s[8:11], s40 offen offset:3072 sc1 lds
    s_mov_b32 m0, 103424
    s_add_u32 s40, s45, 107520
    buffer_load_dwordx4 v2, s[8:11], s40 offen sc1 lds
    s_waitcnt vmcnt(17) lgkmcnt(0)
    s_barrier
    s_mov_b32 m0, 111616
    s_add_u32 s40, s45, 115712
    buffer_load_dwordx4 v2, s[8:11], s40 offen sc1 lds
    buffer_load_dwordx4 v2, s[8:11], s40 offen offset:1024 sc1 lds
    buffer_load_dwordx4 v2, s[8:11], s40 offen offset:2048 sc1 lds
    buffer_load_dwordx4 v2, s[8:11], s40 offen offset:3072 sc1 lds
    s_mov_b32 m0, 115712
    s_add_u32 s40, s45, 119808
    buffer_load_dwordx4 v2, s[8:11], s40 offen sc1 lds
    s_waitcnt vmcnt(10) lgkmcnt(0)
    s_barrier
    s_mov_b32 m0, 123904
    s_add_u32 s40, s45, 128000
    buffer_load_dwordx4 v2, s[8:11], s40 offen sc1 lds
    buffer_load_dwordx4 v2, s[8:11], s40 offen offset:1024 sc1 lds
    buffer_load_dwordx4 v2, s[8:11], s40 offen offset:2048 sc1 lds
    buffer_load_dwordx4 v2, s[8:11], s40 offen offset:3072 sc1 lds
    s_mov_b32 m0, 128000
    s_add_u32 s40, s45, 132096
    buffer_load_dwordx4 v2, s[8:11], s40 offen sc1 lds
    s_waitcnt vmcnt(10) lgkmcnt(0)
    s_barrier
    s_mov_b32 m0, 136192
    s_add_u32 s40, s45, 140288
    buffer_load_dwordx4 v2, s[8:11], s40 offen sc1 lds
    buffer_load_dwordx4 v2, s[8:11], s40 offen offset:1024 sc1 lds
    buffer_load_dwordx4 v2, s[8:11], s40 offen offset:2048 sc1 lds
    buffer_load_dwordx4 v2, s[8:11], s40 offen offset:3072 sc1 lds
    s_mov_b32 m0, 140288
    s_add_u32 s40, s45, 144384
    buffer_load_dwordx4 v2, s[8:11], s40 offen sc1 lds
    s_waitcnt vmcnt(10) lgkmcnt(0)
    s_barrier
    s_mov_b32 m0, 99328
    s_add_u32 s40, s45, 152576
    buffer_load_dwordx4 v2, s[8:11], s40 offen sc1 lds
    buffer_load_dwordx4 v2, s[8:11], s40 offen offset:1024 sc1 lds
    buffer_load_dwordx4 v2, s[8:11], s40 offen offset:2048 sc1 lds
    buffer_load_dwordx4 v2, s[8:11], s40 offen offset:3072 sc1 lds
    s_mov_b32 m0, 103424
    s_add_u32 s40, s45, 156672
    buffer_load_dwordx4 v2, s[8:11], s40 offen sc1 lds
    s_waitcnt vmcnt(10) lgkmcnt(0)
    s_barrier
    s_mov_b32 m0, 111616
    s_add_u32 s40, s45, 164864
    buffer_load_dwordx4 v2, s[8:11], s40 offen sc1 lds
    buffer_load_dwordx4 v2, s[8:11], s40 offen offset:1024 sc1 lds
    buffer_load_dwordx4 v2, s[8:11], s40 offen offset:2048 sc1 lds
    buffer_load_dwordx4 v2, s[8:11], s40 offen offset:3072 sc1 lds
    s_mov_b32 m0, 115712
    s_add_u32 s40, s45, 168960
    buffer_load_dwordx4 v2, s[8:11], s40 offen sc1 lds
    v_min_u32 v58, 23, v1
    v_lshrrev_b32 v59, 1, v58
    v_mul_u32_u24 v57, 10, v59
    v_and_b32 v58, 1, v58
    s_mul_i32 s40, s36, 5
    s_add_u32 s41, s40, 4
    s_lshr_b32 s40, s40, 2
    s_lshr_b32 s41, s41, 2
    v_add_u32 v58, s40, v58
    v_min_u32 v58, s41, v58
    v_add_u32 v57, v57, v58
    v_lshlrev_b32 v57, 7, v57
    s_mov_b32 s47, 26533888
    buffer_load_dword v56, v57, s[8:11], s47 offen sc1
    s_waitcnt vmcnt(11) lgkmcnt(0)
    s_barrier
    s_mov_b32 m0, 123904
    s_add_u32 s40, s45, 177152
    buffer_load_dwordx4 v2, s[8:11], s40 offen sc1 lds
    buffer_load_dwordx4 v2, s[8:11], s40 offen offset:1024 sc1 lds
    buffer_load_dwordx4 v2, s[8:11], s40 offen offset:2048 sc1 lds
    buffer_load_dwordx4 v2, s[8:11], s40 offen offset:3072 sc1 lds
    s_mov_b32 m0, 128000
    s_add_u32 s40, s45, 181248
    buffer_load_dwordx4 v2, s[8:11], s40 offen sc1 lds
    s_waitcnt vmcnt(11) lgkmcnt(0)
    s_barrier
    s_mov_b32 m0, 136192
    s_add_u32 s40, s45, 189440
    buffer_load_dwordx4 v2, s[8:11], s40 offen sc1 lds
    buffer_load_dwordx4 v2, s[8:11], s40 offen offset:1024 sc1 lds
    buffer_load_dwordx4 v2, s[8:11], s40 offen offset:2048 sc1 lds
    buffer_load_dwordx4 v2, s[8:11], s40 offen offset:3072 sc1 lds
    s_mov_b32 m0, 140288
    s_add_u32 s40, s45, 193536
    buffer_load_dwordx4 v2, s[8:11], s40 offen sc1 lds
    s_waitcnt vmcnt(11) lgkmcnt(0)
    s_barrier
    s_mov_b32 m0, 99328
    s_add_u32 s40, s45, 201728
    buffer_load_dwordx4 v2, s[8:11], s40 offen sc1 lds
    buffer_load_dwordx4 v2, s[8:11], s40 offen offset:1024 sc1 lds
    buffer_load_dwordx4 v2, s[8:11], s40 offen offset:2048 sc1 lds
    buffer_load_dwordx4 v2, s[8:11], s40 offen offset:3072 sc1 lds
    s_mov_b32 m0, 103424
    s_add_u32 s40, s45, 205824
    buffer_load_dwordx4 v2, s[8:11], s40 offen sc1 lds
    s_waitcnt vmcnt(10) lgkmcnt(0)
    s_barrier
    s_mov_b32 m0, 111616
    s_add_u32 s40, s45, 214016
    buffer_load_dwordx4 v2, s[8:11], s40 offen sc1 lds
    buffer_load_dwordx4 v2, s[8:11], s40 offen offset:1024 sc1 lds
    buffer_load_dwordx4 v2, s[8:11], s40 offen offset:2048 sc1 lds
    buffer_load_dwordx4 v2, s[8:11], s40 offen offset:3072 sc1 lds
    s_mov_b32 m0, 115712
    s_add_u32 s40, s45, 218112
    buffer_load_dwordx4 v2, s[8:11], s40 offen sc1 lds
    s_waitcnt vmcnt(10) lgkmcnt(0)
    s_barrier
    s_mov_b32 m0, 123904
    s_add_u32 s40, s45, 226304
    buffer_load_dwordx4 v2, s[8:11], s40 offen sc1 lds
    buffer_load_dwordx4 v2, s[8:11], s40 offen offset:1024 sc1 lds
    buffer_load_dwordx4 v2, s[8:11], s40 offen offset:2048 sc1 lds
    buffer_load_dwordx4 v2, s[8:11], s40 offen offset:3072 sc1 lds
    s_mov_b32 m0, 128000
    s_add_u32 s40, s45, 230400
    buffer_load_dwordx4 v2, s[8:11], s40 offen sc1 lds
    s_waitcnt vmcnt(10) lgkmcnt(0)
    s_barrier
    s_mov_b32 m0, 136192
    s_add_u32 s40, s45, 238592
    buffer_load_dwordx4 v2, s[8:11], s40 offen sc1 lds
    buffer_load_dwordx4 v2, s[8:11], s40 offen offset:1024 sc1 lds
    buffer_load_dwordx4 v2, s[8:11], s40 offen offset:2048 sc1 lds
    buffer_load_dwordx4 v2, s[8:11], s40 offen offset:3072 sc1 lds
    s_mov_b32 m0, 140288
    s_add_u32 s40, s45, 242688
    buffer_load_dwordx4 v2, s[8:11], s40 offen sc1 lds
    s_waitcnt vmcnt(10) lgkmcnt(0)
    s_barrier
    v_add_f32 v46, v16, v18
    v_mov_b32 v47, v46
    s_nop 1
    v_permlane32_swap_b32 v46, v47
    v_add_f32 v46, v46, v47
    v_mov_b32 v47, v46
    s_nop 1
    v_permlane16_swap_b32 v46, v47
    v_add_f32 v46, v46, v47
    v_mul_f32 v46, 0x3e000000, v46
    v_sub_f32 v47, v16, v46
    v_sub_f32 v48, v18, v46
    v_mul_f32 v47, v47, v47
    v_fmac_f32 v47, v48, v48
    v_add_f32 v48, v17, v19
    v_fmac_f32 v48, 0x42a00000, v47
    v_mov_b32 v47, v48
    s_nop 1
    v_permlane32_swap_b32 v48, v47
    v_add_f32 v48, v48, v47
    v_mov_b32 v47, v48
    s_nop 1
    v_permlane16_swap_b32 v48, v47
    v_add_f32 v48, v48, v47
    v_mov_b32 v47, 0x3727c5ac
    v_fmac_f32 v47, 0x3acccccd, v48
    v_rsq_f32 v50, v47
    s_nop 0
    v_mul_f32 v51, v46, v50
    v_sub_f32 v51, 0, v51
    v_and_b32 v47, 15, v1
    v_lshlrev_b32 v47, 3, v47
    v_add_u32 v47, 145152, v47
    s_mov_b64 exec, 0xffff
    ds_write_b64 v47, v[50:51]
    s_mov_b64 exec, -1
    v_cmp_eq_u32 vcc, s96, v56
    s_nop 3
    s_cmp_eq_u64 vcc, -1
    s_cbranch_scc1 kp_sfok42
    s_mov_b32 s39, 32768
kp_p43:
    buffer_load_dword v56, v57, s[8:11], s47 offen sc1
    s_waitcnt vmcnt(0)
    v_cmp_eq_u32 vcc, s96, v56
    s_nop 3
    s_cmp_eq_u64 vcc, -1
    s_cbranch_scc1 kp_q44
    s_sub_u32 s39, s39, 1
    s_cmp_lg_u32 s39, 0
    s_cbranch_scc1 kp_p43
kp_q44:
kp_sfok42:
    s_mul_i32 s45, s36, 245760
    s_add_u32 s45, s45, 10108928
    s_mul_i32 s46, s35, 196608
    s_add_u32 s46, s46, 20193280
    s_mov_b32 m0, 35840
    s_add_u32 s40, s45, 3072
    buffer_load_dwordx4 v2, s[8:11], s40 offen sc1 lds
    buffer_load_dwordx4 v2, s[8:11], s40 offen offset:1024 sc1 lds
    buffer_load_dwordx4 v2, s[8:11], s40 offen offset:2048 sc1 lds
    s_waitcnt vmcnt(8) lgkmcnt(0)
    s_barrier
    v_add_f32 v46, v20, v22
    v_mov_b32 v47, v46
    s_nop 1
    v_permlane32_swap_b32 v46, v47
    v_add_f32 v46, v46, v47
    v_mov_b32 v47, v46
    s_nop 1
    v_permlane16_swap_b32 v46, v47
    v_add_f32 v46, v46, v47
    v_mul_f32 v46, 0x3e000000, v46
    v_sub_f32 v47, v20, v46
    v_sub_f32 v48, v22, v46
    v_mul_f32 v47, v47, v47
    v_fmac_f32 v47, v48, v48
    v_add_f32 v48, v21, v23
    v_fmac_f32 v48, 0x42a00000, v47
    v_mov_b32 v47, v48
    s_nop 1
    v_permlane32_swap_b32 v48, v47
    v_add_f32 v48, v48, v47
    v_mov_b32 v47, v48
    s_nop 1
    v_permlane16_swap_b32 v48, v47
    v_add_f32 v48, v48, v47
    v_mov_b32 v47, 0x3727c5ac
    v_fmac_f32 v47, 0x3acccccd, v48
    v_rsq_f32 v50, v47
    s_nop 0
    v_mul_f32 v51, v46, v50
    v_sub_f32 v51, 0, v51
    v_and_b32 v47, 15, v1
    v_lshlrev_b32 v47, 3, v47
    v_add_u32 v47, 145280, v47
    s_mov_b64 exec, 0xffff
    ds_write_b64 v47, v[50:51]
    s_mov_b64 exec, -1
    v_pk_add_f32 v[24:25], v[24:25], v[28:29]
    v_pk_add_f32 v[26:27], v[26:27], v[30:31]
    v_pk_add_f32 v[24:25], v[24:25], v[32:33]
    v_pk_add_f32 v[26:27], v[26:27], v[34:35]
    v_pk_add_f32 v[24:25], v[24:25], v[36:37]
    v_pk_add_f32 v[26:27], v[26:27], v[38:39]
    v_pk_add_f32 v[24:25], v[24:25], v[40:41]
    v_pk_add_f32 v[26:27], v[26:27], v[42:43]
    v_lshlrev_b32 v7, 4, v44
    v_add_u32 v7, 143360, v7
    s_mov_b32 exec_hi, 0
    ds_write_b128 v7, v[24:27]
    s_mov_b64 exec, -1
    s_mov_b32 m0, 45056
    s_add_u32 s40, s45, 12288
    buffer_load_dwordx4 v2, s[8:11], s40 offen sc1 lds
    buffer_load_dwordx4 v2, s[8:11], s40 offen offset:1024 sc1 lds
    buffer_load_dwordx4 v2, s[8:11], s40 offen offset:2048 sc1 lds
    s_waitcnt vmcnt(6) lgkmcnt(0)
    s_barrier
    s_mov_b32 m0, 55296
    s_add_u32 s40, s45, 22528
    buffer_load_dwordx4 v2, s[8:11], s40 offen sc1 lds
    buffer_load_dwordx4 v2, s[8:11], s40 offen offset:1024 sc1 lds
    s_mov_b32 m0, 66560
    s_add_u32 s40, s45, 33792
    buffer_load_dwordx4 v2, s[8:11], s40 offen sc1 lds
    buffer_load_dwordx4 v2, s[8:11], s40 offen offset:1024 sc1 lds
    s_mov_b32 m0, 76800
    s_add_u32 s40, s45, 44032
    buffer_load_dwordx4 v2, s[8:11], s40 offen sc1 lds
    buffer_load_dwordx4 v2, s[8:11], s40 offen offset:1024 sc1 lds
    buffer_load_dwordx4 v2, s[8:11], s40 offen offset:2048 sc1 lds
    s_mov_b32 m0, 86016
    s_add_u32 s40, s45, 53248
    buffer_load_dwordx4 v2, s[8:11], s40 offen sc1 lds
    buffer_load_dwordx4 v2, s[8:11], s40 offen offset:1024 sc1 lds
    buffer_load_dwordx4 v2, s[8:11], s40 offen offset:2048 sc1 lds
    s_mul_i32 s42, s36, 320
    s_add_u32 s42, s42, 5352960
    s_mov_b32 m0, 145920
    s_nop 0
    buffer_load_dwordx4 v2, s[8:11], s42 offen lds
    s_waitcnt vmcnt(0) lgkmcnt(0)
    s_barrier
    s_mov_b32 m0, 26624
    s_add_u32 s40, s46, 26624
    buffer_load_dwordx4 v2, s[8:11], s40 offen sc1 lds
    buffer_load_dwordx4 v2, s[8:11], s40 offen offset:1024 sc1 lds
    s_waitcnt lgkmcnt(0)
    s_barrier
    s_mov_b32 m0, 2048
    s_add_u32 s40, s46, 34816
    buffer_load_dwordx4 v2, s[8:11], s40 offen sc1 lds
    buffer_load_dwordx4 v2, s[8:11], s40 offen offset:1024 sc1 lds
    s_mov_b32 m0, 34816
    s_add_u32 s40, s45, 63488
    buffer_load_dwordx4 v2, s[8:11], s40 offen sc1 lds
    buffer_load_dwordx4 v2, s[8:11], s40 offen offset:1024 sc1 lds
    s_waitcnt lgkmcnt(0)
    s_barrier
    s_mov_b32 m0, 10240
    s_add_u32 s40, s46, 43008
    buffer_load_dwordx4 v2, s[8:11], s40 offen sc1 lds
    buffer_load_dwordx4 v2, s[8:11], s40 offen offset:1024 sc1 lds
    s_mov_b32 m0, 46080
    s_add_u32 s40, s45, 74752
    buffer_load_dwordx4 v2, s[8:11], s40 offen sc1 lds
    buffer_load_dwordx4 v2, s[8:11], s40 offen offset:1024 sc1 lds
    s_waitcnt vmcnt(8) lgkmcnt(0)
    s_barrier
    s_mov_b32 m0, 18432
    s_add_u32 s40, s46, 51200
    buffer_load_dwordx4 v2, s[8:11], s40 offen sc1 lds
    buffer_load_dwordx4 v2, s[8:11], s40 offen offset:1024 sc1 lds
    s_mov_b32 m0, 56320
    s_add_u32 s40, s45, 84992
    buffer_load_dwordx4 v2, s[8:11], s40 offen sc1 lds
    buffer_load_dwordx4 v2, s[8:11], s40 offen offset:1024 sc1 lds
    buffer_load_dwordx4 v2, s[8:11], s40 offen offset:2048 sc1 lds
    s_waitcnt vmcnt(11) lgkmcnt(0)
    s_barrier
    s_mov_b32 m0, 26624
    s_add_u32 s40, s46, 59392
    buffer_load_dwordx4 v2, s[8:11], s40 offen sc1 lds
    buffer_load_dwordx4 v2, s[8:11], s40 offen offset:1024 sc1 lds
    s_mov_b32 m0, 65536
    s_add_u32 s40, s45, 94208
    buffer_load_dwordx4 v2, s[8:11], s40 offen sc1 lds
    buffer_load_dwordx4 v2, s[8:11], s40 offen offset:1024 sc1 lds
    buffer_load_dwordx4 v2, s[8:11], s40 offen offset:2048 sc1 lds
    s_waitcnt vmcnt(12) lgkmcnt(0)
    s_barrier
    s_mov_b32 m0, 2048
    s_add_u32 s40, s46, 67584
    buffer_load_dwordx4 v2, s[8:11], s40 offen sc1 lds
    buffer_load_dwordx4 v2, s[8:11], s40 offen offset:1024 sc1 lds
    s_mov_b32 m0, 75776
    s_add_u32 s40, s45, 104448
    buffer_load_dwordx4 v2, s[8:11], s40 offen sc1 lds
    buffer_load_dwordx4 v2, s[8:11], s40 offen offset:1024 sc1 lds
    s_waitcnt vmcnt(12) lgkmcnt(0)
    s_barrier
    s_mov_b32 m0, 10240
    s_add_u32 s40, s46, 75776
    buffer_load_dwordx4 v2, s[8:11], s40 offen sc1 lds
    buffer_load_dwordx4 v2, s[8:11], s40 offen offset:1024 sc1 lds
    s_mov_b32 m0, 87040
    s_add_u32 s40, s45, 115712
    buffer_load_dwordx4 v2, s[8:11], s40 offen sc1 lds
    buffer_load_dwordx4 v2, s[8:11], s40 offen offset:1024 sc1 lds
    s_waitcnt vmcnt(11) lgkmcnt(0)
    s_barrier
    s_mov_b32 m0, 18432
    s_add_u32 s40, s46, 83968
    buffer_load_dwordx4 v2, s[8:11], s40 offen sc1 lds
    buffer_load_dwordx4 v2, s[8:11], s40 offen offset:1024 sc1 lds
    s_mov_b32 m0, 35840
    s_add_u32 s40, s45, 125952
    buffer_load_dwordx4 v2, s[8:11], s40 offen sc1 lds
    buffer_load_dwordx4 v2, s[8:11], s40 offen offset:1024 sc1 lds
    buffer_load_dwordx4 v2, s[8:11], s40 offen offset:2048 sc1 lds
    s_waitcnt vmcnt(11) lgkmcnt(0)
    s_barrier
    s_mov_b32 m0, 26624
    s_add_u32 s40, s46, 92160
    buffer_load_dwordx4 v2, s[8:11], s40 offen sc1 lds
    buffer_load_dwordx4 v2, s[8:11], s40 offen offset:1024 sc1 lds
    s_mov_b32 m0, 45056
    s_add_u32 s40, s45, 135168
    buffer_load_dwordx4 v2, s[8:11], s40 offen sc1 lds
    buffer_load_dwordx4 v2, s[8:11], s40 offen offset:1024 sc1 lds
    buffer_load_dwordx4 v2, s[8:11], s40 offen offset:2048 sc1 lds
    s_waitcnt vmcnt(12) lgkmcnt(0)
    s_barrier
    s_mov_b32 m0, 2048
    s_add_u32 s40, s46, 100352
    buffer_load_dwordx4 v2, s[8:11], s40 offen sc1 lds
    buffer_load_dwordx4 v2, s[8:11], s40 offen offset:1024 sc1 lds
    s_mov_b32 m0, 55296
    s_add_u32 s40, s45, 145408
    buffer_load_dwordx4 v2, s[8:11], s40 offen sc1 lds
    buffer_load_dwordx4 v2, s[8:11], s40 offen offset:1024 sc1 lds
    s_waitcnt vmcnt(12) lgkmcnt(0)
    s_barrier
    s_mov_b32 m0, 10240
    s_add_u32 s40, s46, 108544
    buffer_load_dwordx4 v2, s[8:11], s40 offen sc1 lds
    buffer_load_dwordx4 v2, s[8:11], s40 offen offset:1024 sc1 lds
    s_mov_b32 m0, 66560
    s_add_u32 s40, s45, 156672
    buffer_load_dwordx4 v2, s[8:11], s40 offen sc1 lds
    buffer_load_dwordx4 v2, s[8:11], s40 offen offset:1024 sc1 lds
    s_waitcnt vmcnt(11) lgkmcnt(0)
    s_barrier
    s_mov_b32 m0, 18432
    s_add_u32 s40, s46, 116736
    buffer_load_dwordx4 v2, s[8:11], s40 offen sc1 lds
    buffer_load_dwordx4 v2, s[8:11], s40 offen offset:1024 sc1 lds
    s_mov_b32 m0, 76800
    s_add_u32 s40, s45, 166912
    buffer_load_dwordx4 v2, s[8:11], s40 offen sc1 lds
    buffer_load_dwordx4 v2, s[8:11], s40 offen offset:1024 sc1 lds
    buffer_load_dwordx4 v2, s[8:11], s40 offen offset:2048 sc1 lds
    s_waitcnt vmcnt(11) lgkmcnt(0)
    s_barrier
    s_mov_b32 m0, 26624
    s_add_u32 s40, s46, 124928
    buffer_load_dwordx4 v2, s[8:11], s40 offen sc1 lds
    buffer_load_dwordx4 v2, s[8:11], s40 offen offset:1024 sc1 lds
    s_mov_b32 m0, 86016
    s_add_u32 s40, s45, 176128
    buffer_load_dwordx4 v2, s[8:11], s40 offen sc1 lds
    buffer_load_dwordx4 v2, s[8:11], s40 offen offset:1024 sc1 lds
    buffer_load_dwordx4 v2, s[8:11], s40 offen offset:2048 sc1 lds
    s_waitcnt vmcnt(12) lgkmcnt(0)
    s_barrier
    s_mov_b32 m0, 2048
    s_add_u32 s40, s46, 133120
    buffer_load_dwordx4 v2, s[8:11], s40 offen sc1 lds
    buffer_load_dwordx4 v2, s[8:11], s40 offen offset:1024 sc1 lds
    s_mov_b32 m0, 34816
    s_add_u32 s40, s45, 186368
    buffer_load_dwordx4 v2, s[8:11], s40 offen sc1 lds
    buffer_load_dwordx4 v2, s[8:11], s40 offen offset:1024 sc1 lds
    s_waitcnt vmcnt(12) lgkmcnt(0)
    s_barrier
    s_mov_b32 m0, 10240
    s_add_u32 s40, s46, 141312
    buffer_load_dwordx4 v2, s[8:11], s40 offen sc1 lds
    buffer_load_dwordx4 v2, s[8:11], s40 offen offset:1024 sc1 lds
    s_mov_b32 m0, 46080
    s_add_u32 s40, s45, 197632
    buffer_load_dwordx4 v2, s[8:11], s40 offen sc1 lds
    buffer_load_dwordx4 v2, s[8:11], s40 offen offset:1024 sc1 lds
    s_waitcnt vmcnt(11) lgkmcnt(0)
    s_barrier
    s_mov_b32 m0, 18432
    s_add_u32 s40, s46, 149504
    buffer_load_dwordx4 v2, s[8:11], s40 offen sc1 lds
    buffer_load_dwordx4 v2, s[8:11], s40 offen offset:1024 sc1 lds
    s_mov_b32 m0, 56320
    s_add_u32 s40, s45, 207872
    buffer_load_dwordx4 v2, s[8:11], s40 offen sc1 lds
    buffer_load_dwordx4 v2, s[8:11], s40 offen offset:1024 sc1 lds
    buffer_load_dwordx4 v2, s[8:11], s40 offen offset:2048 sc1 lds
    s_waitcnt vmcnt(11) lgkmcnt(0)
    s_barrier
    s_mov_b32 m0, 26624
    s_add_u32 s40, s46, 157696
    buffer_load_dwordx4 v2, s[8:11], s40 offen sc1 lds
    buffer_load_dwordx4 v2, s[8:11], s40 offen offset:1024 sc1 lds
    s_mov_b32 m0, 65536
    s_add_u32 s40, s45, 217088
    buffer_load_dwordx4 v2, s[8:11], s40 offen sc1 lds
    buffer_load_dwordx4 v2, s[8:11], s40 offen offset:1024 sc1 lds
    buffer_load_dwordx4 v2, s[8:11], s40 offen offset:2048 sc1 lds
    s_waitcnt vmcnt(12) lgkmcnt(0)
    s_barrier
    s_mov_b32 m0, 2048
    s_add_u32 s40, s46, 165888
    buffer_load_dwordx4 v2, s[8:11], s40 offen sc1 lds
    buffer_load_dwordx4 v2, s[8:11], s40 offen offset:1024 sc1 lds
    s_mov_b32 m0, 75776
    s_add_u32 s40, s45, 227328
    buffer_load_dwordx4 v2, s[8:11], s40 offen sc1 lds
    buffer_load_dwordx4 v2, s[8:11], s40 offen offset:1024 sc1 lds
    s_waitcnt vmcnt(12) lgkmcnt(0)
    s_barrier
    s_mov_b32 m0, 10240
    s_add_u32 s40, s46, 174080
    buffer_load_dwordx4 v2, s[8:11], s40 offen sc1 lds
    buffer_load_dwordx4 v2, s[8:11], s40 offen offset:1024 sc1 lds
    s_mov_b32 m0, 87040
    s_add_u32 s40, s45, 238592
    buffer_load_dwordx4 v2, s[8:11], s40 offen sc1 lds
    buffer_load_dwordx4 v2, s[8:11], s40 offen offset:1024 sc1 lds
    s_waitcnt vmcnt(11) lgkmcnt(0)
    s_barrier
    s_mov_b32 m0, 18432
    s_add_u32 s40, s46, 182272
    buffer_load_dwordx4 v2, s[8:11], s40 offen sc1 lds
    buffer_load_dwordx4 v2, s[8:11], s40 offen offset:1024 sc1 lds
    s_waitcnt vmcnt(8) lgkmcnt(0)
    s_barrier
    s_mov_b32 m0, 26624
    s_add_u32 s40, s46, 190464
    buffer_load_dwordx4 v2, s[8:11], s40 offen sc1 lds
    buffer_load_dwordx4 v2, s[8:11], s40 offen offset:1024 sc1 lds
    s_waitcnt vmcnt(6) lgkmcnt(0)
    s_barrier
    s_waitcnt vmcnt(2) lgkmcnt(0)
    s_barrier
    s_waitcnt vmcnt(0) lgkmcnt(0)
    s_barrier
    s_endpgm
kp_L2:
    s_mul_i32 s45, s34, 163840
    s_add_u32 s45, s45, 2641920
    s_lshl_b32 s46, s33, 13
    s_barrier
    s_mov_b32 m0, 12288
    s_add_u32 s40, s45, 3072
    buffer_load_dwordx4 v2, s[8:11], s40 offen lds
    buffer_load_dwordx4 v2, s[8:11], s40 offen offset:1024 lds
    buffer_load_dwordx4 v2, s[8:11], s40 offen offset:2048 lds
    buffer_load_dwordx4 v2, s[8:11], s40 offen offset:3072 lds
    s_mov_b32 m0, 16384
    s_add_u32 s40, s45, 7168
    buffer_load_dwordx4 v2, s[8:11], s40 offen lds
    s_mov_b32 m0, 28672
    s_add_u32 s40, s45, 10240
    buffer_load_dwordx4 v2, s[8:11], s40 offen lds
    buffer_load_dwordx4 v2, s[8:11], s40 offen offset:1024 lds
    buffer_load_dwordx4 v2, s[8:11], s40 offen offset:2048 lds
    buffer_load_dwordx4 v2, s[8:11], s40 offen offset:3072 lds
    s_mov_b32 m0, 32768
    s_add_u32 s40, s45, 14336
    buffer_load_dwordx4 v2, s[8:11], s40 offen lds
    buffer_load_dwordx4 v2, s[8:11], s40 offen offset:1024 lds
    s_mov_b32 m0, 46080
    s_add_u32 s40, s45, 18432
    buffer_load_dwordx4 v2, s[8:11], s40 offen lds
    buffer_load_dwordx4 v2, s[8:11], s40 offen offset:1024 lds
    buffer_load_dwordx4 v2, s[8:11], s40 offen offset:2048 lds
    buffer_load_dwordx4 v2, s[8:11], s40 offen offset:3072 lds
    s_mov_b32 m0, 50176
    s_add_u32 s40, s45, 22528
    buffer_load_dwordx4 v2, s[8:11], s40 offen lds
    buffer_load_dwordx4 v2, s[8:11], s40 offen offset:1024 lds
    s_getreg_b32 s38, hwreg(HW_REG_XCC_ID, 0, 4)
    s_add_u32 s38, s38, 1
    s_lshl_b32 s40, s33, 4
    s_add_u32 s40, s40, s34
    s_lshl_b32 s40, s40, 7
    s_add_u32 s42, s40, 26566656
    v_mov_b32 v24, s38
    v_mov_b32 v25, s96
    v_mov_b32 v6, 0
    s_mov_b64 exec, 1
    buffer_store_dwordx2 v[24:25], v6, s[8:11], s42 offen
    s_mov_b64 exec, -1
    s_waitcnt vmcnt(13) lgkmcnt(0)
    s_barrier
    s_mov_b32 m0, 60416
    s_add_u32 s40, s46, 404480
    buffer_load_dwordx4 v2, s[8:11], s40 offen lds
    s_mov_b32 m0, 61440
    s_add_u32 s40, s45, 24576
    buffer_load_dwordx4 v2, s[8:11], s40 offen lds
    buffer_load_dwordx4 v2, s[8:11], s40 offen offset:1024 lds
    buffer_load_dwordx4 v2, s[8:11], s40 offen offset:2048 lds
    s_waitcnt vmcnt(11) lgkmcnt(0)
    s_barrier
    s_mov_b32 m0, 9216
    s_add_u32 s40, s45, 32768
    buffer_load_dwordx4 v2, s[8:11], s40 offen lds
    buffer_load_dwordx4 v2, s[8:11], s40 offen offset:1024 lds
    buffer_load_dwordx4 v2, s[8:11], s40 offen offset:2048 lds
    buffer_load_dwordx4 v2, s[8:11], s40 offen offset:3072 lds
    s_waitcnt vmcnt(9) lgkmcnt(0)
    s_barrier
    s_mov_b32 m0, 26624
    s_add_u32 s40, s45, 40960
    buffer_load_dwordx4 v2, s[8:11], s40 offen lds
    buffer_load_dwordx4 v2, s[8:11], s40 offen offset:1024 lds
    buffer_load_dwordx4 v2, s[8:11], s40 offen offset:2048 lds
    buffer_load_dwordx4 v2, s[8:11], s40 offen offset:3072 lds
    s_waitcnt vmcnt(8) lgkmcnt(0)
    s_barrier
    s_mov_b32 m0, 43008
    s_add_u32 s40, s46, 800768
    buffer_load_dwordx4 v2, s[8:11], s40 offen lds
    s_mov_b32 m0, 44032
    s_add_u32 s40, s45, 49152
    buffer_load_dwordx4 v2, s[8:11], s40 offen lds
    buffer_load_dwordx4 v2, s[8:11], s40 offen offset:1024 lds
    buffer_load_dwordx4 v2, s[8:11], s40 offen offset:2048 lds
    buffer_load_dwordx4 v2, s[8:11], s40 offen offset:3072 lds
    s_waitcnt vmcnt(9) lgkmcnt(0)
    s_barrier
    s_mov_b32 m0, 60416
    s_add_u32 s40, s46, 932864
    buffer_load_dwordx4 v2, s[8:11], s40 offen lds
    s_mov_b32 m0, 61440
    s_add_u32 s40, s45, 57344
    buffer_load_dwordx4 v2, s[8:11], s40 offen lds
    buffer_load_dwordx4 v2, s[8:11], s40 offen offset:1024 lds
    buffer_load_dwordx4 v2, s[8:11], s40 offen offset:2048 lds
    s_waitcnt vmcnt(9) lgkmcnt(0)
    s_barrier
    s_mov_b32 m0, 9216
    s_add_u32 s40, s45, 65536
    buffer_load_dwordx4 v2, s[8:11], s40 offen lds
    buffer_load_dwordx4 v2, s[8:11], s40 offen offset:1024 lds
    buffer_load_dwordx4 v2, s[8:11], s40 offen offset:2048 lds
    buffer_load_dwordx4 v2, s[8:11], s40 offen offset:3072 lds
    s_waitcnt vmcnt(8) lgkmcnt(0)
    s_barrier
    s_mov_b32 m0, 26624
    s_add_u32 s40, s45, 73728
    buffer_load_dwordx4 v2, s[8:11], s40 offen lds
    buffer_load_dwordx4 v2, s[8:11], s40 offen offset:1024 lds
    buffer_load_dwordx4 v2, s[8:11], s40 offen offset:2048 lds
    buffer_load_dwordx4 v2, s[8:11], s40 offen offset:3072 lds
    s_waitcnt vmcnt(8) lgkmcnt(0)
    s_barrier
    s_mov_b32 m0, 43008
    s_add_u32 s40, s46, 1329152
    buffer_load_dwordx4 v2, s[8:11], s40 offen lds
    s_mov_b32 m0, 44032
    s_add_u32 s40, s45, 81920
    buffer_load_dwordx4 v2, s[8:11], s40 offen lds
    buffer_load_dwordx4 v2, s[8:11], s40 offen offset:1024 lds
    buffer_load_dwordx4 v2, s[8:11], s40 offen offset:2048 lds
    buffer_load_dwordx4 v2, s[8:11], s40 offen offset:3072 lds
    s_waitcnt vmcnt(9) lgkmcnt(0)
    s_barrier
    s_mov_b32 m0, 60416
    s_add_u32 s40, s46, 1461248
    buffer_load_dwordx4 v2, s[8:11], s40 offen lds
    s_mov_b32 m0, 61440
    s_add_u32 s40, s45, 90112
    buffer_load_dwordx4 v2, s[8:11], s40 offen lds
    buffer_load_dwordx4 v2, s[8:11], s40 offen offset:1024 lds
    buffer_load_dwordx4 v2, s[8:11], s40 offen offset:2048 lds
    s_waitcnt vmcnt(9) lgkmcnt(0)
    s_barrier
    s_mov_b32 m0, 9216
    s_add_u32 s40, s45, 98304
    buffer_load_dwordx4 v2, s[8:11], s40 offen lds
    buffer_load_dwordx4 v2, s[8:11], s40 offen offset:1024 lds
    buffer_load_dwordx4 v2, s[8:11], s40 offen offset:2048 lds
    buffer_load_dwordx4 v2, s[8:11], s40 offen offset:3072 lds
    s_lshl_b32 s40, s33, 11
    s_add_u32 s40, s40, 26566656
    v_and_b32 v20, 15, v1
    v_lshlrev_b32 v20, 7, v20
    buffer_load_dwordx2 v[22:23], v20, s[8:11], s40 offen
    s_waitcnt vmcnt(9) lgkmcnt(0)
    s_barrier
    s_mov_b32 m0, 26624
    s_add_u32 s40, s45, 106496
    buffer_load_dwordx4 v2, s[8:11], s40 offen lds
    buffer_load_dwordx4 v2, s[8:11], s40 offen offset:1024 lds
    buffer_load_dwordx4 v2, s[8:11], s40 offen offset:2048 lds
    buffer_load_dwordx4 v2, s[8:11], s40 offen offset:3072 lds
    s_waitcnt vmcnt(9) lgkmcnt(0)
    s_barrier
    s_mov_b32 m0, 43008
    s_add_u32 s40, s46, 1857536
    buffer_load_dwordx4 v2, s[8:11], s40 offen lds
    s_mov_b32 m0, 44032
    s_add_u32 s40, s45, 114688
    buffer_load_dwordx4 v2, s[8:11], s40 offen lds
    buffer_load_dwordx4 v2, s[8:11], s40 offen offset:1024 lds
    buffer_load_dwordx4 v2, s[8:11], s40 offen offset:2048 lds
    buffer_load_dwordx4 v2, s[8:11], s40 offen offset:3072 lds
    s_waitcnt vmcnt(10) lgkmcnt(0)
    s_barrier
    s_mov_b32 m0, 60416
    s_add_u32 s40, s46, 1989632
    buffer_load_dwordx4 v2, s[8:11], s40 offen lds
    s_mov_b32 m0, 61440
    s_add_u32 s40, s45, 122880
    buffer_load_dwordx4 v2, s[8:11], s40 offen lds
    buffer_load_dwordx4 v2, s[8:11], s40 offen offset:1024 lds
    buffer_load_dwordx4 v2, s[8:11], s40 offen offset:2048 lds
    s_waitcnt vmcnt(9) lgkmcnt(0)
    s_barrier
    s_mov_b32 m0, 9216
    s_add_u32 s40, s45, 131072
    buffer_load_dwordx4 v2, s[8:11], s40 offen lds
    buffer_load_dwordx4 v2, s[8:11], s40 offen offset:1024 lds
    buffer_load_dwordx4 v2, s[8:11], s40 offen offset:2048 lds
    buffer_load_dwordx4 v2, s[8:11], s40 offen offset:3072 lds
    s_waitcnt vmcnt(8) lgkmcnt(0)
    s_barrier
    s_mov_b32 m0, 26624
    s_add_u32 s40, s45, 139264
    buffer_load_dwordx4 v2, s[8:11], s40 offen lds
    buffer_load_dwordx4 v2, s[8:11], s40 offen offset:1024 lds
    buffer_load_dwordx4 v2, s[8:11], s40 offen offset:2048 lds
    buffer_load_dwordx4 v2, s[8:11], s40 offen offset:3072 lds
    s_waitcnt vmcnt(8) lgkmcnt(0)
    s_barrier
    s_mov_b32 m0, 43008
    s_add_u32 s40, s46, 2385920
    buffer_load_dwordx4 v2, s[8:11], s40 offen lds
    s_mov_b32 m0, 44032
    s_add_u32 s40, s45, 147456
    buffer_load_dwordx4 v2, s[8:11], s40 offen lds
    buffer_load_dwordx4 v2, s[8:11], s40 offen offset:1024 lds
    buffer_load_dwordx4 v2, s[8:11], s40 offen offset:2048 lds
    buffer_load_dwordx4 v2, s[8:11], s40 offen offset:3072 lds
    s_waitcnt vmcnt(9) lgkmcnt(0)
    s_barrier
    s_mov_b32 m0, 60416
    s_add_u32 s40, s46, 2518016
    buffer_load_dwordx4 v2, s[8:11], s40 offen lds
    s_mov_b32 m0, 61440
    s_add_u32 s40, s45, 155648
    buffer_load_dwordx4 v2, s[8:11], s40 offen lds
    buffer_load_dwordx4 v2, s[8:11], s40 offen offset:1024 lds
    buffer_load_dwordx4 v2, s[8:11], s40 offen offset:2048 lds
    s_waitcnt vmcnt(9) lgkmcnt(0)
    s_barrier
    s_waitcnt vmcnt(4) lgkmcnt(0)
    s_barrier
    v_cmp_eq_u32 vcc, s38, v22
    v_cmp_eq_u32 s[42:43], s96, v23
    s_nop 3
    s_and_b64 vcc, vcc, s[42:43]
    s_cmp_eq_u64 vcc, -1
    s_cselect_b32 s37, 1, 0
    v_mov_b32 v20, s37
    v_mov_b32 v21, 146944
    ds_write_b32 v21, v20
    s_waitcnt vmcnt(0) lgkmcnt(0)
    s_barrier
    s_barrier
    s_mul_i32 s45, s36, 102400
    s_add_u32 s45, s45, 5357568
    s_mul_i32 s46, s35, 81920
    s_add_u32 s46, s46, 12197888
    s_mov_b32 m0, 6144
    s_add_u32 s40, s45, 6144
    buffer_load_dwordx4 v2, s[8:11], s40 offen sc1 lds
    buffer_load_dwordx4 v2, s[8:11], s40 offen offset:1024 sc1 lds
    s_mov_b32 m0, 15360
    s_add_u32 s40, s45, 15360
    buffer_load_dwordx4 v2, s[8:11], s40 offen sc1 lds
    buffer_load_dwordx4 v2, s[8:11], s40 offen offset:1024 sc1 lds
    buffer_load_dwordx4 v2, s[8:11], s40 offen offset:2048 sc1 lds
    s_mov_b32 m0, 24576
    s_add_u32 s40, s45, 24576
    buffer_load_dwordx4 v2, s[8:11], s40 offen sc1 lds
    buffer_load_dwordx4 v2, s[8:11], s40 offen offset:1024 sc1 lds
    buffer_load_dwordx4 v2, s[8:11], s40 offen offset:2048 sc1 lds
    s_mov_b32 m0, 35840
    s_add_u32 s40, s45, 35840
    buffer_load_dwordx4 v2, s[8:11], s40 offen sc1 lds
    buffer_load_dwordx4 v2, s[8:11], s40 offen offset:1024 sc1 lds
    s_mov_b32 m0, 47104
    s_add_u32 s40, s45, 47104
    buffer_load_dwordx4 v2, s[8:11], s40 offen sc1 lds
    buffer_load_dwordx4 v2, s[8:11], s40 offen offset:1024 sc1 lds
    s_mov_b32 m0, 56320
    s_add_u32 s40, s45, 56320
    buffer_load_dwordx4 v2, s[8:11], s40 offen sc1 lds
    buffer_load_dwordx4 v2, s[8:11], s40 offen offset:1024 sc1 lds
    buffer_load_dwordx4 v2, s[8:11], s40 offen offset:2048 sc1 lds
    s_mov_b32 s28, s22
    s_mov_b32 s29, s23
    s_mov_b32 s30, 2621440
    s_mov_b32 s31, 0x20000
    s_mul_i32 s41, s35, 81920
    s_mul_i32 s42, s36, 160
    s_add_u32 s41, s41, s42
    v_add_u32 v5, 128, v1
    v_mul_u32_u24 v6, 6554, v5
    v_lshrrev_b32 v6, 16, v6
    v_mul_u32_u24 v7, 10, v6
    v_sub_u32 v5, v5, v7
    v_lshlrev_b32 v5, 4, v5
    v_mul_u32_u24 v6, 1280, v6
    v_add_u32 v22, v5, v6
    s_mov_b32 m0, 133120
    s_nop 0
    buffer_load_dwordx4 v22, s[28:31], s41 offen lds
    v_add_u32 v5, 384, v1
    v_mul_u32_u24 v6, 6554, v5
    v_lshrrev_b32 v6, 16, v6
    v_mul_u32_u24 v7, 10, v6
    v_sub_u32 v5, v5, v7
    v_lshlrev_b32 v5, 4, v5
    v_mul_u32_u24 v6, 1280, v6
    v_add_u32 v26, v5, v6
    s_mov_b32 m0, 137216
    s_nop 0
    buffer_load_dwordx4 v26, s[28:31], s41 offen lds
    s_mul_i32 s42, s36, 320
    s_add_u32 s42, s42, 5345280
    s_mov_b32 m0, 141312
    s_nop 0
    buffer_load_dwordx4 v2, s[8:11], s42 offen lds
    s_waitcnt vmcnt(0) lgkmcnt(0)
    s_barrier
    s_mov_b32 m0, 90112
    s_add_u32 s40, s46, 28672
    buffer_load_dwordx4 v2, s[8:11], s40 offen sc1 lds
    buffer_load_dwordx4 v2, s[8:11], s40 offen offset:1024 sc1 lds
    s_waitcnt lgkmcnt(0)
    s_barrier
    s_mov_b32 m0, 65536
    s_add_u32 s40, s46, 36864
    buffer_load_dwordx4 v2, s[8:11], s40 offen sc1 lds
    buffer_load_dwordx4 v2, s[8:11], s40 offen offset:1024 sc1 lds
    s_mov_b32 m0, 4096
    s_add_u32 s40, s45, 65536
    buffer_load_dwordx4 v2, s[8:11], s40 offen sc1 lds
    buffer_load_dwordx4 v2, s[8:11], s40 offen offset:1024 sc1 lds
    buffer_load_dwordx4 v2, s[8:11], s40 offen offset:2048 sc1 lds
    s_waitcnt lgkmcnt(0)
    s_barrier
    s_mov_b32 m0, 73728
    s_add_u32 s40, s46, 45056
    buffer_load_dwordx4 v2, s[8:11], s40 offen sc1 lds
    buffer_load_dwordx4 v2, s[8:11], s40 offen offset:1024 sc1 lds
    s_mov_b32 m0, 15360
    s_add_u32 s40, s45, 76800
    buffer_load_dwordx4 v2, s[8:11], s40 offen sc1 lds
    buffer_load_dwordx4 v2, s[8:11], s40 offen offset:1024 sc1 lds
    s_waitcnt vmcnt(9) lgkmcnt(0)
    s_barrier
    s_mov_b32 m0, 81920
    s_add_u32 s40, s46, 53248
    buffer_load_dwordx4 v2, s[8:11], s40 offen sc1 lds
    buffer_load_dwordx4 v2, s[8:11], s40 offen offset:1024 sc1 lds
    s_mov_b32 m0, 26624
    s_add_u32 s40, s45, 88064
    buffer_load_dwordx4 v2, s[8:11], s40 offen sc1 lds
    buffer_load_dwordx4 v2, s[8:11], s40 offen offset:1024 sc1 lds
    s_waitcnt vmcnt(11) lgkmcnt(0)
    s_barrier
    s_mov_b32 m0, 90112
    s_add_u32 s40, s46, 61440
    buffer_load_dwordx4 v2, s[8:11], s40 offen sc1 lds
    buffer_load_dwordx4 v2, s[8:11], s40 offen offset:1024 sc1 lds
    s_mov_b32 m0, 35840
    s_add_u32 s40, s45, 97280
    buffer_load_dwordx4 v2, s[8:11], s40 offen sc1 lds
    buffer_load_dwordx4 v2, s[8:11], s40 offen offset:1024 sc1 lds
    buffer_load_dwordx4 v2, s[8:11], s40 offen offset:2048 sc1 lds
    v_min_u32 v58, 29, v1
    v_mul_u32_u24 v59, 35, v58
    v_lshrrev_b32 v59, 9, v59
    v_mul_u32_u24 v57, 120, v59
    v_mul_u32_u24 v59, 15, v59
    v_sub_u32 v58, v58, v59
    v_mul_u32_u24 v59, 86, v58
    v_lshrrev_b32 v59, 8, v59
    v_mad_u32_u24 v57, v59, 24, v57
    v_mul_u32_u24 v59, 3, v59
    v_sub_u32 v58, v58, v59
    s_mul_i32 s40, s34, 6
    s_add_u32 s41, s40, 5
    s_lshr_b32 s40, s40, 2
    s_lshr_b32 s41, s41, 2
    v_add_u32 v58, s40, v58
    v_min_u32 v58, s41, v58
    v_add_u32 v57, v57, v58
    v_lshlrev_b32 v57, 7, v57
    s_mov_b32 s47, 26501120
    buffer_load_dword v56, v57, s[8:11], s47 offen sc1
    s_waitcnt vmcnt(12) lgkmcnt(0)
    s_barrier
    s_mov_b32 m0, 65536
    s_add_u32 s40, s46, 69632
    buffer_load_dwordx4 v2, s[8:11], s40 offen sc1 lds
    buffer_load_dwordx4 v2, s[8:11], s40 offen offset:1024 sc1 lds
    s_waitcnt vmcnt(10) lgkmcnt(0)
    s_barrier
    s_mov_b32 m0, 73728
    s_add_u32 s40, s46, 77824
    buffer_load_dwordx4 v2, s[8:11], s40 offen sc1 lds
    buffer_load_dwordx4 v2, s[8:11], s40 offen offset:1024 sc1 lds
    s_waitcnt vmcnt(8) lgkmcnt(0)
    s_barrier
    s_waitcnt vmcnt(4)
    v_cmp_eq_u32 vcc, s96, v56
    s_nop 3
    s_cmp_eq_u64 vcc, -1
    s_cbranch_scc1 kp_sfok45
    s_mov_b32 s39, 32768
kp_p46:
    buffer_load_dword v56, v57, s[8:11], s47 offen sc1
    s_waitcnt vmcnt(0)
    v_cmp_eq_u32 vcc, s96, v56
    s_nop 3
    s_cmp_eq_u64 vcc, -1
    s_cbranch_scc1 kp_q47
    s_sub_u32 s39, s39, 1
    s_cmp_lg_u32 s39, 0
    s_cbranch_scc1 kp_p46
kp_q47:
kp_sfok45:
    s_mul_i32 s45, s34, 245760
    s_add_u32 s45, s45, 6176768
    s_mul_i32 s46, s33, 163840
    s_add_u32 s46, s46, 17440768
    s_mov_b32 m0, 100352
    s_add_u32 s40, s45, 6144
    buffer_load_dwordx4 v2, s[8:11], s40 offen sc1 lds
    buffer_load_dwordx4 v2, s[8:11], s40 offen offset:1024 sc1 lds
    buffer_load_dwordx4 v2, s[8:11], s40 offen offset:2048 sc1 lds
    s_waitcnt vmcnt(5) lgkmcnt(0)
    s_barrier
    s_mov_b32 m0, 112640
    s_add_u32 s40, s45, 18432
    buffer_load_dwordx4 v2, s[8:11], s40 offen sc1 lds
    buffer_load_dwordx4 v2, s[8:11], s40 offen offset:1024 sc1 lds
    buffer_load_dwordx4 v2, s[8:11], s40 offen offset:2048 sc1 lds
    s_waitcnt vmcnt(6) lgkmcnt(0)
    s_barrier
    s_mov_b32 m0, 124928
    s_add_u32 s40, s45, 30720
    buffer_load_dwordx4 v2, s[8:11], s40 offen sc1 lds
    buffer_load_dwordx4 v2, s[8:11], s40 offen offset:1024 sc1 lds
    buffer_load_dwordx4 v2, s[8:11], s40 offen offset:2048 sc1 lds
    s_waitcnt vmcnt(6) lgkmcnt(0)
    s_barrier
    s_mov_b32 m0, 141312
    s_add_u32 s40, s45, 47104
    buffer_load_dwordx4 v2, s[8:11], s40 offen sc1 lds
    buffer_load_dwordx4 v2, s[8:11], s40 offen offset:1024 sc1 lds
    s_mov_b32 m0, 24576
    s_add_u32 s40, s46, 24576
    buffer_load_dwordx4 v2, s[8:11], s40 offen sc1 lds
    buffer_load_dwordx4 v2, s[8:11], s40 offen offset:1024 sc1 lds
    buffer_load_dwordx4 v2, s[8:11], s40 offen offset:2048 sc1 lds
    s_waitcnt vmcnt(8) lgkmcnt(0)
    s_barrier
    s_mov_b32 m0, 104448
    s_add_u32 s40, s45, 59392
    buffer_load_dwordx4 v2, s[8:11], s40 offen sc1 lds
    buffer_load_dwordx4 v2, s[8:11], s40 offen offset:1024 sc1 lds
    s_mov_b32 m0, 0
    s_add_u32 s40, s46, 32768
    buffer_load_dwordx4 v2, s[8:11], s40 offen sc1 lds
    buffer_load_dwordx4 v2, s[8:11], s40 offen offset:1024 sc1 lds
    buffer_load_dwordx4 v2, s[8:11], s40 offen offset:2048 sc1 lds
    s_waitcnt vmcnt(10) lgkmcnt(0)
    s_barrier
    s_mov_b32 m0, 116736
    s_add_u32 s40, s45, 71680
    buffer_load_dwordx4 v2, s[8:11], s40 offen sc1 lds
    buffer_load_dwordx4 v2, s[8:11], s40 offen offset:1024 sc1 lds
    s_mov_b32 m0, 8192
    s_add_u32 s40, s46, 40960
    buffer_load_dwordx4 v2, s[8:11], s40 offen sc1 lds
    buffer_load_dwordx4 v2, s[8:11], s40 offen offset:1024 sc1 lds
    buffer_load_dwordx4 v2, s[8:11], s40 offen offset:2048 sc1 lds
    s_waitcnt vmcnt(10) lgkmcnt(0)
    s_barrier
    s_mov_b32 m0, 129024
    s_add_u32 s40, s45, 83968
    buffer_load_dwordx4 v2, s[8:11], s40 offen sc1 lds
    buffer_load_dwordx4 v2, s[8:11], s40 offen offset:1024 sc1 lds
    s_mov_b32 m0, 16384
    s_add_u32 s40, s46, 49152
    buffer_load_dwordx4 v2, s[8:11], s40 offen sc1 lds
    buffer_load_dwordx4 v2, s[8:11], s40 offen offset:1024 sc1 lds
    buffer_load_dwordx4 v2, s[8:11], s40 offen offset:2048 sc1 lds
    s_waitcnt vmcnt(10) lgkmcnt(0)
    s_barrier
    s_mov_b32 m0, 141312
    s_add_u32 s40, s45, 96256
    buffer_load_dwordx4 v2, s[8:11], s40 offen sc1 lds
    buffer_load_dwordx4 v2, s[8:11], s40 offen offset:1024 sc1 lds
    s_mov_b32 m0, 24576
    s_add_u32 s40, s46, 57344
    buffer_load_dwordx4 v2, s[8:11], s40 offen sc1 lds
    buffer_load_dwordx4 v2, s[8:11], s40 offen offset:1024 sc1 lds
    buffer_load_dwordx4 v2, s[8:11], s40 offen offset:2048 sc1 lds
    s_lshl_b32 s42, s33, 3
    s_add_u32 s42, s42, 4
    s_lshl_b32 s42, s42, 10
    s_add_u32 s42, s42, 20062208
    v_and_b32 v5, 15, v1
    v_lshl_add_u32 v5, v5, 6, v3
    buffer_load_dwordx4 v[16:19], v5, s[8:11], s42 offen offset:0 sc1
    buffer_load_dwordx4 v[20:23], v5, s[8:11], s42 offen offset:1024 sc1
    s_waitcnt vmcnt(12) lgkmcnt(0)
    s_barrier
    s_mov_b32 m0, 104448
    s_add_u32 s40, s45, 108544
    buffer_load_dwordx4 v2, s[8:11], s40 offen sc1 lds
    buffer_load_dwordx4 v2, s[8:11], s40 offen offset:1024 sc1 lds
    s_mov_b32 m0, 0
    s_add_u32 s40, s46, 65536
    buffer_load_dwordx4 v2, s[8:11], s40 offen sc1 lds
    buffer_load_dwordx4 v2, s[8:11], s40 offen offset:1024 sc1 lds
    buffer_load_dwordx4 v2, s[8:11], s40 offen offset:2048 sc1 lds
    s_waitcnt vmcnt(12) lgkmcnt(0)
    s_barrier
    s_mov_b32 m0, 116736
    s_add_u32 s40, s45, 120832
    buffer_load_dwordx4 v2, s[8:11], s40 offen sc1 lds
    buffer_load_dwordx4 v2, s[8:11], s40 offen offset:1024 sc1 lds
    s_mov_b32 m0, 8192
    s_add_u32 s40, s46, 73728
    buffer_load_dwordx4 v2, s[8:11], s40 offen sc1 lds
    buffer_load_dwordx4 v2, s[8:11], s40 offen offset:1024 sc1 lds
    buffer_load_dwordx4 v2, s[8:11], s40 offen offset:2048 sc1 lds
    s_waitcnt vmcnt(12) lgkmcnt(0)
    s_barrier
    s_mov_b32 m0, 129024
    s_add_u32 s40, s45, 133120
    buffer_load_dwordx4 v2, s[8:11], s40 offen sc1 lds
    buffer_load_dwordx4 v2, s[8:11], s40 offen offset:1024 sc1 lds
    s_mov_b32 m0, 16384
    s_add_u32 s40, s46, 81920
    buffer_load_dwordx4 v2, s[8:11], s40 offen sc1 lds
    buffer_load_dwordx4 v2, s[8:11], s40 offen offset:1024 sc1 lds
    buffer_load_dwordx4 v2, s[8:11], s40 offen offset:2048 sc1 lds
    s_waitcnt vmcnt(10) lgkmcnt(0)
    s_barrier
    s_mov_b32 m0, 141312
    s_add_u32 s40, s45, 145408
    buffer_load_dwordx4 v2, s[8:11], s40 offen sc1 lds
    buffer_load_dwordx4 v2, s[8:11], s40 offen offset:1024 sc1 lds
    s_mov_b32 m0, 24576
    s_add_u32 s40, s46, 90112
    buffer_load_dwordx4 v2, s[8:11], s40 offen sc1 lds
    buffer_load_dwordx4 v2, s[8:11], s40 offen offset:1024 sc1 lds
    buffer_load_dwordx4 v2, s[8:11], s40 offen offset:2048 sc1 lds
    s_waitcnt vmcnt(10) lgkmcnt(0)
    s_barrier
    s_mov_b32 m0, 104448
    s_add_u32 s40, s45, 157696
    buffer_load_dwordx4 v2, s[8:11], s40 offen sc1 lds
    buffer_load_dwordx4 v2, s[8:11], s40 offen offset:1024 sc1 lds
    s_mov_b32 m0, 0
    s_add_u32 s40, s46, 98304
    buffer_load_dwordx4 v2, s[8:11], s40 offen sc1 lds
    buffer_load_dwordx4 v2, s[8:11], s40 offen offset:1024 sc1 lds
    buffer_load_dwordx4 v2, s[8:11], s40 offen offset:2048 sc1 lds
    s_waitcnt vmcnt(10) lgkmcnt(0)
    s_barrier
    s_mov_b32 m0, 116736
    s_add_u32 s40, s45, 169984
    buffer_load_dwordx4 v2, s[8:11], s40 offen sc1 lds
    buffer_load_dwordx4 v2, s[8:11], s40 offen offset:1024 sc1 lds
    s_mov_b32 m0, 8192
    s_add_u32 s40, s46, 106496
    buffer_load_dwordx4 v2, s[8:11], s40 offen sc1 lds
    buffer_load_dwordx4 v2, s[8:11], s40 offen offset:1024 sc1 lds
    buffer_load_dwordx4 v2, s[8:11], s40 offen offset:2048 sc1 lds
    v_min_u32 v58, 23, v1
    v_lshrrev_b32 v59, 1, v58
    v_mul_u32_u24 v57, 10, v59
    v_and_b32 v58, 1, v58
    s_mul_i32 s40, s36, 5
    s_add_u32 s41, s40, 4
    s_lshr_b32 s40, s40, 2
    s_lshr_b32 s41, s41, 2
    v_add_u32 v58, s40, v58
    v_min_u32 v58, s41, v58
    v_add_u32 v57, v57, v58
    v_lshlrev_b32 v57, 7, v57
    s_mov_b32 s47, 26533888
    buffer_load_dword v56, v57, s[8:11], s47 offen sc1
    s_waitcnt vmcnt(11) lgkmcnt(0)
    s_barrier
    s_mov_b32 m0, 129024
    s_add_u32 s40, s45, 182272
    buffer_load_dwordx4 v2, s[8:11], s40 offen sc1 lds
    buffer_load_dwordx4 v2, s[8:11], s40 offen offset:1024 sc1 lds
    s_mov_b32 m0, 16384
    s_add_u32 s40, s46, 114688
    buffer_load_dwordx4 v2, s[8:11], s40 offen sc1 lds
    buffer_load_dwordx4 v2, s[8:11], s40 offen offset:1024 sc1 lds
    buffer_load_dwordx4 v2, s[8:11], s40 offen offset:2048 sc1 lds
    s_waitcnt vmcnt(11) lgkmcnt(0)
    s_barrier
    s_mov_b32 m0, 141312
    s_add_u32 s40, s45, 194560
    buffer_load_dwordx4 v2, s[8:11], s40 offen sc1 lds
    buffer_load_dwordx4 v2, s[8:11], s40 offen offset:1024 sc1 lds
    s_mov_b32 m0, 24576
    s_add_u32 s40, s46, 122880
    buffer_load_dwordx4 v2, s[8:11], s40 offen sc1 lds
    buffer_load_dwordx4 v2, s[8:11], s40 offen offset:1024 sc1 lds
    buffer_load_dwordx4 v2, s[8:11], s40 offen offset:2048 sc1 lds
    s_waitcnt vmcnt(11) lgkmcnt(0)
    s_barrier
    s_mov_b32 m0, 104448
    s_add_u32 s40, s45, 206848
    buffer_load_dwordx4 v2, s[8:11], s40 offen sc1 lds
    buffer_load_dwordx4 v2, s[8:11], s40 offen offset:1024 sc1 lds
    s_mov_b32 m0, 0
    s_add_u32 s40, s46, 131072
    buffer_load_dwordx4 v2, s[8:11], s40 offen sc1 lds
    buffer_load_dwordx4 v2, s[8:11], s40 offen offset:1024 sc1 lds
    buffer_load_dwordx4 v2, s[8:11], s40 offen offset:2048 sc1 lds
    s_waitcnt vmcnt(10) lgkmcnt(0)
    s_barrier
    s_mov_b32 m0, 116736
    s_add_u32 s40, s45, 219136
    buffer_load_dwordx4 v2, s[8:11], s40 offen sc1 lds
    buffer_load_dwordx4 v2, s[8:11], s40 offen offset:1024 sc1 lds
    s_mov_b32 m0, 8192
    s_add_u32 s40, s46, 139264
    buffer_load_dwordx4 v2, s[8:11], s40 offen sc1 lds
    buffer_load_dwordx4 v2, s[8:11], s40 offen offset:1024 sc1 lds
    buffer_load_dwordx4 v2, s[8:11], s40 offen offset:2048 sc1 lds
    s_waitcnt vmcnt(10) lgkmcnt(0)
    s_barrier
    s_mov_b32 m0, 129024
    s_add_u32 s40, s45, 231424
    buffer_load_dwordx4 v2, s[8:11], s40 offen sc1 lds
    buffer_load_dwordx4 v2, s[8:11], s40 offen offset:1024 sc1 lds
    s_mov_b32 m0, 16384
    s_add_u32 s40, s46, 147456
    buffer_load_dwordx4 v2, s[8:11], s40 offen sc1 lds
    buffer_load_dwordx4 v2, s[8:11], s40 offen offset:1024 sc1 lds
    buffer_load_dwordx4 v2, s[8:11], s40 offen offset:2048 sc1 lds
    s_waitcnt vmcnt(10) lgkmcnt(0)
    s_barrier
    s_mov_b32 m0, 141312
    s_add_u32 s40, s45, 243712
    buffer_load_dwordx4 v2, s[8:11], s40 offen sc1 lds
    buffer_load_dwordx4 v2, s[8:11], s40 offen offset:1024 sc1 lds
    s_mov_b32 m0, 24576
    s_add_u32 s40, s46, 155648
    buffer_load_dwordx4 v2, s[8:11], s40 offen sc1 lds
    buffer_load_dwordx4 v2, s[8:11], s40 offen offset:1024 sc1 lds
    buffer_load_dwordx4 v2, s[8:11], s40 offen offset:2048 sc1 lds
    s_waitcnt vmcnt(10) lgkmcnt(0)
    s_barrier
    v_add_f32 v46, v16, v18
    v_mov_b32 v47, v46
    s_nop 1
    v_permlane32_swap_b32 v46, v47
    v_add_f32 v46, v46, v47
    v_mov_b32 v47, v46
    s_nop 1
    v_permlane16_swap_b32 v46, v47
    v_add_f32 v46, v46, v47
    v_mul_f32 v46, 0x3e000000, v46
    v_sub_f32 v47, v16, v46
    v_sub_f32 v48, v18, v46
    v_mul_f32 v47, v47, v47
    v_fmac_f32 v47, v48, v48
    v_add_f32 v48, v17, v19
    v_fmac_f32 v48, 0x42a00000, v47
    v_mov_b32 v47, v48
    s_nop 1
    v_permlane32_swap_b32 v48, v47
    v_add_f32 v48, v48, v47
    v_mov_b32 v47, v48
    s_nop 1
    v_permlane16_swap_b32 v48, v47
    v_add_f32 v48, v48, v47
    v_mov_b32 v47, 0x3727c5ac
    v_fmac_f32 v47, 0x3acccccd, v48
    v_rsq_f32 v50, v47
    s_nop 0
    v_mul_f32 v51, v46, v50
    v_sub_f32 v51, 0, v51
    v_and_b32 v47, 15, v1
    v_lshlrev_b32 v47, 3, v47
    v_add_u32 v47, 145408, v47
    s_mov_b64 exec, 0xffff
    ds_write_b64 v47, v[50:51]
    s_mov_b64 exec, -1
    v_cmp_eq_u32 vcc, s96, v56
    s_nop 3
    s_cmp_eq_u64 vcc, -1
    s_cbranch_scc1 kp_sfok48
    s_mov_b32 s39, 32768
kp_p49:
    buffer_load_dword v56, v57, s[8:11], s47 offen sc1
    s_waitcnt vmcnt(0)
    v_cmp_eq_u32 vcc, s96, v56
    s_nop 3
    s_cmp_eq_u64 vcc, -1
    s_cbranch_scc1 kp_q50
    s_sub_u32 s39, s39, 1
    s_cmp_lg_u32 s39, 0
    s_cbranch_scc1 kp_p49
kp_q50:
kp_sfok48:
    s_mul_i32 s45, s36, 245760
    s_add_u32 s45, s45, 10108928
    s_mul_i32 s46, s35, 196608
    s_add_u32 s46, s46, 20193280
    s_mov_b32 m0, 38912
    s_add_u32 s40, s45, 6144
    buffer_load_dwordx4 v2, s[8:11], s40 offen sc1 lds
    buffer_load_dwordx4 v2, s[8:11], s40 offen offset:1024 sc1 lds
    s_waitcnt vmcnt(7) lgkmcnt(0)
    s_barrier
    v_add_f32 v46, v20, v22
    v_mov_b32 v47, v46
    s_nop 1
    v_permlane32_swap_b32 v46, v47
    v_add_f32 v46, v46, v47
    v_mov_b32 v47, v46
    s_nop 1
    v_permlane16_swap_b32 v46, v47
    v_add_f32 v46, v46, v47
    v_mul_f32 v46, 0x3e000000, v46
    v_sub_f32 v47, v20, v46
    v_sub_f32 v48, v22, v46
    v_mul_f32 v47, v47, v47
    v_fmac_f32 v47, v48, v48
    v_add_f32 v48, v21, v23
    v_fmac_f32 v48, 0x42a00000, v47
    v_mov_b32 v47, v48
    s_nop 1
    v_permlane32_swap_b32 v48, v47
    v_add_f32 v48, v48, v47
    v_mov_b32 v47, v48
    s_nop 1
    v_permlane16_swap_b32 v48, v47
    v_add_f32 v48, v48, v47
    v_mov_b32 v47, 0x3727c5ac
    v_fmac_f32 v47, 0x3acccccd, v48
    v_rsq_f32 v50, v47
    s_nop 0
    v_mul_f32 v51, v46, v50
    v_sub_f32 v51, 0, v51
    v_and_b32 v47, 15, v1
    v_lshlrev_b32 v47, 3, v47
    v_add_u32 v47, 145536, v47
    s_mov_b64 exec, 0xffff
    ds_write_b64 v47, v[50:51]
    s_mov_b64 exec, -1
    s_mov_b32 m0, 48128
    s_add_u32 s40, s45, 15360
    buffer_load_dwordx4 v2, s[8:11], s40 offen sc1 lds
    buffer_load_dwordx4 v2, s[8:11], s40 offen offset:1024 sc1 lds
    buffer_load_dwordx4 v2, s[8:11], s40 offen offset:2048 sc1 lds
    s_waitcnt vmcnt(5) lgkmcnt(0)
    s_barrier
    s_mov_b32 m0, 57344
    s_add_u32 s40, s45, 24576
    buffer_load_dwordx4 v2, s[8:11], s40 offen sc1 lds
    buffer_load_dwordx4 v2, s[8:11], s40 offen offset:1024 sc1 lds
    buffer_load_dwordx4 v2, s[8:11], s40 offen offset:2048 sc1 lds
    s_mov_b32 m0, 68608
    s_add_u32 s40, s45, 35840
    buffer_load_dwordx4 v2, s[8:11], s40 offen sc1 lds
    buffer_load_dwordx4 v2, s[8:11], s40 offen offset:1024 sc1 lds
    s_mov_b32 m0, 79872
    s_add_u32 s40, s45, 47104
    buffer_load_dwordx4 v2, s[8:11], s40 offen sc1 lds
    buffer_load_dwordx4 v2, s[8:11], s40 offen offset:1024 sc1 lds
    s_mov_b32 m0, 89088
    s_add_u32 s40, s45, 56320
    buffer_load_dwordx4 v2, s[8:11], s40 offen sc1 lds
    buffer_load_dwordx4 v2, s[8:11], s40 offen offset:1024 sc1 lds
    buffer_load_dwordx4 v2, s[8:11], s40 offen offset:2048 sc1 lds
    s_waitcnt vmcnt(13) lgkmcnt(0)
    s_barrier
    s_mov_b32 m0, 28672
    s_add_u32 s40, s46, 28672
    buffer_load_dwordx4 v2, s[8:11], s40 offen sc1 lds
    buffer_load_dwordx4 v2, s[8:11], s40 offen offset:1024 sc1 lds
    s_waitcnt vmcnt(12) lgkmcnt(0)
    s_barrier
    s_mov_b32 m0, 4096
    s_add_u32 s40, s46, 36864
    buffer_load_dwordx4 v2, s[8:11], s40 offen sc1 lds
    buffer_load_dwordx4 v2, s[8:11], s40 offen offset:1024 sc1 lds
    s_mov_b32 m0, 36864
    s_add_u32 s40, s45, 65536
    buffer_load_dwordx4 v2, s[8:11], s40 offen sc1 lds
    buffer_load_dwordx4 v2, s[8:11], s40 offen offset:1024 sc1 lds
    buffer_load_dwordx4 v2, s[8:11], s40 offen offset:2048 sc1 lds
    s_waitcnt vmcnt(14) lgkmcnt(0)
    s_barrier
    s_mov_b32 m0, 12288
    s_add_u32 s40, s46, 45056
    buffer_load_dwordx4 v2, s[8:11], s40 offen sc1 lds
    buffer_load_dwordx4 v2, s[8:11], s40 offen offset:1024 sc1 lds
    s_mov_b32 m0, 48128
    s_add_u32 s40, s45, 76800
    buffer_load_dwordx4 v2, s[8:11], s40 offen sc1 lds
    buffer_load_dwordx4 v2, s[8:11], s40 offen offset:1024 sc1 lds
    s_waitcnt vmcnt(9) lgkmcnt(0)
    s_barrier
    s_mov_b32 m0, 20480
    s_add_u32 s40, s46, 53248
    buffer_load_dwordx4 v2, s[8:11], s40 offen sc1 lds
    buffer_load_dwordx4 v2, s[8:11], s40 offen offset:1024 sc1 lds
    s_mov_b32 m0, 59392
    s_add_u32 s40, s45, 88064
    buffer_load_dwordx4 v2, s[8:11], s40 offen sc1 lds
    buffer_load_dwordx4 v2, s[8:11], s40 offen offset:1024 sc1 lds
    s_waitcnt vmcnt(11) lgkmcnt(0)
    s_barrier
    s_mov_b32 m0, 28672
    s_add_u32 s40, s46, 61440
    buffer_load_dwordx4 v2, s[8:11], s40 offen sc1 lds
    buffer_load_dwordx4 v2, s[8:11], s40 offen offset:1024 sc1 lds
    s_mov_b32 m0, 68608
    s_add_u32 s40, s45, 97280
    buffer_load_dwordx4 v2, s[8:11], s40 offen sc1 lds
    buffer_load_dwordx4 v2, s[8:11], s40 offen offset:1024 sc1 lds
    buffer_load_dwordx4 v2, s[8:11], s40 offen offset:2048 sc1 lds
    s_waitcnt vmcnt(11) lgkmcnt(0)
    s_barrier
    s_mov_b32 m0, 4096
    s_add_u32 s40, s46, 69632
    buffer_load_dwordx4 v2, s[8:11], s40 offen sc1 lds
    buffer_load_dwordx4 v2, s[8:11], s40 offen offset:1024 sc1 lds
    s_mov_b32 m0, 77824
    s_add_u32 s40, s45, 106496
    buffer_load_dwordx4 v2, s[8:11], s40 offen sc1 lds
    buffer_load_dwordx4 v2, s[8:11], s40 offen offset:1024 sc1 lds
    buffer_load_dwordx4 v2, s[8:11], s40 offen offset:2048 sc1 lds
    s_waitcnt vmcnt(12) lgkmcnt(0)
    s_barrier
    s_mov_b32 m0, 12288
    s_add_u32 s40, s46, 77824
    buffer_load_dwordx4 v2, s[8:11], s40 offen sc1 lds
    buffer_load_dwordx4 v2, s[8:11], s40 offen offset:1024 sc1 lds
    s_mov_b32 m0, 89088
    s_add_u32 s40, s45, 117760
    buffer_load_dwordx4 v2, s[8:11], s40 offen sc1 lds
    buffer_load_dwordx4 v2, s[8:11], s40 offen offset:1024 sc1 lds
    s_waitcnt vmcnt(12) lgkmcnt(0)
    s_barrier
    s_mov_b32 m0, 20480
    s_add_u32 s40, s46, 86016
    buffer_load_dwordx4 v2, s[8:11], s40 offen sc1 lds
    buffer_load_dwordx4 v2, s[8:11], s40 offen offset:1024 sc1 lds
    s_mov_b32 m0, 38912
    s_add_u32 s40, s45, 129024
    buffer_load_dwordx4 v2, s[8:11], s40 offen sc1 lds
    buffer_load_dwordx4 v2, s[8:11], s40 offen offset:1024 sc1 lds
    s_waitcnt vmcnt(11) lgkmcnt(0)
    s_barrier
    s_mov_b32 m0, 28672
    s_add_u32 s40, s46, 94208
    buffer_load_dwordx4 v2, s[8:11], s40 offen sc1 lds
    buffer_load_dwordx4 v2, s[8:11], s40 offen offset:1024 sc1 lds
    s_mov_b32 m0, 48128
    s_add_u32 s40, s45, 138240
    buffer_load_dwordx4 v2, s[8:11], s40 offen sc1 lds
    buffer_load_dwordx4 v2, s[8:11], s40 offen offset:1024 sc1 lds
    buffer_load_dwordx4 v2, s[8:11], s40 offen offset:2048 sc1 lds
    s_waitcnt vmcnt(11) lgkmcnt(0)
    s_barrier
    s_mov_b32 m0, 4096
    s_add_u32 s40, s46, 102400
    buffer_load_dwordx4 v2, s[8:11], s40 offen sc1 lds
    buffer_load_dwordx4 v2, s[8:11], s40 offen offset:1024 sc1 lds
    s_mov_b32 m0, 57344
    s_add_u32 s40, s45, 147456
    buffer_load_dwordx4 v2, s[8:11], s40 offen sc1 lds
    buffer_load_dwordx4 v2, s[8:11], s40 offen offset:1024 sc1 lds
    buffer_load_dwordx4 v2, s[8:11], s40 offen offset:2048 sc1 lds
    s_waitcnt vmcnt(12) lgkmcnt(0)
    s_barrier
    s_mov_b32 m0, 12288
    s_add_u32 s40, s46, 110592
    buffer_load_dwordx4 v2, s[8:11], s40 offen sc1 lds
    buffer_load_dwordx4 v2, s[8:11], s40 offen offset:1024 sc1 lds
    s_mov_b32 m0, 68608
    s_add_u32 s40, s45, 158720
    buffer_load_dwordx4 v2, s[8:11], s40 offen sc1 lds
    buffer_load_dwordx4 v2, s[8:11], s40 offen offset:1024 sc1 lds
    s_waitcnt vmcnt(12) lgkmcnt(0)
    s_barrier
    s_mov_b32 m0, 20480
    s_add_u32 s40, s46, 118784
    buffer_load_dwordx4 v2, s[8:11], s40 offen sc1 lds
    buffer_load_dwordx4 v2, s[8:11], s40 offen offset:1024 sc1 lds
    s_mov_b32 m0, 79872
    s_add_u32 s40, s45, 169984
    buffer_load_dwordx4 v2, s[8:11], s40 offen sc1 lds
    buffer_load_dwordx4 v2, s[8:11], s40 offen offset:1024 sc1 lds
    s_waitcnt vmcnt(11) lgkmcnt(0)
    s_barrier
    s_mov_b32 m0, 28672
    s_add_u32 s40, s46, 126976
    buffer_load_dwordx4 v2, s[8:11], s40 offen sc1 lds
    buffer_load_dwordx4 v2, s[8:11], s40 offen offset:1024 sc1 lds
    s_mov_b32 m0, 89088
    s_add_u32 s40, s45, 179200
    buffer_load_dwordx4 v2, s[8:11], s40 offen sc1 lds
    buffer_load_dwordx4 v2, s[8:11], s40 offen offset:1024 sc1 lds
    buffer_load_dwordx4 v2, s[8:11], s40 offen offset:2048 sc1 lds
    s_waitcnt vmcnt(11) lgkmcnt(0)
    s_barrier
    s_mov_b32 m0, 4096
    s_add_u32 s40, s46, 135168
    buffer_load_dwordx4 v2, s[8:11], s40 offen sc1 lds
    buffer_load_dwordx4 v2, s[8:11], s40 offen offset:1024 sc1 lds
    s_mov_b32 m0, 36864
    s_add_u32 s40, s45, 188416
    buffer_load_dwordx4 v2, s[8:11], s40 offen sc1 lds
    buffer_load_dwordx4 v2, s[8:11], s40 offen offset:1024 sc1 lds
    buffer_load_dwordx4 v2, s[8:11], s40 offen offset:2048 sc1 lds
    s_waitcnt vmcnt(12) lgkmcnt(0)
    s_barrier
    s_mov_b32 m0, 12288
    s_add_u32 s40, s46, 143360
    buffer_load_dwordx4 v2, s[8:11], s40 offen sc1 lds
    buffer_load_dwordx4 v2, s[8:11], s40 offen offset:1024 sc1 lds
    s_mov_b32 m0, 48128
    s_add_u32 s40, s45, 199680
    buffer_load_dwordx4 v2, s[8:11], s40 offen sc1 lds
    buffer_load_dwordx4 v2, s[8:11], s40 offen offset:1024 sc1 lds
    s_waitcnt vmcnt(12) lgkmcnt(0)
    s_barrier
    s_mov_b32 m0, 20480
    s_add_u32 s40, s46, 151552
    buffer_load_dwordx4 v2, s[8:11], s40 offen sc1 lds
    buffer_load_dwordx4 v2, s[8:11], s40 offen offset:1024 sc1 lds
    s_mov_b32 m0, 59392
    s_add_u32 s40, s45, 210944
    buffer_load_dwordx4 v2, s[8:11], s40 offen sc1 lds
    buffer_load_dwordx4 v2, s[8:11], s40 offen offset:1024 sc1 lds
    s_waitcnt vmcnt(11) lgkmcnt(0)
    s_barrier
    s_mov_b32 m0, 28672
    s_add_u32 s40, s46, 159744
    buffer_load_dwordx4 v2, s[8:11], s40 offen sc1 lds
    buffer_load_dwordx4 v2, s[8:11], s40 offen offset:1024 sc1 lds
    s_mov_b32 m0, 68608
    s_add_u32 s40, s45, 220160
    buffer_load_dwordx4 v2, s[8:11], s40 offen sc1 lds
    buffer_load_dwordx4 v2, s[8:11], s40 offen offset:1024 sc1 lds
    buffer_load_dwordx4 v2, s[8:11], s40 offen offset:2048 sc1 lds
    s_waitcnt vmcnt(11) lgkmcnt(0)
    s_barrier
    s_mov_b32 m0, 4096
    s_add_u32 s40, s46, 167936
    buffer_load_dwordx4 v2, s[8:11], s40 offen sc1 lds
    buffer_load_dwordx4 v2, s[8:11], s40 offen offset:1024 sc1 lds
    s_mov_b32 m0, 77824
    s_add_u32 s40, s45, 229376
    buffer_load_dwordx4 v2, s[8:11], s40 offen sc1 lds
    buffer_load_dwordx4 v2, s[8:11], s40 offen offset:1024 sc1 lds
    buffer_load_dwordx4 v2, s[8:11], s40 offen offset:2048 sc1 lds
    s_waitcnt vmcnt(12) lgkmcnt(0)
    s_barrier
    s_mov_b32 m0, 12288
    s_add_u32 s40, s46, 176128
    buffer_load_dwordx4 v2, s[8:11], s40 offen sc1 lds
    buffer_load_dwordx4 v2, s[8:11], s40 offen offset:1024 sc1 lds
    s_mov_b32 m0, 89088
    s_add_u32 s40, s45, 240640
    buffer_load_dwordx4 v2, s[8:11], s40 offen sc1 lds
    buffer_load_dwordx4 v2, s[8:11], s40 offen offset:1024 sc1 lds
    s_waitcnt vmcnt(12) lgkmcnt(0)
    s_barrier
    s_mov_b32 m0, 20480
    s_add_u32 s40, s46, 184320
    buffer_load_dwordx4 v2, s[8:11], s40 offen sc1 lds
    buffer_load_dwordx4 v2, s[8:11], s40 offen offset:1024 sc1 lds
    s_waitcnt vmcnt(9) lgkmcnt(0)
    s_barrier
    s_mov_b32 m0, 28672
    s_add_u32 s40, s46, 192512
    buffer_load_dwordx4 v2, s[8:11], s40 offen sc1 lds
    buffer_load_dwordx4 v2, s[8:11], s40 offen offset:1024 sc1 lds
    s_waitcnt vmcnt(6) lgkmcnt(0)
    s_barrier
    s_waitcnt vmcnt(2) lgkmcnt(0)
    s_barrier
    s_waitcnt vmcnt(0) lgkmcnt(0)
    s_barrier
    s_endpgm
kp_L3:
    s_mul_i32 s45, s34, 163840
    s_add_u32 s45, s45, 2641920
    s_lshl_b32 s46, s33, 13
    s_min_u32 s40, s2, 239
    s_cmp_ge_u32 s40, 120
    s_cselect_b32 s44, 1, 0
    s_cselect_b32 s12, s16, s18
    s_cselect_b32 s13, s17, s19
    s_mov_b32 s14, 1966080
    s_mov_b32 s15, 0x20000
    s_mul_i32 s41, s44, 120
    s_sub_u32 s40, s40, s41
    s_mul_i32 s41, s40, 43
    s_lshr_b32 s41, s41, 10
    s_mul_i32 s42, s41, 24
    s_sub_u32 s42, s40, s42
    s_mul_i32 s48, s41, 393216
    s_lshl_b32 s43, s42, 7
    s_add_u32 s48, s48, s43
    s_cmp_lt_u32 s2, 240
    s_cselect_b32 s48, s48, 0x40000000
    v_and_b32 v5, 1, v1
    v_mul_u32_u24 v5, 2560, v5
    v_sub_u32 v9, 5120, v5
    v_add_u32 v9, v9, v3
    s_lshl_b32 s49, s41, 9
    s_add_u32 s49, s49, 5345280
    s_lshl_b32 s56, s42, 2
    s_mov_b32 s57, s41
    s_mov_b32 s58, s44
    s_mov_b32 s41, s57
    s_mov_b32 s44, s58
    s_add_u32 s42, s56, 0
    s_mul_i32 s40, s42, 43
    s_lshr_b32 s40, s40, 8
    s_mul_i32 s43, s40, 6
    s_sub_u32 s43, s42, s43
    s_mul_i32 s40, s40, 20
    s_lshl_b32 s42, s41, 2
    s_add_u32 s40, s40, s42
    s_mul_i32 s40, s40, 12
    s_add_u32 s40, s40, s43
    s_mul_i32 s43, s44, 6
    s_add_u32 s40, s40, s43
    s_lshl_b32 s40, s40, 10
    s_add_u32 s52, s40, 6176768
    s_add_u32 s42, s56, 1
    s_mul_i32 s40, s42, 43
    s_lshr_b32 s40, s40, 8
    s_mul_i32 s43, s40, 6
    s_sub_u32 s43, s42, s43
    s_mul_i32 s40, s40, 20
    s_lshl_b32 s42, s41, 2
    s_add_u32 s40, s40, s42
    s_mul_i32 s40, s40, 12
    s_add_u32 s40, s40, s43
    s_mul_i32 s43, s44, 6
    s_add_u32 s40, s40, s43
    s_lshl_b32 s40, s40, 10
    s_add_u32 s53, s40, 6176768
    s_add_u32 s42, s56, 2
    s_mul_i32 s40, s42, 43
    s_lshr_b32 s40, s40, 8
    s_mul_i32 s43, s40, 6
    s_sub_u32 s43, s42, s43
    s_mul_i32 s40, s40, 20
    s_lshl_b32 s42, s41, 2
    s_add_u32 s40, s40, s42
    s_mul_i32 s40, s40, 12
    s_add_u32 s40, s40, s43
    s_mul_i32 s43, s44, 6
    s_add_u32 s40, s40, s43
    s_lshl_b32 s40, s40, 10
    s_add_u32 s54, s40, 6176768
    s_add_u32 s42, s56, 3
    s_mul_i32 s40, s42, 43
    s_lshr_b32 s40, s40, 8
    s_mul_i32 s43, s40, 6
    s_sub_u32 s43, s42, s43
    s_mul_i32 s40, s40, 20
    s_lshl_b32 s42, s41, 2
    s_add_u32 s40, s40, s42
    s_mul_i32 s40, s40, 12
    s_add_u32 s40, s40, s43
    s_mul_i32 s43, s44, 6
    s_add_u32 s40, s40, s43
    s_lshl_b32 s40, s40, 10
    s_add_u32 s55, s40, 6176768
    s_mul_i32 s40, s41, 24576
    s_mul_i32 s43, s44, 6144
    s_add_u32 s40, s40, s43
    s_lshl_b32 s43, s56, 6
    s_add_u32 s40, s40, s43
    s_add_u32 s50, s40, 12075008
    v_bfe_u32 v6, v1, 4, 1
    v_bfe_u32 v5, v1, 5, 1
    v_lshl_or_b32 v5, v5, 1, v6
    v_lshlrev_b32 v5, 1, v5
    v_and_b32 v6, 7, v1
    v_xor_b32 v5, v5, v6
    v_lshrrev_b32 v6, 3, v1
    v_mul_u32_u24 v112, 3072, v6
    v_lshl_add_u32 v112, v5, 4, v112
    v_bfe_u32 v6, v1, 4, 1
    v_bfe_u32 v5, v1, 5, 1
    v_xor_b32 v5, 1, v5
    v_lshl_or_b32 v5, v5, 1, v6
    v_lshlrev_b32 v5, 1, v5
    v_and_b32 v6, 7, v1
    v_xor_b32 v5, v5, v6
    v_lshrrev_b32 v6, 3, v1
    v_mul_u32_u24 v113, 3072, v6
    v_lshl_add_u32 v113, v5, 4, v113
    v_lshrrev_b32 v5, 4, v1
    v_bfe_u32 v6, v1, 2, 2
    v_lshl_add_u32 v5, v5, 2, v6
    v_bfe_u32 v6, v1, 1, 1
    v_bfe_u32 v116, v5, 2, 1
    v_bfe_u32 v7, v5, 3, 1
    v_xor_b32 v116, v116, v7
    v_bfe_u32 v7, v5, 1, 1
    v_lshl_or_b32 v116, v116, 1, v7
    v_lshlrev_b32 v116, 1, v116
    v_xor_b32 v6, v6, v116
    v_lshlrev_b32 v6, 4, v6
    v_and_b32 v116, 1, v1
    v_lshl_add_u32 v6, v116, 3, v6
    v_lshl_add_u32 v116, v5, 7, v6
    v_add_u32 v116, 147456, v116
    v_lshrrev_b32 v5, 4, v1
    v_bfe_u32 v6, v1, 2, 2
    v_lshl_add_u32 v5, v5, 2, v6
    v_add_u32 v5, 16, v5
    v_bfe_u32 v6, v1, 1, 1
    v_bfe_u32 v117, v5, 2, 1
    v_bfe_u32 v7, v5, 3, 1
    v_xor_b32 v117, v117, v7
    v_bfe_u32 v7, v5, 1, 1
    v_lshl_or_b32 v117, v117, 1, v7
    v_lshlrev_b32 v117, 1, v117
    v_xor_b32 v6, v6, v117
    v_lshlrev_b32 v6, 4, v6
    v_and_b32 v117, 1, v1
    v_lshl_add_u32 v6, v117, 3, v6
    v_lshl_add_u32 v117, v5, 7, v6
    v_add_u32 v117, 147456, v117
    v_lshrrev_b32 v5, 4, v1
    v_bfe_u32 v6, v1, 2, 2
    v_lshl_add_u32 v5, v5, 2, v6
    v_bfe_u32 v6, v1, 1, 1
    v_add_u32 v6, 2, v6
    v_bfe_u32 v118, v5, 2, 1
    v_bfe_u32 v7, v5, 3, 1
    v_xor_b32 v118, v118, v7
    v_bfe_u32 v7, v5, 1, 1
    v_lshl_or_b32 v118, v118, 1, v7
    v_lshlrev_b32 v118, 1, v118
    v_xor_b32 v6, v6, v118
    v_lshlrev_b32 v6, 4, v6
    v_and_b32 v118, 1, v1
    v_lshl_add_u32 v6, v118, 3, v6
    v_lshl_add_u32 v118, v5, 7, v6
    v_add_u32 v118, 147456, v118
    v_lshrrev_b32 v5, 4, v1
    v_bfe_u32 v6, v1, 2, 2
    v_lshl_add_u32 v5, v5, 2, v6
    v_add_u32 v5, 16, v5
    v_bfe_u32 v6, v1, 1, 1
    v_add_u32 v6, 2, v6
    v_bfe_u32 v119, v5, 2, 1
    v_bfe_u32 v7, v5, 3, 1
    v_xor_b32 v119, v119, v7
    v_bfe_u32 v7, v5, 1, 1
    v_lshl_or_b32 v119, v119, 1, v7
    v_lshlrev_b32 v119, 1, v119
    v_xor_b32 v6, v6, v119
    v_lshlrev_b32 v6, 4, v6
    v_and_b32 v119, 1, v1
    v_lshl_add_u32 v6, v119, 3, v6
    v_lshl_add_u32 v119, v5, 7, v6
    v_add_u32 v119, 147456, v119
    v_lshrrev_b32 v5, 4, v1
    v_bfe_u32 v6, v1, 2, 2
    v_lshl_add_u32 v5, v5, 2, v6
    v_bfe_u32 v6, v1, 1, 1
    v_add_u32 v6, 4, v6
    v_bfe_u32 v120, v5, 2, 1
    v_bfe_u32 v7, v5, 3, 1
    v_xor_b32 v120, v120, v7
    v_bfe_u32 v7, v5, 1, 1
    v_lshl_or_b32 v120, v120, 1, v7
    v_lshlrev_b32 v120, 1, v120
    v_xor_b32 v6, v6, v120
    v_lshlrev_b32 v6, 4, v6
    v_and_b32 v120, 1, v1
    v_lshl_add_u32 v6, v120, 3, v6
    v_lshl_add_u32 v120, v5, 7, v6
    v_add_u32 v120, 147456, v120
    v_lshrrev_b32 v5, 4, v1
    v_bfe_u32 v6, v1, 2, 2
    v_lshl_add_u32 v5, v5, 2, v6
    v_add_u32 v5, 16, v5
    v_bfe_u32 v6, v1, 1, 1
    v_add_u32 v6, 4, v6
    v_bfe_u32 v121, v5, 2, 1
    v_bfe_u32 v7, v5, 3, 1
    v_xor_b32 v121, v121, v7
    v_bfe_u32 v7, v5, 1, 1
    v_lshl_or_b32 v121, v121, 1, v7
    v_lshlrev_b32 v121, 1, v121
    v_xor_b32 v6, v6, v121
    v_lshlrev_b32 v6, 4, v6
    v_and_b32 v121, 1, v1
    v_lshl_add_u32 v6, v121, 3, v6
    v_lshl_add_u32 v121, v5, 7, v6
    v_add_u32 v121, 147456, v121
    v_lshrrev_b32 v5, 4, v1
    v_bfe_u32 v6, v1, 2, 2
    v_lshl_add_u32 v5, v5, 2, v6
    v_bfe_u32 v6, v1, 1, 1
    v_add_u32 v6, 6, v6
    v_bfe_u32 v122, v5, 2, 1
    v_bfe_u32 v7, v5, 3, 1
    v_xor_b32 v122, v122, v7
    v_bfe_u32 v7, v5, 1, 1
    v_lshl_or_b32 v122, v122, 1, v7
    v_lshlrev_b32 v122, 1, v122
    v_xor_b32 v6, v6, v122
    v_lshlrev_b32 v6, 4, v6
    v_and_b32 v122, 1, v1
    v_lshl_add_u32 v6, v122, 3, v6
    v_lshl_add_u32 v122, v5, 7, v6
    v_add_u32 v122, 147456, v122
    v_lshrrev_b32 v5, 4, v1
    v_bfe_u32 v6, v1, 2, 2
    v_lshl_add_u32 v5, v5, 2, v6
    v_add_u32 v5, 16, v5
    v_bfe_u32 v6, v1, 1, 1
    v_add_u32 v6, 6, v6
    v_bfe_u32 v123, v5, 2, 1
    v_bfe_u32 v7, v5, 3, 1
    v_xor_b32 v123, v123, v7
    v_bfe_u32 v7, v5, 1, 1
    v_lshl_or_b32 v123, v123, 1, v7
    v_lshlrev_b32 v123, 1, v123
    v_xor_b32 v6, v6, v123
    v_lshlrev_b32 v6, 4, v6
    v_and_b32 v123, 1, v1
    v_lshl_add_u32 v6, v123, 3, v6
    v_lshl_add_u32 v123, v5, 7, v6
    v_add_u32 v123, 147456, v123
    s_barrier
    s_waitcnt lgkmcnt(0)
    s_barrier
    s_mov_b32 m0, 64512
    s_add_u32 s40, s45, 27648
    buffer_load_dwordx4 v2, s[8:11], s40 offen lds
    buffer_load_dwordx4 v2, s[8:11], s40 offen offset:1024 lds
    buffer_load_dwordx4 v2, s[8:11], s40 offen offset:2048 lds
    buffer_load_dwordx4 v2, s[8:11], s40 offen offset:3072 lds
    s_mov_b32 m0, 68608
    s_add_u32 s40, s45, 31744
    buffer_load_dwordx4 v2, s[8:11], s40 offen lds
    s_waitcnt lgkmcnt(0)
    s_barrier
    s_mov_b32 m0, 13312
    s_add_u32 s40, s45, 36864
    buffer_load_dwordx4 v2, s[8:11], s40 offen lds
    buffer_load_dwordx4 v2, s[8:11], s40 offen offset:1024 lds
    buffer_load_dwordx4 v2, s[8:11], s40 offen offset:2048 lds
    buffer_load_dwordx4 v2, s[8:11], s40 offen offset:3072 lds
    s_waitcnt lgkmcnt(0)
    s_barrier
    s_mov_b32 m0, 30720
    s_add_u32 s40, s45, 45056
    buffer_load_dwordx4 v2, s[8:11], s40 offen lds
    buffer_load_dwordx4 v2, s[8:11], s40 offen offset:1024 lds
    buffer_load_dwordx4 v2, s[8:11], s40 offen offset:2048 lds
    buffer_load_dwordx4 v2, s[8:11], s40 offen offset:3072 lds
    s_waitcnt vmcnt(8) lgkmcnt(0)
    s_barrier
    s_mov_b32 m0, 48128
    s_add_u32 s40, s45, 53248
    buffer_load_dwordx4 v2, s[8:11], s40 offen lds
    buffer_load_dwordx4 v2, s[8:11], s40 offen offset:1024 lds
    buffer_load_dwordx4 v2, s[8:11], s40 offen offset:2048 lds
    buffer_load_dwordx4 v2, s[8:11], s40 offen offset:3072 lds
    s_waitcnt vmcnt(8) lgkmcnt(0)
    s_barrier
    s_mov_b32 m0, 64512
    s_add_u32 s40, s45, 60416
    buffer_load_dwordx4 v2, s[8:11], s40 offen lds
    buffer_load_dwordx4 v2, s[8:11], s40 offen offset:1024 lds
    buffer_load_dwordx4 v2, s[8:11], s40 offen offset:2048 lds
    buffer_load_dwordx4 v2, s[8:11], s40 offen offset:3072 lds
    s_mov_b32 m0, 68608
    s_add_u32 s40, s45, 64512
    buffer_load_dwordx4 v2, s[8:11], s40 offen lds
    s_waitcnt vmcnt(9) lgkmcnt(0)
    s_barrier
    s_mov_b32 m0, 13312
    s_add_u32 s40, s45, 69632
    buffer_load_dwordx4 v2, s[8:11], s40 offen lds
    buffer_load_dwordx4 v2, s[8:11], s40 offen offset:1024 lds
    buffer_load_dwordx4 v2, s[8:11], s40 offen offset:2048 lds
    buffer_load_dwordx4 v2, s[8:11], s40 offen offset:3072 lds
    s_waitcnt vmcnt(9) lgkmcnt(0)
    s_barrier
    s_mov_b32 m0, 30720
    s_add_u32 s40, s45, 77824
    buffer_load_dwordx4 v2, s[8:11], s40 offen lds
    buffer_load_dwordx4 v2, s[8:11], s40 offen offset:1024 lds
    buffer_load_dwordx4 v2, s[8:11], s40 offen offset:2048 lds
    buffer_load_dwordx4 v2, s[8:11], s40 offen offset:3072 lds
    s_waitcnt vmcnt(8) lgkmcnt(0)
    s_barrier
    s_mov_b32 m0, 48128
    s_add_u32 s40, s45, 86016
    buffer_load_dwordx4 v2, s[8:11], s40 offen lds
    buffer_load_dwordx4 v2, s[8:11], s40 offen offset:1024 lds
    buffer_load_dwordx4 v2, s[8:11], s40 offen offset:2048 lds
    buffer_load_dwordx4 v2, s[8:11], s40 offen offset:3072 lds
    s_waitcnt vmcnt(8) lgkmcnt(0)
    s_barrier
    s_mov_b32 m0, 64512
    s_add_u32 s40, s45, 93184
    buffer_load_dwordx4 v2, s[8:11], s40 offen lds
    buffer_load_dwordx4 v2, s[8:11], s40 offen offset:1024 lds
    buffer_load_dwordx4 v2, s[8:11], s40 offen offset:2048 lds
    buffer_load_dwordx4 v2, s[8:11], s40 offen offset:3072 lds
    s_mov_b32 m0, 68608
    s_add_u32 s40, s45, 97280
    buffer_load_dwordx4 v2, s[8:11], s40 offen lds
    s_waitcnt vmcnt(9) lgkmcnt(0)
    s_barrier
    s_mov_b32 m0, 13312
    s_add_u32 s40, s45, 102400
    buffer_load_dwordx4 v2, s[8:11], s40 offen lds
    buffer_load_dwordx4 v2, s[8:11], s40 offen offset:1024 lds
    buffer_load_dwordx4 v2, s[8:11], s40 offen offset:2048 lds
    buffer_load_dwordx4 v2, s[8:11], s40 offen offset:3072 lds
    s_waitcnt vmcnt(9) lgkmcnt(0)
    s_barrier
    s_mov_b32 m0, 30720
    s_add_u32 s40, s45, 110592
    buffer_load_dwordx4 v2, s[8:11], s40 offen lds
    buffer_load_dwordx4 v2, s[8:11], s40 offen offset:1024 lds
    buffer_load_dwordx4 v2, s[8:11], s40 offen offset:2048 lds
    buffer_load_dwordx4 v2, s[8:11], s40 offen offset:3072 lds
    s_waitcnt vmcnt(8) lgkmcnt(0)
    s_barrier
    s_mov_b32 m0, 48128
    s_add_u32 s40, s45, 118784
    buffer_load_dwordx4 v2, s[8:11], s40 offen lds
    buffer_load_dwordx4 v2, s[8:11], s40 offen offset:1024 lds
    buffer_load_dwordx4 v2, s[8:11], s40 offen offset:2048 lds
    buffer_load_dwordx4 v2, s[8:11], s40 offen offset:3072 lds
    s_waitcnt vmcnt(8) lgkmcnt(0)
    s_barrier
    s_mov_b32 m0, 64512
    s_add_u32 s40, s45, 125952
    buffer_load_dwordx4 v2, s[8:11], s40 offen lds
    buffer_load_dwordx4 v2, s[8:11], s40 offen offset:1024 lds
    buffer_load_dwordx4 v2, s[8:11], s40 offen offset:2048 lds
    buffer_load_dwordx4 v2, s[8:11], s40 offen offset:3072 lds
    s_mov_b32 m0, 68608
    s_add_u32 s40, s45, 130048
    buffer_load_dwordx4 v2, s[8:11], s40 offen lds
    s_waitcnt vmcnt(9) lgkmcnt(0)
    s_barrier
    s_mov_b32 m0, 13312
    s_add_u32 s40, s45, 135168
    buffer_load_dwordx4 v2, s[8:11], s40 offen lds
    buffer_load_dwordx4 v2, s[8:11], s40 offen offset:1024 lds
    buffer_load_dwordx4 v2, s[8:11], s40 offen offset:2048 lds
    buffer_load_dwordx4 v2, s[8:11], s40 offen offset:3072 lds
    s_waitcnt vmcnt(9) lgkmcnt(0)
    s_barrier
    s_mov_b32 m0, 30720
    s_add_u32 s40, s45, 143360
    buffer_load_dwordx4 v2, s[8:11], s40 offen lds
    buffer_load_dwordx4 v2, s[8:11], s40 offen offset:1024 lds
    buffer_load_dwordx4 v2, s[8:11], s40 offen offset:2048 lds
    buffer_load_dwordx4 v2, s[8:11], s40 offen offset:3072 lds
    s_waitcnt vmcnt(8) lgkmcnt(0)
    s_barrier
    s_mov_b32 m0, 48128
    s_add_u32 s40, s45, 151552
    buffer_load_dwordx4 v2, s[8:11], s40 offen lds
    buffer_load_dwordx4 v2, s[8:11], s40 offen offset:1024 lds
    buffer_load_dwordx4 v2, s[8:11], s40 offen offset:2048 lds
    buffer_load_dwordx4 v2, s[8:11], s40 offen offset:3072 lds
    s_waitcnt vmcnt(8) lgkmcnt(0)
    s_barrier
    s_mov_b32 m0, 64512
    s_add_u32 s40, s45, 158720
    buffer_load_dwordx4 v2, s[8:11], s40 offen lds
    buffer_load_dwordx4 v2, s[8:11], s40 offen offset:1024 lds
    buffer_load_dwordx4 v2, s[8:11], s40 offen offset:2048 lds
    buffer_load_dwordx4 v2, s[8:11], s40 offen offset:3072 lds
    s_mov_b32 m0, 68608
    s_add_u32 s40, s45, 162816
    buffer_load_dwordx4 v2, s[8:11], s40 offen lds
    s_waitcnt vmcnt(9) lgkmcnt(0)
    s_barrier
    s_mov_b32 m0, 147456
    s_add_u32 s42, s48, 0
    buffer_load_dwordx4 v112, s[12:15], s42 offen nt lds
    s_mov_b32 m0, 148480
    s_add_u32 s42, s48, 24576
    buffer_load_dwordx4 v113, s[12:15], s42 offen nt lds
    s_mov_b32 m0, 149504
    s_add_u32 s42, s48, 49152
    buffer_load_dwordx4 v112, s[12:15], s42 offen nt lds
    s_mov_b32 m0, 150528
    s_add_u32 s42, s48, 73728
    buffer_load_dwordx4 v113, s[12:15], s42 offen nt lds
    s_mov_b32 m0, 151552
    s_add_u32 s42, s48, 98304
    buffer_load_dwordx4 v112, s[12:15], s42 offen nt lds
    s_mov_b32 m0, 152576
    s_add_u32 s42, s48, 122880
    buffer_load_dwordx4 v113, s[12:15], s42 offen nt lds
    s_mov_b32 m0, 153600
    s_add_u32 s42, s48, 147456
    buffer_load_dwordx4 v112, s[12:15], s42 offen nt lds
    s_mov_b32 m0, 154624
    s_add_u32 s42, s48, 172032
    buffer_load_dwordx4 v113, s[12:15], s42 offen nt lds
    s_mov_b32 m0, 155648
    s_add_u32 s42, s48, 196608
    buffer_load_dwordx4 v112, s[12:15], s42 offen nt lds
    s_mov_b32 m0, 156672
    s_add_u32 s42, s48, 221184
    buffer_load_dwordx4 v113, s[12:15], s42 offen nt lds
    s_mov_b32 m0, 157696
    s_add_u32 s42, s48, 245760
    buffer_load_dwordx4 v112, s[12:15], s42 offen nt lds
    s_mov_b32 m0, 158720
    s_add_u32 s42, s48, 270336
    buffer_load_dwordx4 v113, s[12:15], s42 offen nt lds
    s_mov_b32 m0, 159744
    s_add_u32 s42, s48, 294912
    buffer_load_dwordx4 v112, s[12:15], s42 offen nt lds
    s_mov_b32 m0, 160768
    s_add_u32 s42, s48, 319488
    buffer_load_dwordx4 v113, s[12:15], s42 offen nt lds
    s_mov_b32 m0, 161792
    s_add_u32 s42, s48, 344064
    buffer_load_dwordx4 v112, s[12:15], s42 offen nt lds
    s_mov_b32 m0, 162816
    s_add_u32 s42, s48, 368640
    buffer_load_dwordx4 v113, s[12:15], s42 offen nt lds
    buffer_load_dwordx4 v[32:35], v9, s[8:11], s49 offen offset:0
    buffer_load_dwordx4 v[36:39], v9, s[8:11], s49 offen offset:64
    buffer_load_dwordx4 v[40:43], v9, s[8:11], s49 offen offset:128
    buffer_load_dwordx4 v[44:47], v9, s[8:11], s49 offen offset:192
    buffer_load_dwordx4 v[48:51], v9, s[8:11], s49 offen offset:256
    buffer_load_dwordx4 v[52:55], v9, s[8:11], s49 offen offset:320
    buffer_load_dwordx4 v[56:59], v9, s[8:11], s49 offen offset:384
    buffer_load_dwordx4 v[60:63], v9, s[8:11], s49 offen offset:448
    s_waitcnt vmcnt(29) lgkmcnt(0)
    s_barrier
    s_waitcnt vmcnt(24) lgkmcnt(0)
    s_barrier
    s_barrier
    s_mul_i32 s45, s36, 102400
    s_add_u32 s45, s45, 5357568
    s_mul_i32 s46, s35, 81920
    s_add_u32 s46, s46, 12197888
    s_mov_b32 m0, 8192
    s_add_u32 s40, s45, 8192
    buffer_load_dwordx4 v2, s[8:11], s40 offen sc1 lds
    buffer_load_dwordx4 v2, s[8:11], s40 offen offset:1024 sc1 lds
    s_mov_b32 m0, 18432
    s_add_u32 s40, s45, 18432
    buffer_load_dwordx4 v2, s[8:11], s40 offen sc1 lds
    buffer_load_dwordx4 v2, s[8:11], s40 offen offset:1024 sc1 lds
    s_mov_b32 m0, 27648
    s_add_u32 s40, s45, 27648
    buffer_load_dwordx4 v2, s[8:11], s40 offen sc1 lds
    buffer_load_dwordx4 v2, s[8:11], s40 offen offset:1024 sc1 lds
    buffer_load_dwordx4 v2, s[8:11], s40 offen offset:2048 sc1 lds
    s_mov_b32 m0, 37888
    s_add_u32 s40, s45, 37888
    buffer_load_dwordx4 v2, s[8:11], s40 offen sc1 lds
    buffer_load_dwordx4 v2, s[8:11], s40 offen offset:1024 sc1 lds
    buffer_load_dwordx4 v2, s[8:11], s40 offen offset:2048 sc1 lds
    s_mov_b32 m0, 49152
    s_add_u32 s40, s45, 49152
    buffer_load_dwordx4 v2, s[8:11], s40 offen sc1 lds
    buffer_load_dwordx4 v2, s[8:11], s40 offen offset:1024 sc1 lds
    s_mov_b32 m0, 59392
    s_add_u32 s40, s45, 59392
    buffer_load_dwordx4 v2, s[8:11], s40 offen sc1 lds
    buffer_load_dwordx4 v2, s[8:11], s40 offen offset:1024 sc1 lds
    s_mov_b32 s28, s22
    s_mov_b32 s29, s23
    s_mov_b32 s30, 2621440
    s_mov_b32 s31, 0x20000
    s_mul_i32 s41, s35, 81920
    s_mul_i32 s42, s36, 160
    s_add_u32 s41, s41, s42
    v_add_u32 v5, 192, v1
    v_mul_u32_u24 v6, 6554, v5
    v_lshrrev_b32 v6, 16, v6
    v_mul_u32_u24 v7, 10, v6
    v_sub_u32 v5, v5, v7
    v_lshlrev_b32 v5, 4, v5
    v_mul_u32_u24 v6, 1280, v6
    v_add_u32 v23, v5, v6
    s_mov_b32 m0, 134144
    s_nop 0
    buffer_load_dwordx4 v23, s[28:31], s41 offen lds
    v_add_u32 v5, 448, v1
    v_mul_u32_u24 v6, 6554, v5
    v_lshrrev_b32 v6, 16, v6
    v_mul_u32_u24 v7, 10, v6
    v_sub_u32 v5, v5, v7
    v_lshlrev_b32 v5, 4, v5
    v_mul_u32_u24 v6, 1280, v6
    v_add_u32 v27, v5, v6
    s_mov_b32 m0, 138240
    s_nop 0
    buffer_load_dwordx4 v27, s[28:31], s41 offen lds
    s_mul_i32 s42, s36, 320
    s_add_u32 s42, s42, 5350400
    s_mov_b32 m0, 142336
    s_nop 0
    buffer_load_dwordx4 v2, s[8:11], s42 offen lds
    s_cmp_lt_u32 s2, 240
    s_cbranch_scc0 kp_side151
    s_waitcnt vmcnt(17)
    v_cvt_pk_bf16_f32 v64, v32, v33
    v_cvt_pk_bf16_f32 v65, v34, v35
    v_cvt_pk_bf16_f32 v66, v36, v37
    v_cvt_pk_bf16_f32 v67, v38, v39
    v_cvt_pk_bf16_f32 v68, v40, v41
    v_cvt_pk_bf16_f32 v69, v42, v43
    v_cvt_pk_bf16_f32 v70, v44, v45
    v_cvt_pk_bf16_f32 v71, v46, v47
    v_cvt_pk_bf16_f32 v72, v48, v49
    v_cvt_pk_bf16_f32 v73, v50, v51
    v_cvt_pk_bf16_f32 v74, v52, v53
    v_cvt_pk_bf16_f32 v75, v54, v55
    v_cvt_pk_bf16_f32 v76, v56, v57
    v_cvt_pk_bf16_f32 v77, v58, v59
    v_cvt_pk_bf16_f32 v78, v60, v61
    v_cvt_pk_bf16_f32 v79, v62, v63
    v_and_b32 v5, 1, v1
    v_mul_u32_u24 v5, 12288, v5
    v_add_u32 v5, v5, v3
    ds_read_b64_tr_b16 v[80:81], v116 offset:0
    ds_read_b64_tr_b16 v[82:83], v117 offset:0
    ds_read_b64_tr_b16 v[84:85], v116 offset:4096
    ds_read_b64_tr_b16 v[86:87], v117 offset:4096
    ds_read_b64_tr_b16 v[88:89], v116 offset:8192
    ds_read_b64_tr_b16 v[90:91], v117 offset:8192
    ds_read_b64_tr_b16 v[92:93], v116 offset:12288
    ds_read_b64_tr_b16 v[94:95], v117 offset:12288
    s_waitcnt lgkmcnt(6)
    buffer_store_dwordx4 v[80:83], v2, s[8:11], s52 offen sc1
    s_add_u32 s52, s52, 12288
    v_mfma_f32_16x16x32_bf16 v[96:99], v[80:83], v[64:67], 0
    s_waitcnt lgkmcnt(4)
    buffer_store_dwordx4 v[84:87], v2, s[8:11], s52 offen sc1
    s_add_u32 s52, s52, 12288
    v_mfma_f32_16x16x32_bf16 v[96:99], v[84:87], v[68:71], v[96:99]
    s_waitcnt lgkmcnt(2)
    buffer_store_dwordx4 v[88:91], v2, s[8:11], s52 offen sc1
    s_add_u32 s52, s52, 12288
    v_mfma_f32_16x16x32_bf16 v[96:99], v[88:91], v[72:75], v[96:99]
    s_waitcnt lgkmcnt(0)
    buffer_store_dwordx4 v[92:95], v2, s[8:11], s52 offen sc1
    v_mfma_f32_16x16x32_bf16 v[96:99], v[92:95], v[76:79], v[96:99]
    s_nop 1
    ds_read_b64_tr_b16 v[80:81], v118 offset:0
    ds_read_b64_tr_b16 v[82:83], v119 offset:0
    ds_read_b64_tr_b16 v[84:85], v118 offset:4096
    ds_read_b64_tr_b16 v[86:87], v119 offset:4096
    ds_read_b64_tr_b16 v[88:89], v118 offset:8192
    ds_read_b64_tr_b16 v[90:91], v119 offset:8192
    ds_read_b64_tr_b16 v[92:93], v118 offset:12288
    ds_read_b64_tr_b16 v[94:95], v119 offset:12288
    s_waitcnt lgkmcnt(6)
    buffer_store_dwordx4 v[80:83], v2, s[8:11], s53 offen sc1
    s_add_u32 s53, s53, 12288
    v_mfma_f32_16x16x32_bf16 v[100:103], v[80:83], v[64:67], 0
    s_waitcnt lgkmcnt(4)
    buffer_store_dwordx4 v[84:87], v2, s[8:11], s53 offen sc1
    s_add_u32 s53, s53, 12288
    v_mfma_f32_16x16x32_bf16 v[100:103], v[84:87], v[68:71], v[100:103]
    s_waitcnt lgkmcnt(2)
    buffer_store_dwordx4 v[88:91], v2, s[8:11], s53 offen sc1
    s_add_u32 s53, s53, 12288
    v_mfma_f32_16x16x32_bf16 v[100:103], v[88:91], v[72:75], v[100:103]
    s_waitcnt lgkmcnt(0)
    buffer_store_dwordx4 v[92:95], v2, s[8:11], s53 offen sc1
    v_mfma_f32_16x16x32_bf16 v[100:103], v[92:95], v[76:79], v[100:103]
    s_nop 1
    ds_read_b64_tr_b16 v[80:81], v120 offset:0
    ds_read_b64_tr_b16 v[82:83], v121 offset:0
    ds_read_b64_tr_b16 v[84:85], v120 offset:4096
    ds_read_b64_tr_b16 v[86:87], v121 offset:4096
    ds_read_b64_tr_b16 v[88:89], v120 offset:8192
    ds_read_b64_tr_b16 v[90:91], v121 offset:8192
    ds_read_b64_tr_b16 v[92:93], v120 offset:12288
    ds_read_b64_tr_b16 v[94:95], v121 offset:12288
    s_waitcnt lgkmcnt(6)
    buffer_store_dwordx4 v[80:83], v2, s[8:11], s54 offen sc1
    s_add_u32 s54, s54, 12288
    v_mfma_f32_16x16x32_bf16 v[104:107], v[80:83], v[64:67], 0
    s_waitcnt lgkmcnt(4)
    buffer_store_dwordx4 v[84:87], v2, s[8:11], s54 offen sc1
    s_add_u32 s54, s54, 12288
    v_mfma_f32_16x16x32_bf16 v[104:107], v[84:87], v[68:71], v[104:107]
    s_waitcnt lgkmcnt(2)
    buffer_store_dwordx4 v[88:91], v2, s[8:11], s54 offen sc1
    s_add_u32 s54, s54, 12288
    v_mfma_f32_16x16x32_bf16 v[104:107], v[88:91], v[72:75], v[104:107]
    s_waitcnt lgkmcnt(0)
    buffer_store_dwordx4 v[92:95], v2, s[8:11], s54 offen sc1
    v_mfma_f32_16x16x32_bf16 v[104:107], v[92:95], v[76:79], v[104:107]
    s_nop 1
    ds_read_b64_tr_b16 v[80:81], v122 offset:0
    ds_read_b64_tr_b16 v[82:83], v123 offset:0
    ds_read_b64_tr_b16 v[84:85], v122 offset:4096
    ds_read_b64_tr_b16 v[86:87], v123 offset:4096
    ds_read_b64_tr_b16 v[88:89], v122 offset:8192
    ds_read_b64_tr_b16 v[90:91], v123 offset:8192
    ds_read_b64_tr_b16 v[92:93], v122 offset:12288
    ds_read_b64_tr_b16 v[94:95], v123 offset:12288
    s_waitcnt lgkmcnt(6)
    buffer_store_dwordx4 v[80:83], v2, s[8:11], s55 offen sc1
    s_add_u32 s55, s55, 12288
    v_mfma_f32_16x16x32_bf16 v[108:111], v[80:83], v[64:67], 0
    s_waitcnt lgkmcnt(4)
    buffer_store_dwordx4 v[84:87], v2, s[8:11], s55 offen sc1
    s_add_u32 s55, s55, 12288
    v_mfma_f32_16x16x32_bf16 v[108:111], v[84:87], v[68:71], v[108:111]
    s_waitcnt lgkmcnt(2)
    buffer_store_dwordx4 v[88:91], v2, s[8:11], s55 offen sc1
    s_add_u32 s55, s55, 12288
    v_mfma_f32_16x16x32_bf16 v[108:111], v[88:91], v[72:75], v[108:111]
    s_waitcnt lgkmcnt(0)
    buffer_store_dwordx4 v[92:95], v2, s[8:11], s55 offen sc1
    v_mfma_f32_16x16x32_bf16 v[108:111], v[92:95], v[76:79], v[108:111]
    s_nop 1
    s_mov_b32 exec_lo, 0x00030003
    s_mov_b32 exec_hi, 0x00030003
    buffer_store_dwordx4 v[96:99], v5, s[8:11], s50 offen offset:0 sc1
    buffer_store_dwordx4 v[100:103], v5, s[8:11], s50 offen offset:64 sc1
    buffer_store_dwordx4 v[104:107], v5, s[8:11], s50 offen offset:128 sc1
    s_nop 0
    buffer_store_dwordx4 v[108:111], v5, s[8:11], s50 offen offset:192 sc1
    s_mov_b64 exec, -1
kp_side151:
    s_lshl_b32 s40, s2, 7
    s_add_u32 s40, s40, 26501120
    v_mov_b32 v5, s96
    v_mov_b32 v6, 0
    s_waitcnt vmcnt(0)
    s_mov_b64 exec, 1
    buffer_store_dword v5, v6, s[8:11], s40 offen sc1
    s_mov_b64 exec, -1
    s_mov_b32 s12, s20
    s_mov_b32 s13, s21
    s_mov_b32 s14, 1966080
    s_mov_b32 s15, 0x20000
    s_min_u32 s40, s2, 119
    s_mul_i32 s41, s40, 205
    s_lshr_b32 s41, s41, 11
    s_mul_i32 s42, s41, 10
    s_sub_u32 s42, s40, s42
    s_mul_i32 s48, s41, 163840
    s_lshl_b32 s43, s42, 7
    s_add_u32 s48, s48, s43
    s_cmp_lt_u32 s2, 120
    s_cselect_b32 s48, s48, 0x40000000
    s_lshl_b32 s44, s42, 2
    s_lshl_b32 s41, s41, 2
    s_add_u32 s42, s44, 0
    s_mul_i32 s40, s42, 205
    s_lshr_b32 s40, s40, 10
    s_mul_i32 s43, s40, 5
    s_sub_u32 s43, s42, s43
    s_mul_i32 s40, s40, 48
    s_add_u32 s40, s40, s41
    s_mul_i32 s40, s40, 5
    s_add_u32 s40, s40, s43
    s_lshl_b32 s40, s40, 10
    s_add_u32 s52, s40, 10108928
    s_add_u32 s42, s44, 1
    s_mul_i32 s40, s42, 205
    s_lshr_b32 s40, s40, 10
    s_mul_i32 s43, s40, 5
    s_sub_u32 s43, s42, s43
    s_mul_i32 s40, s40, 48
    s_add_u32 s40, s40, s41
    s_mul_i32 s40, s40, 5
    s_add_u32 s40, s40, s43
    s_lshl_b32 s40, s40, 10
    s_add_u32 s53, s40, 10108928
    s_add_u32 s42, s44, 2
    s_mul_i32 s40, s42, 205
    s_lshr_b32 s40, s40, 10
    s_mul_i32 s43, s40, 5
    s_sub_u32 s43, s42, s43
    s_mul_i32 s40, s40, 48
    s_add_u32 s40, s40, s41
    s_mul_i32 s40, s40, 5
    s_add_u32 s40, s40, s43
    s_lshl_b32 s40, s40, 10
    s_add_u32 s54, s40, 10108928
    s_add_u32 s42, s44, 3
    s_mul_i32 s40, s42, 205
    s_lshr_b32 s40, s40, 10
    s_mul_i32 s43, s40, 5
    s_sub_u32 s43, s42, s43
    s_mul_i32 s40, s40, 48
    s_add_u32 s40, s40, s41
    s_mul_i32 s40, s40, 5
    s_add_u32 s40, s40, s43
    s_lshl_b32 s40, s40, 10
    s_add_u32 s55, s40, 10108928
    v_bfe_u32 v6, v1, 4, 1
    v_bfe_u32 v5, v1, 5, 1
    v_lshl_or_b32 v5, v5, 1, v6
    v_lshlrev_b32 v5, 1, v5
    v_and_b32 v6, 7, v1
    v_xor_b32 v5, v5, v6
    v_lshrrev_b32 v6, 3, v1
    v_mul_u32_u24 v112, 1280, v6
    v_lshl_add_u32 v112, v5, 4, v112
    v_bfe_u32 v6, v1, 4, 1
    v_bfe_u32 v5, v1, 5, 1
    v_xor_b32 v5, 1, v5
    v_lshl_or_b32 v5, v5, 1, v6
    v_lshlrev_b32 v5, 1, v5
    v_and_b32 v6, 7, v1
    v_xor_b32 v5, v5, v6
    v_lshrrev_b32 v6, 3, v1
    v_mul_u32_u24 v113, 1280, v6
    v_lshl_add_u32 v113, v5, 4, v113
    s_waitcnt lgkmcnt(0)
    s_barrier
    s_mov_b32 m0, 92160
    s_add_u32 s40, s46, 30720
    buffer_load_dwordx4 v2, s[8:11], s40 offen sc1 lds
    buffer_load_dwordx4 v2, s[8:11], s40 offen offset:1024 sc1 lds
    s_waitcnt lgkmcnt(0)
    s_barrier
    s_mov_b32 m0, 67584
    s_add_u32 s40, s46, 38912
    buffer_load_dwordx4 v2, s[8:11], s40 offen sc1 lds
    buffer_load_dwordx4 v2, s[8:11], s40 offen offset:1024 sc1 lds
    s_mov_b32 m0, 7168
    s_add_u32 s40, s45, 68608
    buffer_load_dwordx4 v2, s[8:11], s40 offen sc1 lds
    buffer_load_dwordx4 v2, s[8:11], s40 offen offset:1024 sc1 lds
    buffer_load_dwordx4 v2, s[8:11], s40 offen offset:2048 sc1 lds
    s_waitcnt lgkmcnt(0)
    s_barrier
    s_mov_b32 m0, 75776
    s_add_u32 s40, s46, 47104
    buffer_load_dwordx4 v2, s[8:11], s40 offen sc1 lds
    buffer_load_dwordx4 v2, s[8:11], s40 offen offset:1024 sc1 lds
    s_mov_b32 m0, 17408
    s_add_u32 s40, s45, 78848
    buffer_load_dwordx4 v2, s[8:11], s40 offen sc1 lds
    buffer_load_dwordx4 v2, s[8:11], s40 offen offset:1024 sc1 lds
    buffer_load_dwordx4 v2, s[8:11], s40 offen offset:2048 sc1 lds
    s_waitcnt vmcnt(10) lgkmcnt(0)
    s_barrier
    s_mov_b32 m0, 83968
    s_add_u32 s40, s46, 55296
    buffer_load_dwordx4 v2, s[8:11], s40 offen sc1 lds
    buffer_load_dwordx4 v2, s[8:11], s40 offen offset:1024 sc1 lds
    s_mov_b32 m0, 28672
    s_add_u32 s40, s45, 90112
    buffer_load_dwordx4 v2, s[8:11], s40 offen sc1 lds
    buffer_load_dwordx4 v2, s[8:11], s40 offen offset:1024 sc1 lds
    s_waitcnt vmcnt(12) lgkmcnt(0)
    s_barrier
    s_mov_b32 m0, 92160
    s_add_u32 s40, s46, 63488
    buffer_load_dwordx4 v2, s[8:11], s40 offen sc1 lds
    buffer_load_dwordx4 v2, s[8:11], s40 offen offset:1024 sc1 lds
    s_mov_b32 m0, 38912
    s_add_u32 s40, s45, 100352
    buffer_load_dwordx4 v2, s[8:11], s40 offen sc1 lds
    buffer_load_dwordx4 v2, s[8:11], s40 offen offset:1024 sc1 lds
    v_min_u32 v58, 29, v1
    v_mul_u32_u24 v59, 35, v58
    v_lshrrev_b32 v59, 9, v59
    v_mul_u32_u24 v57, 120, v59
    v_mul_u32_u24 v59, 15, v59
    v_sub_u32 v58, v58, v59
    v_mul_u32_u24 v59, 86, v58
    v_lshrrev_b32 v59, 8, v59
    v_mad_u32_u24 v57, v59, 24, v57
    v_mul_u32_u24 v59, 3, v59
    v_sub_u32 v58, v58, v59
    s_mul_i32 s40, s34, 6
    s_add_u32 s41, s40, 5
    s_lshr_b32 s40, s40, 2
    s_lshr_b32 s41, s41, 2
    v_add_u32 v58, s40, v58
    v_min_u32 v58, s41, v58
    v_add_u32 v57, v57, v58
    v_lshlrev_b32 v57, 7, v57
    s_mov_b32 s47, 26501120
    buffer_load_dword v56, v57, s[8:11], s47 offen sc1
    s_waitcnt vmcnt(12) lgkmcnt(0)
    s_barrier
    s_mov_b32 m0, 67584
    s_add_u32 s40, s46, 71680
    buffer_load_dwordx4 v2, s[8:11], s40 offen sc1 lds
    buffer_load_dwordx4 v2, s[8:11], s40 offen offset:1024 sc1 lds
    s_waitcnt vmcnt(9) lgkmcnt(0)
    s_barrier
    s_mov_b32 m0, 75776
    s_add_u32 s40, s46, 79872
    buffer_load_dwordx4 v2, s[8:11], s40 offen sc1 lds
    buffer_load_dwordx4 v2, s[8:11], s40 offen offset:1024 sc1 lds
    s_waitcnt vmcnt(7) lgkmcnt(0)
    s_barrier
    s_waitcnt vmcnt(4)
    v_cmp_eq_u32 vcc, s96, v56
    s_nop 3
    s_cmp_eq_u64 vcc, -1
    s_cbranch_scc1 kp_sfok52
    s_mov_b32 s39, 32768
kp_p53:
    buffer_load_dword v56, v57, s[8:11], s47 offen sc1
    s_waitcnt vmcnt(0)
    v_cmp_eq_u32 vcc, s96, v56
    s_nop 3
    s_cmp_eq_u64 vcc, -1
    s_cbranch_scc1 kp_q54
    s_sub_u32 s39, s39, 1
    s_cmp_lg_u32 s39, 0
    s_cbranch_scc1 kp_p53
kp_q54:
kp_sfok52:
    s_mul_i32 s45, s34, 245760
    s_add_u32 s45, s45, 6176768
    s_mul_i32 s46, s33, 163840
    s_add_u32 s46, s46, 17440768
    s_mov_b32 m0, 103424
    s_add_u32 s40, s45, 9216
    buffer_load_dwordx4 v2, s[8:11], s40 offen sc1 lds
    buffer_load_dwordx4 v2, s[8:11], s40 offen offset:1024 sc1 lds
    buffer_load_dwordx4 v2, s[8:11], s40 offen offset:2048 sc1 lds
    s_waitcnt vmcnt(5) lgkmcnt(0)
    s_barrier
    s_mov_b32 m0, 147456
    s_add_u32 s42, s48, 0
    buffer_load_dwordx4 v112, s[12:15], s42 offen nt lds
    s_mov_b32 m0, 148480
    s_add_u32 s42, s48, 10240
    buffer_load_dwordx4 v113, s[12:15], s42 offen nt lds
    s_mov_b32 m0, 149504
    s_add_u32 s42, s48, 20480
    buffer_load_dwordx4 v112, s[12:15], s42 offen nt lds
    s_mov_b32 m0, 150528
    s_add_u32 s42, s48, 30720
    buffer_load_dwordx4 v113, s[12:15], s42 offen nt lds
    s_mov_b32 m0, 151552
    s_add_u32 s42, s48, 40960
    buffer_load_dwordx4 v112, s[12:15], s42 offen nt lds
    s_mov_b32 m0, 152576
    s_add_u32 s42, s48, 51200
    buffer_load_dwordx4 v113, s[12:15], s42 offen nt lds
    s_mov_b32 m0, 153600
    s_add_u32 s42, s48, 61440
    buffer_load_dwordx4 v112, s[12:15], s42 offen nt lds
    s_mov_b32 m0, 154624
    s_add_u32 s42, s48, 71680
    buffer_load_dwordx4 v113, s[12:15], s42 offen nt lds
    s_mov_b32 m0, 155648
    s_add_u32 s42, s48, 81920
    buffer_load_dwordx4 v112, s[12:15], s42 offen nt lds
    s_mov_b32 m0, 156672
    s_add_u32 s42, s48, 92160
    buffer_load_dwordx4 v113, s[12:15], s42 offen nt lds
    s_mov_b32 m0, 157696
    s_add_u32 s42, s48, 102400
    buffer_load_dwordx4 v112, s[12:15], s42 offen nt lds
    s_mov_b32 m0, 158720
    s_add_u32 s42, s48, 112640
    buffer_load_dwordx4 v113, s[12:15], s42 offen nt lds
    s_mov_b32 m0, 159744
    s_add_u32 s42, s48, 122880
    buffer_load_dwordx4 v112, s[12:15], s42 offen nt lds
    s_mov_b32 m0, 160768
    s_add_u32 s42, s48, 133120
    buffer_load_dwordx4 v113, s[12:15], s42 offen nt lds
    s_mov_b32 m0, 161792
    s_add_u32 s42, s48, 143360
    buffer_load_dwordx4 v112, s[12:15], s42 offen nt lds
    s_mov_b32 m0, 162816
    s_add_u32 s42, s48, 153600
    buffer_load_dwordx4 v113, s[12:15], s42 offen nt lds
    s_mov_b32 m0, 115712
    s_add_u32 s40, s45, 21504
    buffer_load_dwordx4 v2, s[8:11], s40 offen sc1 lds
    buffer_load_dwordx4 v2, s[8:11], s40 offen offset:1024 sc1 lds
    buffer_load_dwordx4 v2, s[8:11], s40 offen offset:2048 sc1 lds
    s_waitcnt vmcnt(22) lgkmcnt(0)
    s_barrier
    s_mov_b32 m0, 128000
    s_add_u32 s40, s45, 33792
    buffer_load_dwordx4 v2, s[8:11], s40 offen sc1 lds
    buffer_load_dwordx4 v2, s[8:11], s40 offen offset:1024 sc1 lds
    buffer_load_dwordx4 v2, s[8:11], s40 offen offset:2048 sc1 lds
    s_cmp_lt_u32 s2, 120
    s_cbranch_scc0 kp_side255
    s_waitcnt vmcnt(6)
    ds_read_b64_tr_b16 v[80:81], v116 offset:0
    ds_read_b64_tr_b16 v[82:83], v117 offset:0
    ds_read_b64_tr_b16 v[84:85], v116 offset:4096
    ds_read_b64_tr_b16 v[86:87], v117 offset:4096
    ds_read_b64_tr_b16 v[88:89], v116 offset:8192
    ds_read_b64_tr_b16 v[90:91], v117 offset:8192
    ds_read_b64_tr_b16 v[92:93], v116 offset:12288
    ds_read_b64_tr_b16 v[94:95], v117 offset:12288
    s_waitcnt lgkmcnt(6)
    buffer_store_dwordx4 v[80:83], v2, s[8:11], s52 offen sc1
    s_add_u32 s52, s52, 5120
    s_waitcnt lgkmcnt(4)
    buffer_store_dwordx4 v[84:87], v2, s[8:11], s52 offen sc1
    s_add_u32 s52, s52, 5120
    s_waitcnt lgkmcnt(2)
    buffer_store_dwordx4 v[88:91], v2, s[8:11], s52 offen sc1
    s_add_u32 s52, s52, 5120
    s_waitcnt lgkmcnt(0)
    buffer_store_dwordx4 v[92:95], v2, s[8:11], s52 offen sc1
    s_nop 1
    ds_read_b64_tr_b16 v[80:81], v118 offset:0
    ds_read_b64_tr_b16 v[82:83], v119 offset:0
    ds_read_b64_tr_b16 v[84:85], v118 offset:4096
    ds_read_b64_tr_b16 v[86:87], v119 offset:4096
    ds_read_b64_tr_b16 v[88:89], v118 offset:8192
    ds_read_b64_tr_b16 v[90:91], v119 offset:8192
    ds_read_b64_tr_b16 v[92:93], v118 offset:12288
    ds_read_b64_tr_b16 v[94:95], v119 offset:12288
    s_waitcnt lgkmcnt(6)
    buffer_store_dwordx4 v[80:83], v2, s[8:11], s53 offen sc1
    s_add_u32 s53, s53, 5120
    s_waitcnt lgkmcnt(4)
    buffer_store_dwordx4 v[84:87], v2, s[8:11], s53 offen sc1
    s_add_u32 s53, s53, 5120
    s_waitcnt lgkmcnt(2)
    buffer_store_dwordx4 v[88:91], v2, s[8:11], s53 offen sc1
    s_add_u32 s53, s53, 5120
    s_waitcnt lgkmcnt(0)
    buffer_store_dwordx4 v[92:95], v2, s[8:11], s53 offen sc1
    s_nop 1
    ds_read_b64_tr_b16 v[80:81], v120 offset:0
    ds_read_b64_tr_b16 v[82:83], v121 offset:0
    ds_read_b64_tr_b16 v[84:85], v120 offset:4096
    ds_read_b64_tr_b16 v[86:87], v121 offset:4096
    ds_read_b64_tr_b16 v[88:89], v120 offset:8192
    ds_read_b64_tr_b16 v[90:91], v121 offset:8192
    ds_read_b64_tr_b16 v[92:93], v120 offset:12288
    ds_read_b64_tr_b16 v[94:95], v121 offset:12288
    s_waitcnt lgkmcnt(6)
    buffer_store_dwordx4 v[80:83], v2, s[8:11], s54 offen sc1
    s_add_u32 s54, s54, 5120
    s_waitcnt lgkmcnt(4)
    buffer_store_dwordx4 v[84:87], v2, s[8:11], s54 offen sc1
    s_add_u32 s54, s54, 5120
    s_waitcnt lgkmcnt(2)
    buffer_store_dwordx4 v[88:91], v2, s[8:11], s54 offen sc1
    s_add_u32 s54, s54, 5120
    s_waitcnt lgkmcnt(0)
    buffer_store_dwordx4 v[92:95], v2, s[8:11], s54 offen sc1
    s_nop 1
    ds_read_b64_tr_b16 v[80:81], v122 offset:0
    ds_read_b64_tr_b16 v[82:83], v123 offset:0
    ds_read_b64_tr_b16 v[84:85], v122 offset:4096
    ds_read_b64_tr_b16 v[86:87], v123 offset:4096
    ds_read_b64_tr_b16 v[88:89], v122 offset:8192
    ds_read_b64_tr_b16 v[90:91], v123 offset:8192
    ds_read_b64_tr_b16 v[92:93], v122 offset:12288
    ds_read_b64_tr_b16 v[94:95], v123 offset:12288
    s_waitcnt lgkmcnt(6)
    buffer_store_dwordx4 v[80:83], v2, s[8:11], s55 offen sc1
    s_add_u32 s55, s55, 5120
    s_waitcnt lgkmcnt(4)
    buffer_store_dwordx4 v[84:87], v2, s[8:11], s55 offen sc1
    s_add_u32 s55, s55, 5120
    s_waitcnt lgkmcnt(2)
    buffer_store_dwordx4 v[88:91], v2, s[8:11], s55 offen sc1
    s_add_u32 s55, s55, 5120
    s_waitcnt lgkmcnt(0)
    buffer_store_dwordx4 v[92:95], v2, s[8:11], s55 offen sc1
    s_nop 1
kp_side255:
    s_lshl_b32 s40, s2, 7
    s_add_u32 s40, s40, 26533888
    v_mov_b32 v5, s96
    v_mov_b32 v6, 0
    s_waitcnt vmcnt(0)
    s_mov_b64 exec, 1
    buffer_store_dword v5, v6, s[8:11], s40 offen sc1
    s_mov_b64 exec, -1
    s_waitcnt lgkmcnt(0)
    s_barrier
    s_mov_b32 m0, 27648
    s_add_u32 s40, s46, 27648
    buffer_load_dwordx4 v2, s[8:11], s40 offen sc1 lds
    buffer_load_dwordx4 v2, s[8:11], s40 offen offset:1024 sc1 lds
    buffer_load_dwordx4 v2, s[8:11], s40 offen offset:2048 sc1 lds
    buffer_load_dwordx4 v2, s[8:11], s40 offen offset:3072 sc1 lds
    s_mov_b32 m0, 31744
    s_add_u32 s40, s46, 31744
    buffer_load_dwordx4 v2, s[8:11], s40 offen sc1 lds
    s_waitcnt lgkmcnt(0)
    s_barrier
    s_mov_b32 m0, 3072
    s_add_u32 s40, s46, 35840
    buffer_load_dwordx4 v2, s[8:11], s40 offen sc1 lds
    buffer_load_dwordx4 v2, s[8:11], s40 offen offset:1024 sc1 lds
    buffer_load_dwordx4 v2, s[8:11], s40 offen offset:2048 sc1 lds
    buffer_load_dwordx4 v2, s[8:11], s40 offen offset:3072 sc1 lds
    s_mov_b32 m0, 7168
    s_add_u32 s40, s46, 39936
    buffer_load_dwordx4 v2, s[8:11], s40 offen sc1 lds
    s_waitcnt lgkmcnt(0)
    s_barrier
    s_mov_b32 m0, 11264
    s_add_u32 s40, s46, 44032
    buffer_load_dwordx4 v2, s[8:11], s40 offen sc1 lds
    buffer_load_dwordx4 v2, s[8:11], s40 offen offset:1024 sc1 lds
    buffer_load_dwordx4 v2, s[8:11], s40 offen offset:2048 sc1 lds
    buffer_load_dwordx4 v2, s[8:11], s40 offen offset:3072 sc1 lds
    s_mov_b32 m0, 15360
    s_add_u32 s40, s46, 48128
    buffer_load_dwordx4 v2, s[8:11], s40 offen sc1 lds
    s_waitcnt vmcnt(10) lgkmcnt(0)
    s_barrier
    s_mov_b32 m0, 19456
    s_add_u32 s40, s46, 52224
    buffer_load_dwordx4 v2, s[8:11], s40 offen sc1 lds
    buffer_load_dwordx4 v2, s[8:11], s40 offen offset:1024 sc1 lds
    buffer_load_dwordx4 v2, s[8:11], s40 offen offset:2048 sc1 lds
    buffer_load_dwordx4 v2, s[8:11], s40 offen offset:3072 sc1 lds
    s_mov_b32 m0, 23552
    s_add_u32 s40, s46, 56320
    buffer_load_dwordx4 v2, s[8:11], s40 offen sc1 lds
    s_waitcnt vmcnt(10) lgkmcnt(0)
    s_barrier
    s_mov_b32 m0, 27648
    s_add_u32 s40, s46, 60416
    buffer_load_dwordx4 v2, s[8:11], s40 offen sc1 lds
    buffer_load_dwordx4 v2, s[8:11], s40 offen offset:1024 sc1 lds
    buffer_load_dwordx4 v2, s[8:11], s40 offen offset:2048 sc1 lds
    buffer_load_dwordx4 v2, s[8:11], s40 offen offset:3072 sc1 lds
    s_mov_b32 m0, 31744
    s_add_u32 s40, s46, 64512
    buffer_load_dwordx4 v2, s[8:11], s40 offen sc1 lds
    s_waitcnt vmcnt(10) lgkmcnt(0)
    s_barrier
    s_mov_b32 m0, 3072
    s_add_u32 s40, s46, 68608
    buffer_load_dwordx4 v2, s[8:11], s40 offen sc1 lds
    buffer_load_dwordx4 v2, s[8:11], s40 offen offset:1024 sc1 lds
    buffer_load_dwordx4 v2, s[8:11], s40 offen offset:2048 sc1 lds
    buffer_load_dwordx4 v2, s[8:11], s40 offen offset:3072 sc1 lds
    s_mov_b32 m0, 7168
    s_add_u32 s40, s46, 72704
    buffer_load_dwordx4 v2, s[8:11], s40 offen sc1 lds
    s_lshl_b32 s42, s33, 3
    s_add_u32 s42, s42, 6
    s_lshl_b32 s42, s42, 10
    s_add_u32 s42, s42, 20062208
    v_and_b32 v5, 15, v1
    v_lshl_add_u32 v5, v5, 6, v3
    buffer_load_dwordx4 v[16:19], v5, s[8:11], s42 offen offset:0 sc1
    buffer_load_dwordx4 v[20:23], v5, s[8:11], s42 offen offset:1024 sc1
    s_waitcnt vmcnt(12) lgkmcnt(0)
    s_barrier
    s_mov_b32 m0, 11264
    s_add_u32 s40, s46, 76800
    buffer_load_dwordx4 v2, s[8:11], s40 offen sc1 lds
    buffer_load_dwordx4 v2, s[8:11], s40 offen offset:1024 sc1 lds
    buffer_load_dwordx4 v2, s[8:11], s40 offen offset:2048 sc1 lds
    buffer_load_dwordx4 v2, s[8:11], s40 offen offset:3072 sc1 lds
    s_mov_b32 m0, 15360
    s_add_u32 s40, s46, 80896
    buffer_load_dwordx4 v2, s[8:11], s40 offen sc1 lds
    s_waitcnt vmcnt(12) lgkmcnt(0)
    s_barrier
    s_mov_b32 m0, 19456
    s_add_u32 s40, s46, 84992
    buffer_load_dwordx4 v2, s[8:11], s40 offen sc1 lds
    buffer_load_dwordx4 v2, s[8:11], s40 offen offset:1024 sc1 lds
    buffer_load_dwordx4 v2, s[8:11], s40 offen offset:2048 sc1 lds
    buffer_load_dwordx4 v2, s[8:11], s40 offen offset:3072 sc1 lds
    s_mov_b32 m0, 23552
    s_add_u32 s40, s46, 89088
    buffer_load_dwordx4 v2, s[8:11], s40 offen sc1 lds
    s_waitcnt vmcnt(12) lgkmcnt(0)
    s_barrier
    s_mov_b32 m0, 27648
    s_add_u32 s40, s46, 93184
    buffer_load_dwordx4 v2, s[8:11], s40 offen sc1 lds
    buffer_load_dwordx4 v2, s[8:11], s40 offen offset:1024 sc1 lds
    buffer_load_dwordx4 v2, s[8:11], s40 offen offset:2048 sc1 lds
    buffer_load_dwordx4 v2, s[8:11], s40 offen offset:3072 sc1 lds
    s_mov_b32 m0, 31744
    s_add_u32 s40, s46, 97280
    buffer_load_dwordx4 v2, s[8:11], s40 offen sc1 lds
    s_waitcnt vmcnt(10) lgkmcnt(0)
    s_barrier
    s_mov_b32 m0, 3072
    s_add_u32 s40, s46, 101376
    buffer_load_dwordx4 v2, s[8:11], s40 offen sc1 lds
    buffer_load_dwordx4 v2, s[8:11], s40 offen offset:1024 sc1 lds
    buffer_load_dwordx4 v2, s[8:11], s40 offen offset:2048 sc1 lds
    buffer_load_dwordx4 v2, s[8:11], s40 offen offset:3072 sc1 lds
    s_mov_b32 m0, 7168
    s_add_u32 s40, s46, 105472
    buffer_load_dwordx4 v2, s[8:11], s40 offen sc1 lds
    s_waitcnt vmcnt(10) lgkmcnt(0)
    s_barrier
    s_mov_b32 m0, 11264
    s_add_u32 s40, s46, 109568
    buffer_load_dwordx4 v2, s[8:11], s40 offen sc1 lds
    buffer_load_dwordx4 v2, s[8:11], s40 offen offset:1024 sc1 lds
    buffer_load_dwordx4 v2, s[8:11], s40 offen offset:2048 sc1 lds
    buffer_load_dwordx4 v2, s[8:11], s40 offen offset:3072 sc1 lds
    s_mov_b32 m0, 15360
    s_add_u32 s40, s46, 113664
    buffer_load_dwordx4 v2, s[8:11], s40 offen sc1 lds
    v_min_u32 v58, 23, v1
    v_lshrrev_b32 v59, 1, v58
    v_mul_u32_u24 v57, 10, v59
    v_and_b32 v58, 1, v58
    s_mul_i32 s40, s36, 5
    s_add_u32 s41, s40, 4
    s_lshr_b32 s40, s40, 2
    s_lshr_b32 s41, s41, 2
    v_add_u32 v58, s40, v58
    v_min_u32 v58, s41, v58
    v_add_u32 v57, v57, v58
    v_lshlrev_b32 v57, 7, v57
    s_mov_b32 s47, 26533888
    buffer_load_dword v56, v57, s[8:11], s47 offen sc1
    s_waitcnt vmcnt(11) lgkmcnt(0)
    s_barrier
    s_mov_b32 m0, 19456
    s_add_u32 s40, s46, 117760
    buffer_load_dwordx4 v2, s[8:11], s40 offen sc1 lds
    buffer_load_dwordx4 v2, s[8:11], s40 offen offset:1024 sc1 lds
    buffer_load_dwordx4 v2, s[8:11], s40 offen offset:2048 sc1 lds
    buffer_load_dwordx4 v2, s[8:11], s40 offen offset:3072 sc1 lds
    s_mov_b32 m0, 23552
    s_add_u32 s40, s46, 121856
    buffer_load_dwordx4 v2, s[8:11], s40 offen sc1 lds
    s_waitcnt vmcnt(11) lgkmcnt(0)
    s_barrier
    s_mov_b32 m0, 27648
    s_add_u32 s40, s46, 125952
    buffer_load_dwordx4 v2, s[8:11], s40 offen sc1 lds
    buffer_load_dwordx4 v2, s[8:11], s40 offen offset:1024 sc1 lds
    buffer_load_dwordx4 v2, s[8:11], s40 offen offset:2048 sc1 lds
    buffer_load_dwordx4 v2, s[8:11], s40 offen offset:3072 sc1 lds
    s_mov_b32 m0, 31744
    s_add_u32 s40, s46, 130048
    buffer_load_dwordx4 v2, s[8:11], s40 offen sc1 lds
    s_waitcnt vmcnt(11) lgkmcnt(0)
    s_barrier
    s_mov_b32 m0, 3072
    s_add_u32 s40, s46, 134144
    buffer_load_dwordx4 v2, s[8:11], s40 offen sc1 lds
    buffer_load_dwordx4 v2, s[8:11], s40 offen offset:1024 sc1 lds
    buffer_load_dwordx4 v2, s[8:11], s40 offen offset:2048 sc1 lds
    buffer_load_dwordx4 v2, s[8:11], s40 offen offset:3072 sc1 lds
    s_mov_b32 m0, 7168
    s_add_u32 s40, s46, 138240
    buffer_load_dwordx4 v2, s[8:11], s40 offen sc1 lds
    s_waitcnt vmcnt(10) lgkmcnt(0)
    s_barrier
    s_mov_b32 m0, 11264
    s_add_u32 s40, s46, 142336
    buffer_load_dwordx4 v2, s[8:11], s40 offen sc1 lds
    buffer_load_dwordx4 v2, s[8:11], s40 offen offset:1024 sc1 lds
    buffer_load_dwordx4 v2, s[8:11], s40 offen offset:2048 sc1 lds
    buffer_load_dwordx4 v2, s[8:11], s40 offen offset:3072 sc1 lds
    s_mov_b32 m0, 15360
    s_add_u32 s40, s46, 146432
    buffer_load_dwordx4 v2, s[8:11], s40 offen sc1 lds
    s_waitcnt vmcnt(10) lgkmcnt(0)
    s_barrier
    s_mov_b32 m0, 19456
    s_add_u32 s40, s46, 150528
    buffer_load_dwordx4 v2, s[8:11], s40 offen sc1 lds
    buffer_load_dwordx4 v2, s[8:11], s40 offen offset:1024 sc1 lds
    buffer_load_dwordx4 v2, s[8:11], s40 offen offset:2048 sc1 lds
    buffer_load_dwordx4 v2, s[8:11], s40 offen offset:3072 sc1 lds
    s_mov_b32 m0, 23552
    s_add_u32 s40, s46, 154624
    buffer_load_dwordx4 v2, s[8:11], s40 offen sc1 lds
    s_waitcnt vmcnt(10) lgkmcnt(0)
    s_barrier
    s_mov_b32 m0, 27648
    s_add_u32 s40, s46, 158720
    buffer_load_dwordx4 v2, s[8:11], s40 offen sc1 lds
    buffer_load_dwordx4 v2, s[8:11], s40 offen offset:1024 sc1 lds
    buffer_load_dwordx4 v2, s[8:11], s40 offen offset:2048 sc1 lds
    buffer_load_dwordx4 v2, s[8:11], s40 offen offset:3072 sc1 lds
    s_mov_b32 m0, 31744
    s_add_u32 s40, s46, 162816
    buffer_load_dwordx4 v2, s[8:11], s40 offen sc1 lds
    s_waitcnt vmcnt(10) lgkmcnt(0)
    s_barrier
    v_add_f32 v46, v16, v18
    v_mov_b32 v47, v46
    s_nop 1
    v_permlane32_swap_b32 v46, v47
    v_add_f32 v46, v46, v47
    v_mov_b32 v47, v46
    s_nop 1
    v_permlane16_swap_b32 v46, v47
    v_add_f32 v46, v46, v47
    v_mul_f32 v46, 0x3e000000, v46
    v_sub_f32 v47, v16, v46
    v_sub_f32 v48, v18, v46
    v_mul_f32 v47, v47, v47
    v_fmac_f32 v47, v48, v48
    v_add_f32 v48, v17, v19
    v_fmac_f32 v48, 0x42a00000, v47
    v_mov_b32 v47, v48
    s_nop 1
    v_permlane32_swap_b32 v48, v47
    v_add_f32 v48, v48, v47
    v_mov_b32 v47, v48
    s_nop 1
    v_permlane16_swap_b32 v48, v47
    v_add_f32 v48, v48, v47
    v_mov_b32 v47, 0x3727c5ac
    v_fmac_f32 v47, 0x3acccccd, v48
    v_rsq_f32 v50, v47
    s_nop 0
    v_mul_f32 v51, v46, v50
    v_sub_f32 v51, 0, v51
    v_and_b32 v47, 15, v1
    v_lshlrev_b32 v47, 3, v47
    v_add_u32 v47, 145664, v47
    s_mov_b64 exec, 0xffff
    ds_write_b64 v47, v[50:51]
    s_mov_b64 exec, -1
    v_cmp_eq_u32 vcc, s96, v56
    s_nop 3
    s_cmp_eq_u64 vcc, -1
    s_cbranch_scc1 kp_sfok56
    s_mov_b32 s39, 32768
kp_p57:
    buffer_load_dword v56, v57, s[8:11], s47 offen sc1
    s_waitcnt vmcnt(0)
    v_cmp_eq_u32 vcc, s96, v56
    s_nop 3
    s_cmp_eq_u64 vcc, -1
    s_cbranch_scc1 kp_q58
    s_sub_u32 s39, s39, 1
    s_cmp_lg_u32 s39, 0
    s_cbranch_scc1 kp_p57
kp_q58:
kp_sfok56:
    s_mul_i32 s45, s36, 245760
    s_add_u32 s45, s45, 10108928
    s_mul_i32 s46, s35, 196608
    s_add_u32 s46, s46, 20193280
    s_mov_b32 m0, 40960
    s_add_u32 s40, s45, 8192
    buffer_load_dwordx4 v2, s[8:11], s40 offen sc1 lds
    buffer_load_dwordx4 v2, s[8:11], s40 offen offset:1024 sc1 lds
    s_waitcnt vmcnt(7) lgkmcnt(0)
    s_barrier
    v_add_f32 v46, v20, v22
    v_mov_b32 v47, v46
    s_nop 1
    v_permlane32_swap_b32 v46, v47
    v_add_f32 v46, v46, v47
    v_mov_b32 v47, v46
    s_nop 1
    v_permlane16_swap_b32 v46, v47
    v_add_f32 v46, v46, v47
    v_mul_f32 v46, 0x3e000000, v46
    v_sub_f32 v47, v20, v46
    v_sub_f32 v48, v22, v46
    v_mul_f32 v47, v47, v47
    v_fmac_f32 v47, v48, v48
    v_add_f32 v48, v21, v23
    v_fmac_f32 v48, 0x42a00000, v47
    v_mov_b32 v47, v48
    s_nop 1
    v_permlane32_swap_b32 v48, v47
    v_add_f32 v48, v48, v47
    v_mov_b32 v47, v48
    s_nop 1
    v_permlane16_swap_b32 v48, v47
    v_add_f32 v48, v48, v47
    v_mov_b32 v47, 0x3727c5ac
    v_fmac_f32 v47, 0x3acccccd, v48
    v_rsq_f32 v50, v47
    s_nop 0
    v_mul_f32 v51, v46, v50
    v_sub_f32 v51, 0, v51
    v_and_b32 v47, 15, v1
    v_lshlrev_b32 v47, 3, v47
    v_add_u32 v47, 145792, v47
    s_mov_b64 exec, 0xffff
    ds_write_b64 v47, v[50:51]
    s_mov_b64 exec, -1
    s_mov_b32 m0, 51200
    s_add_u32 s40, s45, 18432
    buffer_load_dwordx4 v2, s[8:11], s40 offen sc1 lds
    buffer_load_dwordx4 v2, s[8:11], s40 offen offset:1024 sc1 lds
    s_waitcnt vmcnt(4) lgkmcnt(0)
    s_barrier
    s_mov_b32 m0, 60416
    s_add_u32 s40, s45, 27648
    buffer_load_dwordx4 v2, s[8:11], s40 offen sc1 lds
    buffer_load_dwordx4 v2, s[8:11], s40 offen offset:1024 sc1 lds
    buffer_load_dwordx4 v2, s[8:11], s40 offen offset:2048 sc1 lds
    s_mov_b32 m0, 70656
    s_add_u32 s40, s45, 37888
    buffer_load_dwordx4 v2, s[8:11], s40 offen sc1 lds
    buffer_load_dwordx4 v2, s[8:11], s40 offen offset:1024 sc1 lds
    buffer_load_dwordx4 v2, s[8:11], s40 offen offset:2048 sc1 lds
    s_mov_b32 m0, 81920
    s_add_u32 s40, s45, 49152
    buffer_load_dwordx4 v2, s[8:11], s40 offen sc1 lds
    buffer_load_dwordx4 v2, s[8:11], s40 offen offset:1024 sc1 lds
    s_mov_b32 m0, 92160
    s_add_u32 s40, s45, 59392
    buffer_load_dwordx4 v2, s[8:11], s40 offen sc1 lds
    buffer_load_dwordx4 v2, s[8:11], s40 offen offset:1024 sc1 lds
    s_waitcnt vmcnt(12) lgkmcnt(0)
    s_barrier
    s_mov_b32 m0, 30720
    s_add_u32 s40, s46, 30720
    buffer_load_dwordx4 v2, s[8:11], s40 offen sc1 lds
    buffer_load_dwordx4 v2, s[8:11], s40 offen offset:1024 sc1 lds
    s_waitcnt vmcnt(12) lgkmcnt(0)
    s_barrier
    s_mov_b32 m0, 6144
    s_add_u32 s40, s46, 38912
    buffer_load_dwordx4 v2, s[8:11], s40 offen sc1 lds
    buffer_load_dwordx4 v2, s[8:11], s40 offen offset:1024 sc1 lds
    s_mov_b32 m0, 39936
    s_add_u32 s40, s45, 68608
    buffer_load_dwordx4 v2, s[8:11], s40 offen sc1 lds
    buffer_load_dwordx4 v2, s[8:11], s40 offen offset:1024 sc1 lds
    buffer_load_dwordx4 v2, s[8:11], s40 offen offset:2048 sc1 lds
    s_waitcnt vmcnt(14) lgkmcnt(0)
    s_barrier
    s_mov_b32 m0, 14336
    s_add_u32 s40, s46, 47104
    buffer_load_dwordx4 v2, s[8:11], s40 offen sc1 lds
    buffer_load_dwordx4 v2, s[8:11], s40 offen offset:1024 sc1 lds
    s_mov_b32 m0, 50176
    s_add_u32 s40, s45, 78848
    buffer_load_dwordx4 v2, s[8:11], s40 offen sc1 lds
    buffer_load_dwordx4 v2, s[8:11], s40 offen offset:1024 sc1 lds
    buffer_load_dwordx4 v2, s[8:11], s40 offen offset:2048 sc1 lds
    s_waitcnt vmcnt(10) lgkmcnt(0)
    s_barrier
    s_mov_b32 m0, 22528
    s_add_u32 s40, s46, 55296
    buffer_load_dwordx4 v2, s[8:11], s40 offen sc1 lds
    buffer_load_dwordx4 v2, s[8:11], s40 offen offset:1024 sc1 lds
    s_mov_b32 m0, 61440
    s_add_u32 s40, s45, 90112
    buffer_load_dwordx4 v2, s[8:11], s40 offen sc1 lds
    buffer_load_dwordx4 v2, s[8:11], s40 offen offset:1024 sc1 lds
    s_waitcnt vmcnt(12) lgkmcnt(0)
    s_barrier
    s_mov_b32 m0, 30720
    s_add_u32 s40, s46, 63488
    buffer_load_dwordx4 v2, s[8:11], s40 offen sc1 lds
    buffer_load_dwordx4 v2, s[8:11], s40 offen offset:1024 sc1 lds
    s_mov_b32 m0, 71680
    s_add_u32 s40, s45, 100352
    buffer_load_dwordx4 v2, s[8:11], s40 offen sc1 lds
    buffer_load_dwordx4 v2, s[8:11], s40 offen offset:1024 sc1 lds
    s_waitcnt vmcnt(11) lgkmcnt(0)
    s_barrier
    s_mov_b32 m0, 6144
    s_add_u32 s40, s46, 71680
    buffer_load_dwordx4 v2, s[8:11], s40 offen sc1 lds
    buffer_load_dwordx4 v2, s[8:11], s40 offen offset:1024 sc1 lds
    s_mov_b32 m0, 80896
    s_add_u32 s40, s45, 109568
    buffer_load_dwordx4 v2, s[8:11], s40 offen sc1 lds
    buffer_load_dwordx4 v2, s[8:11], s40 offen offset:1024 sc1 lds
    buffer_load_dwordx4 v2, s[8:11], s40 offen offset:2048 sc1 lds
    s_waitcnt vmcnt(11) lgkmcnt(0)
    s_barrier
    s_mov_b32 m0, 14336
    s_add_u32 s40, s46, 79872
    buffer_load_dwordx4 v2, s[8:11], s40 offen sc1 lds
    buffer_load_dwordx4 v2, s[8:11], s40 offen offset:1024 sc1 lds
    s_mov_b32 m0, 91136
    s_add_u32 s40, s45, 119808
    buffer_load_dwordx4 v2, s[8:11], s40 offen sc1 lds
    buffer_load_dwordx4 v2, s[8:11], s40 offen offset:1024 sc1 lds
    buffer_load_dwordx4 v2, s[8:11], s40 offen offset:2048 sc1 lds
    s_waitcnt vmcnt(12) lgkmcnt(0)
    s_barrier
    s_mov_b32 m0, 22528
    s_add_u32 s40, s46, 88064
    buffer_load_dwordx4 v2, s[8:11], s40 offen sc1 lds
    buffer_load_dwordx4 v2, s[8:11], s40 offen offset:1024 sc1 lds
    s_mov_b32 m0, 40960
    s_add_u32 s40, s45, 131072
    buffer_load_dwordx4 v2, s[8:11], s40 offen sc1 lds
    buffer_load_dwordx4 v2, s[8:11], s40 offen offset:1024 sc1 lds
    s_waitcnt vmcnt(12) lgkmcnt(0)
    s_barrier
    s_mov_b32 m0, 30720
    s_add_u32 s40, s46, 96256
    buffer_load_dwordx4 v2, s[8:11], s40 offen sc1 lds
    buffer_load_dwordx4 v2, s[8:11], s40 offen offset:1024 sc1 lds
    s_mov_b32 m0, 51200
    s_add_u32 s40, s45, 141312
    buffer_load_dwordx4 v2, s[8:11], s40 offen sc1 lds
    buffer_load_dwordx4 v2, s[8:11], s40 offen offset:1024 sc1 lds
    s_waitcnt vmcnt(11) lgkmcnt(0)
    s_barrier
    s_mov_b32 m0, 6144
    s_add_u32 s40, s46, 104448
    buffer_load_dwordx4 v2, s[8:11], s40 offen sc1 lds
    buffer_load_dwordx4 v2, s[8:11], s40 offen offset:1024 sc1 lds
    s_mov_b32 m0, 60416
    s_add_u32 s40, s45, 150528
    buffer_load_dwordx4 v2, s[8:11], s40 offen sc1 lds
    buffer_load_dwordx4 v2, s[8:11], s40 offen offset:1024 sc1 lds
    buffer_load_dwordx4 v2, s[8:11], s40 offen offset:2048 sc1 lds
    s_waitcnt vmcnt(11) lgkmcnt(0)
    s_barrier
    s_mov_b32 m0, 14336
    s_add_u32 s40, s46, 112640
    buffer_load_dwordx4 v2, s[8:11], s40 offen sc1 lds
    buffer_load_dwordx4 v2, s[8:11], s40 offen offset:1024 sc1 lds
    s_mov_b32 m0, 70656
    s_add_u32 s40, s45, 160768
    buffer_load_dwordx4 v2, s[8:11], s40 offen sc1 lds
    buffer_load_dwordx4 v2, s[8:11], s40 offen offset:1024 sc1 lds
    buffer_load_dwordx4 v2, s[8:11], s40 offen offset:2048 sc1 lds
    s_waitcnt vmcnt(12) lgkmcnt(0)
    s_barrier
    s_mov_b32 m0, 22528
    s_add_u32 s40, s46, 120832
    buffer_load_dwordx4 v2, s[8:11], s40 offen sc1 lds
    buffer_load_dwordx4 v2, s[8:11], s40 offen offset:1024 sc1 lds
    s_mov_b32 m0, 81920
    s_add_u32 s40, s45, 172032
    buffer_load_dwordx4 v2, s[8:11], s40 offen sc1 lds
    buffer_load_dwordx4 v2, s[8:11], s40 offen offset:1024 sc1 lds
    s_waitcnt vmcnt(12) lgkmcnt(0)
    s_barrier
    s_mov_b32 m0, 30720
    s_add_u32 s40, s46, 129024
    buffer_load_dwordx4 v2, s[8:11], s40 offen sc1 lds
    buffer_load_dwordx4 v2, s[8:11], s40 offen offset:1024 sc1 lds
    s_mov_b32 m0, 92160
    s_add_u32 s40, s45, 182272
    buffer_load_dwordx4 v2, s[8:11], s40 offen sc1 lds
    buffer_load_dwordx4 v2, s[8:11], s40 offen offset:1024 sc1 lds
    s_waitcnt vmcnt(11) lgkmcnt(0)
    s_barrier
    s_mov_b32 m0, 6144
    s_add_u32 s40, s46, 137216
    buffer_load_dwordx4 v2, s[8:11], s40 offen sc1 lds
    buffer_load_dwordx4 v2, s[8:11], s40 offen offset:1024 sc1 lds
    s_mov_b32 m0, 39936
    s_add_u32 s40, s45, 191488
    buffer_load_dwordx4 v2, s[8:11], s40 offen sc1 lds
    buffer_load_dwordx4 v2, s[8:11], s40 offen offset:1024 sc1 lds
    buffer_load_dwordx4 v2, s[8:11], s40 offen offset:2048 sc1 lds
    s_waitcnt vmcnt(11) lgkmcnt(0)
    s_barrier
    s_mov_b32 m0, 14336
    s_add_u32 s40, s46, 145408
    buffer_load_dwordx4 v2, s[8:11], s40 offen sc1 lds
    buffer_load_dwordx4 v2, s[8:11], s40 offen offset:1024 sc1 lds
    s_mov_b32 m0, 50176
    s_add_u32 s40, s45, 201728
    buffer_load_dwordx4 v2, s[8:11], s40 offen sc1 lds
    buffer_load_dwordx4 v2, s[8:11], s40 offen offset:1024 sc1 lds
    buffer_load_dwordx4 v2, s[8:11], s40 offen offset:2048 sc1 lds
    s_waitcnt vmcnt(12) lgkmcnt(0)
    s_barrier
    s_mov_b32 m0, 22528
    s_add_u32 s40, s46, 153600
    buffer_load_dwordx4 v2, s[8:11], s40 offen sc1 lds
    buffer_load_dwordx4 v2, s[8:11], s40 offen offset:1024 sc1 lds
    s_mov_b32 m0, 61440
    s_add_u32 s40, s45, 212992
    buffer_load_dwordx4 v2, s[8:11], s40 offen sc1 lds
    buffer_load_dwordx4 v2, s[8:11], s40 offen offset:1024 sc1 lds
    s_waitcnt vmcnt(12) lgkmcnt(0)
    s_barrier
    s_mov_b32 m0, 30720
    s_add_u32 s40, s46, 161792
    buffer_load_dwordx4 v2, s[8:11], s40 offen sc1 lds
    buffer_load_dwordx4 v2, s[8:11], s40 offen offset:1024 sc1 lds
    s_mov_b32 m0, 71680
    s_add_u32 s40, s45, 223232
    buffer_load_dwordx4 v2, s[8:11], s40 offen sc1 lds
    buffer_load_dwordx4 v2, s[8:11], s40 offen offset:1024 sc1 lds
    s_waitcnt vmcnt(11) lgkmcnt(0)
    s_barrier
    s_mov_b32 m0, 6144
    s_add_u32 s40, s46, 169984
    buffer_load_dwordx4 v2, s[8:11], s40 offen sc1 lds
    buffer_load_dwordx4 v2, s[8:11], s40 offen offset:1024 sc1 lds
    s_mov_b32 m0, 80896
    s_add_u32 s40, s45, 232448
    buffer_load_dwordx4 v2, s[8:11], s40 offen sc1 lds
    buffer_load_dwordx4 v2, s[8:11], s40 offen offset:1024 sc1 lds
    buffer_load_dwordx4 v2, s[8:11], s40 offen offset:2048 sc1 lds
    s_waitcnt vmcnt(11) lgkmcnt(0)
    s_barrier
    s_mov_b32 m0, 14336
    s_add_u32 s40, s46, 178176
    buffer_load_dwordx4 v2, s[8:11], s40 offen sc1 lds
    buffer_load_dwordx4 v2, s[8:11], s40 offen offset:1024 sc1 lds
    s_mov_b32 m0, 91136
    s_add_u32 s40, s45, 242688
    buffer_load_dwordx4 v2, s[8:11], s40 offen sc1 lds
    buffer_load_dwordx4 v2, s[8:11], s40 offen offset:1024 sc1 lds
    buffer_load_dwordx4 v2, s[8:11], s40 offen offset:2048 sc1 lds
    s_waitcnt vmcnt(12) lgkmcnt(0)
    s_barrier
    s_mov_b32 m0, 22528
    s_add_u32 s40, s46, 186368
    buffer_load_dwordx4 v2, s[8:11], s40 offen sc1 lds
    buffer_load_dwordx4 v2, s[8:11], s40 offen offset:1024 sc1 lds
    s_waitcnt vmcnt(10) lgkmcnt(0)
    s_barrier
    s_mov_b32 m0, 30720
    s_add_u32 s40, s46, 194560
    buffer_load_dwordx4 v2, s[8:11], s40 offen sc1 lds
    buffer_load_dwordx4 v2, s[8:11], s40 offen offset:1024 sc1 lds
    s_waitcnt vmcnt(7) lgkmcnt(0)
    s_barrier
    s_waitcnt vmcnt(2) lgkmcnt(0)
    s_barrier
    s_waitcnt vmcnt(0) lgkmcnt(0)
    s_barrier
    s_endpgm
kp_end:
    s_endpgm
all_code_end:
    s_endpgm
.section .rodata,"a"
.p2align 6
.amdhsa_kernel adaLN_cond__sliding_local_dilated__geglu_ffn__prompt_kernel
  .amdhsa_next_free_vgpr 256
  .amdhsa_next_free_sgpr 102
  .amdhsa_accum_offset 256
  .amdhsa_group_segment_fixed_size 0
  .amdhsa_kernarg_size 96
  .amdhsa_user_sgpr_count 2
  .amdhsa_user_sgpr_kernarg_segment_ptr 1
  .amdhsa_system_sgpr_workgroup_id_x 1
  .amdhsa_float_denorm_mode_32 3
.end_amdhsa_kernel
```
